```python
import torch

def _softmax(x, axis=-1):
    return torch.softmax(x, dim=axis)
def _gelu(x):
    return torch.nn.functional.gelu(x, approximate="tanh")
def _silu(x):
    return torch.nn.functional.silu(x)
def _sigmoid(x):
    return torch.sigmoid(x)
def _layernorm(x, axis=-1, eps=1e-5):
    m = x.mean(dim=axis, keepdim=True)
    v = x.var(dim=axis, keepdim=True, unbiased=False)
    return (x - m) / torch.sqrt(v + eps)
def _scatter_add(tgt, idx, src, axis=0):
    return tgt.clone().index_add_(axis, idx, src)
def _segment_sum(src, seg, n):
    out = torch.zeros((n,) + src.shape[1:], dtype=src.dtype)
    return out.index_add_(0, seg, src)
def _pad(x, pw):
    flat = tuple(v for pair in reversed(pw) for v in pair)
    return torch.nn.functional.pad(x, flat)

kernel_name = 'recurrent_scan__ssm_conv_s5__glu_gated_swiglu__prompt'

def setup_inputs():

    _w = (lambda a: (lambda t: t.to(torch.bfloat16) if t.is_floating_point() else t)(torch.as_tensor(a)))
    def _A_setup():
        B, S, D = 1, 2048, 640
        P = D
        Lambda_re = -0.5 * (lambda _x: torch.exp(torch.as_tensor(_x)))((lambda *s: torch.randn(*s, dtype=torch.bfloat16) * 0.8)(P))
        Lambda_im = (lambda *s: torch.randn(*s, dtype=torch.bfloat16) * 0.8)(P) * 1.0
        B_re = (lambda *s: torch.randn(*s, dtype=torch.bfloat16) * 0.8)(P, D) * (D ** -0.5)
        B_im = (lambda *s: torch.randn(*s, dtype=torch.bfloat16) * 0.8)(P, D) * (D ** -0.5)
        C_re = (lambda *s: torch.randn(*s, dtype=torch.bfloat16) * 0.8)(D, P) * (P ** -0.5)
        C_im = (lambda *s: torch.randn(*s, dtype=torch.bfloat16) * 0.8)(D, P) * (P ** -0.5)
        log_dt = (lambda *s: torch.randn(*s, dtype=torch.bfloat16) * 0.8)(P) * 0.3 - 2.0
        Dskip = (lambda *s: torch.randn(*s, dtype=torch.bfloat16) * 0.8)(D)
        return {
            "x": _w((lambda *s: torch.randn(*s, dtype=torch.bfloat16) * 0.05)(B, S, D)),
            "Lambda_re": _w(Lambda_re),
            "Lambda_im": _w(Lambda_im),
            "B_re": _w(B_re),
            "B_im": _w(B_im),
            "C_re": _w(C_re),
            "C_im": _w(C_im),
            "log_dt": _w(log_dt),
            "Dskip": _w(Dskip),
        }
    _A_in = _A_setup()

    def _B_setup():
        B, S, D, F = 1, 2048, 640, 1728
        return {
            "x": _w((lambda *s: torch.randn(*s, dtype=torch.bfloat16) * 0.05)(B, S, D)),
            "w1": _w((lambda *s: torch.randn(*s, dtype=torch.bfloat16) * 0.2)(D, F) * (2.0 / D) ** 0.5),
            "w3": _w((lambda *s: torch.randn(*s, dtype=torch.bfloat16) * 0.2)(D, F) * (2.0 / D) ** 0.5),
            "w2": _w((lambda *s: torch.randn(*s, dtype=torch.bfloat16) * 0.2)(F, D) * (2.0 / F) ** 0.5),
        }
    _B_in = _B_setup()

    return {
        "A_x": _A_in["x"],
        "A_Lambda_re": _A_in["Lambda_re"],
        "A_Lambda_im": _A_in["Lambda_im"],
        "A_B_re": _A_in["B_re"],
        "A_B_im": _A_in["B_im"],
        "A_C_re": _A_in["C_re"],
        "A_C_im": _A_in["C_im"],
        "A_log_dt": _A_in["log_dt"],
        "A_Dskip": _A_in["Dskip"],
        "B_x": _B_in["x"],
        "B_w1": _B_in["w1"],
        "B_w3": _B_in["w3"],
        "B_w2": _B_in["w2"],
    }

def reference(A_x, A_Lambda_re, A_Lambda_im, A_B_re, A_B_im, A_C_re, A_C_im, A_log_dt, A_Dskip, B_x, B_w1, B_w3, B_w2):
    def _A_ref(x, Lambda_re, Lambda_im, B_re, B_im, C_re, C_im, log_dt, Dskip):
        Bsz, L, H = x.shape
        Lam = Lambda_re + 1j * Lambda_im
        Bmat = B_re + 1j * B_im
        Cmat = C_re + 1j * C_im
        dt = torch.exp(log_dt)
        Lam_bar = torch.exp(dt * Lam)
        B_bar = ((Lam_bar - 1.0) / Lam)[:, None] * Bmat
        Bu = torch.einsum("bld,pd->blp", x + 0j, B_bar)
        h = torch.zeros_like(Bu[:, 0, :])
        hs = []
        for t in range(L):
            h = Lam_bar[None, :] * h + Bu[:, t, :]
            hs.append(h)
        hseq = torch.stack(hs, 1)
        y = 2.0 * torch.einsum("blp,dp->bld", hseq, Cmat).real + x * Dskip[None, None, :]
        return y

    def _B_ref(x, w1, w3, w2):
        gate = torch.einsum("bsd,df->bsf", x, w1)
        up = torch.einsum("bsd,df->bsf", x, w3)
        h = _silu(gate) * up
        out = torch.einsum("bsf,fd->bsd", h, w2)
        return out

    x = A_x
    xn = _layernorm(x, axis=-1)
    s = _A_ref(xn, A_Lambda_re, A_Lambda_im, A_B_re, A_B_im, A_C_re, A_C_im, A_log_dt, A_Dskip)
    g = _silu(_B_ref(xn, B_w1, B_w3, B_w2))
    return x + s * g
```

```asm
; @launch grid=(256,1,1) block=(512,1,1) lds=163840
.amdgcn_target "amdgcn-amd-amdhsa--gfx950"
.text
.globl recurrent_scan__ssm_conv_s5__glu_gated_swiglu__prompt_kernel
.p2align 8
.type recurrent_scan__ssm_conv_s5__glu_gated_swiglu__prompt_kernel,@function
recurrent_scan__ssm_conv_s5__glu_gated_swiglu__prompt_kernel:
    s_cmp_ge_u32 s2, 256
    s_cbranch_scc1 L_end
    s_load_dwordx16 s[64:79], s[0:1], 0
    s_load_dwordx16 s[80:95], s[0:1], 64
    v_lshrrev_b32 v2, 6, v0
    v_and_b32 v1, 63, v0
    v_readfirstlane_b32 s32, v2
    s_bfe_u32 s3, s2, 0x20003
    s_mul_i32 s3, s3, 5
    s_add_u32 s3, s3, 1
    s_lshr_b32 s3, s3, 1
    s_lshr_b32 s54, s2, 5
    s_add_u32 s3, s3, s54
    s_sub_u32 s54, s3, 10
    s_min_u32 s3, s3, s54
    s_and_b32 s54, s2, 1
    s_add_u32 s3, s3, s54
    s_bfe_u32 s54, s2, 0x20001
    s_mul_i32 s54, s54, 3
    s_add_u32 s3, s3, s54
    s_sub_u32 s54, s3, 10
    s_min_u32 s3, s3, s54
    s_lshr_b32 s54, s2, 5
    s_xor_b32 s54, s54, s2
    s_and_b32 s54, s54, 4
    s_mul_i32 s54, s54, 33
    s_xor_b32 s2, s2, s54
    s_and_b32 s38, s2, 7
    s_lshr_b32 s39, s2, 3
    s_and_b32 s35, s38, 1
    s_lshl_b32 s35, s35, 2
    s_and_b32 s46, s39, 3
    s_add_u32 s35, s35, s46
    s_lshr_b32 s46, s38, 1
    s_lshr_b32 s47, s39, 2
    s_lshl_b32 s37, s46, 3
    s_add_u32 s37, s37, s47
    s_and_b32 s33, s32, 3
    s_lshr_b32 s34, s32, 2
    s_mul_i32 s48, s46, 5
    s_add_u32 s48, s48, s47
    s_sub_u32 s48, s48, 10
    s_mul_i32 s51, s46, 3
    s_add_u32 s51, s51, s47
    s_add_u32 s51, s51, 5
    s_cmp_lt_u32 s46, 2
    s_cselect_b32 s50, s37, s51
    s_cselect_b32 s52, 0, 5
    v_and_b32 v3, 15, v1
    v_lshrrev_b32 v4, 4, v1
    v_lshlrev_b32 v5, 4, v1
    v_lshlrev_b32 v6, 2, v1
    s_lshl_b32 s40, s32, 12
    s_lshl_b32 s96, s34, 1
    s_add_u32 s96, s96, s33
    s_and_b32 s96, s96, 3
    s_lshl_b32 s53, s35, 8
    s_lshl_b32 s54, s37, 3
    s_add_u32 s53, s53, s54
    s_add_u32 s53, s53, s32
    s_cmp_lg_u32 s32, 7
    s_cbranch_scc1 Lskip_1
    s_getpc_b64 s[28:29]
    s_mov_b32 s30, CODE_BYTES
    s_mov_b32 s31, 0x20000
    s_and_b32 s54, s39, 15
    s_mul_i32 s54, s54, 3072
    s_mov_b64 exec, 0xffffff
    v_lshlrev_b32 v2, 7, v1
    buffer_load_dword v254, v2, s[28:31], s54 offen
    s_mov_b64 exec, -1
Lskip_1:
L_pc:
    s_cmp_lt_u32 s47, s52
    s_cselect_b64 s[62:63], -1, 0
    v_lshrrev_b32 v7, 3, v1
    v_and_b32 v8, 7, v1
    v_lshrrev_b32 v10, 4, v1
    v_xor_b32 v10, v10, v8
    v_lshlrev_b32 v10, 4, v10
    v_lshrrev_b32 v11, 2, v7
    v_lshlrev_b32 v11, 4, v11
    v_and_b32 v12, 1, v7
    v_lshl_add_u32 v11, v12, 3, v11
    v_bfe_u32 v12, v7, 1, 1
    v_add_u32 v11, v11, v12
    v_cndmask_b32 v9, v7, v11, s[62:63]
    s_lshl_b32 s55, s32, 5
    s_lshr_b32 s56, s32, 1
    s_lshl_b32 s56, s56, 6
    s_and_b32 s57, s32, 1
    s_lshl_b32 s57, s57, 2
    s_add_u32 s56, s56, s57
    s_cmp_lg_u32 s62, 0
    s_cselect_b32 s55, s56, s55
    s_cselect_b32 s57, 32, 8
    s_cselect_b32 s58, 2, 16
    s_lshl_b32 s56, s35, 8
    s_add_u32 s55, s55, s56
    v_add_u32 v9, s55, v9
    v_mul_u32_u24 v9, 1280, v9
    s_mul_i32 s57, s57, 1280
    s_mul_i32 s58, s58, 1280
    v_add_u32 v192, v9, v10
    v_xor_b32 v10, 64, v10
    v_add3_u32 v193, v9, v10, s57
    v_add_u32 v194, s58, v192
    v_add_u32 v195, s58, v193
    s_waitcnt lgkmcnt(0)
    s_mov_b32 s4, s64
    s_mov_b32 s5, s65
    s_mov_b32 s6, 2621440
    s_mov_b32 s7, 0x20000
    s_mov_b32 s8, s94
    s_mov_b32 s9, s95
    s_mov_b32 s10, 30408704
    s_mov_b32 s11, 0x20000
    s_mov_b32 s12, s92
    s_mov_b32 s13, s93
    s_mov_b32 s14, 256
    s_mov_b32 s15, 0x20000
    s_cmp_eq_u32 s62, 0
    s_cbranch_scc1 Lskip_2
    s_lshl_b32 s60, s48, 7
    s_lshl_b32 s61, s34, 6
    s_add_u32 s60, s60, s61
    v_lshlrev_b32 v7, 1, v3
    s_mov_b32 s28, s66
    s_mov_b32 s29, s67
    s_mov_b32 s30, 1280
    s_mov_b32 s31, 0x20000
    buffer_load_ushort v236, v7, s[28:31], s60 offen offset:0
    buffer_load_ushort v237, v7, s[28:31], s60 offen offset:32
    s_mov_b32 s28, s68
    s_mov_b32 s29, s69
    s_mov_b32 s30, 1280
    s_mov_b32 s31, 0x20000
    buffer_load_ushort v238, v7, s[28:31], s60 offen offset:0
    buffer_load_ushort v239, v7, s[28:31], s60 offen offset:32
    s_mov_b32 s28, s78
    s_mov_b32 s29, s79
    s_mov_b32 s30, 1280
    s_mov_b32 s31, 0x20000
    buffer_load_ushort v240, v7, s[28:31], s60 offen offset:0
    buffer_load_ushort v241, v7, s[28:31], s60 offen offset:32
Lskip_2:
    s_and_b32 s60, s53, 0xfffffff0
    s_bfe_u32 s61, s53, 0x10003
    s_lshl_b32 s61, s61, 2
    s_add_u32 s60, s60, s61
    s_add_u32 s60, s60, s33
    s_lshl_b32 s61, s34, 3
    s_add_u32 s60, s60, s61
    s_mul_i32 s60, s60, 1280
    buffer_load_dwordx4 v[212:215], v5, s[4:7], s60 offen
    buffer_load_dword v216, v6, s[4:7], s60 offen offset:1024
    s_lshl_b32 s44, s3, 7
    s_add_u32 m0, s40, 0
    s_nop 0
    buffer_load_dwordx4 v192, s[4:7], s44 offen lds
    s_add_u32 m0, s40, 1024
    s_nop 0
    buffer_load_dwordx4 v193, s[4:7], s44 offen lds
    s_add_u32 m0, s40, 2048
    s_nop 0
    buffer_load_dwordx4 v194, s[4:7], s44 offen lds
    s_add_u32 m0, s40, 3072
    s_nop 0
    buffer_load_dwordx4 v195, s[4:7], s44 offen lds
    s_cmp_lg_u32 s62, 0
    s_cbranch_scc1 L_ssm
    s_mov_b32 s36, s50
    s_mul_i32 s46, s36, 80
    s_add_u32 s47, s46, 32
    s_add_u32 s48, s46, 64
    s_cmp_eq_u32 s36, 21
    s_cselect_b32 s48, s47, s48
    s_cselect_b32 s47, s46, s47
    s_mul_i32 s45, s3, 221184
    s_mul_i32 s49, s32, 3
    s_lshl_b32 s50, s32, 1
    s_add_u32 s50, s50, 4
    s_cmp_lt_u32 s32, 4
    s_cselect_b32 s49, s49, s50
    s_add_u32 s50, s49, 0
    s_lshl_b32 s51, s50, 10
    s_add_u32 s41, s51, 32768
    s_cmp_ge_u32 s50, 10
    s_cselect_b32 s51, 10, 0
    s_cselect_b32 s57, 1, 0
    s_sub_u32 s50, s50, s51
    s_lshl_b32 s50, s50, 6
    v_add_u32 v7, s50, v1
    v_mul_u32_u24 v8, 6554, v7
    v_lshrrev_b32 v8, 16, v8
    v_mul_u32_u24 v9, 10, v8
    v_sub_u32 v9, v7, v9
    v_and_b32 v10, 35, v8
    v_bfe_u32 v11, v8, 2, 2
    v_lshl_add_u32 v10, v11, 3, v10
    v_bfe_u32 v11, v8, 4, 1
    v_lshl_add_u32 v10, v11, 2, v10
    v_and_b32 v11, 3, v9
    v_lshlrev_b32 v11, 3, v11
    v_add_u32 v12, s46, v11
    v_add_u32 v13, s47, v11
    v_cmp_gt_u32 vcc, 4, v9
    s_nop 1
    v_cndmask_b32 v12, v13, v12, vcc
    v_and_b32 v11, 1, v9
    v_xor_b32 v11, s57, v11
    v_lshlrev_b32 v11, 3, v11
    v_add_u32 v13, s48, v11
    v_cmp_gt_u32 vcc, 8, v9
    s_nop 1
    v_cndmask_b32 v12, v13, v12, vcc
    v_mul_u32_u24 v10, 3456, v10
    v_lshl_add_u32 v196, v12, 1, v10
    s_add_u32 s50, s49, 1
    s_lshl_b32 s51, s50, 10
    s_add_u32 s42, s51, 32768
    s_cmp_ge_u32 s50, 10
    s_cselect_b32 s51, 10, 0
    s_cselect_b32 s58, 1, 0
    s_sub_u32 s50, s50, s51
    s_lshl_b32 s50, s50, 6
    v_add_u32 v7, s50, v1
    v_mul_u32_u24 v8, 6554, v7
    v_lshrrev_b32 v8, 16, v8
    v_mul_u32_u24 v9, 10, v8
    v_sub_u32 v9, v7, v9
    v_and_b32 v10, 35, v8
    v_bfe_u32 v11, v8, 2, 2
    v_lshl_add_u32 v10, v11, 3, v10
    v_bfe_u32 v11, v8, 4, 1
    v_lshl_add_u32 v10, v11, 2, v10
    v_and_b32 v11, 3, v9
    v_lshlrev_b32 v11, 3, v11
    v_add_u32 v12, s46, v11
    v_add_u32 v13, s47, v11
    v_cmp_gt_u32 vcc, 4, v9
    s_nop 1
    v_cndmask_b32 v12, v13, v12, vcc
    v_and_b32 v11, 1, v9
    v_xor_b32 v11, s58, v11
    v_lshlrev_b32 v11, 3, v11
    v_add_u32 v13, s48, v11
    v_cmp_gt_u32 vcc, 8, v9
    s_nop 1
    v_cndmask_b32 v12, v13, v12, vcc
    v_mul_u32_u24 v10, 3456, v10
    v_lshl_add_u32 v197, v12, 1, v10
    s_add_u32 s50, s49, 2
    s_lshl_b32 s51, s50, 10
    s_add_u32 s43, s51, 32768
    s_cmp_ge_u32 s50, 10
    s_cselect_b32 s51, 10, 0
    s_cselect_b32 s59, 1, 0
    s_sub_u32 s50, s50, s51
    s_lshl_b32 s50, s50, 6
    v_add_u32 v7, s50, v1
    v_mul_u32_u24 v8, 6554, v7
    v_lshrrev_b32 v8, 16, v8
    v_mul_u32_u24 v9, 10, v8
    v_sub_u32 v9, v7, v9
    v_and_b32 v10, 35, v8
    v_bfe_u32 v11, v8, 2, 2
    v_lshl_add_u32 v10, v11, 3, v10
    v_bfe_u32 v11, v8, 4, 1
    v_lshl_add_u32 v10, v11, 2, v10
    v_and_b32 v11, 3, v9
    v_lshlrev_b32 v11, 3, v11
    v_add_u32 v12, s46, v11
    v_add_u32 v13, s47, v11
    v_cmp_gt_u32 vcc, 4, v9
    s_nop 1
    v_cndmask_b32 v12, v13, v12, vcc
    v_and_b32 v11, 1, v9
    v_xor_b32 v11, s59, v11
    v_lshlrev_b32 v11, 3, v11
    v_add_u32 v13, s48, v11
    v_cmp_gt_u32 vcc, 8, v9
    s_nop 1
    v_cndmask_b32 v12, v13, v12, vcc
    v_mul_u32_u24 v10, 3456, v10
    v_lshl_add_u32 v198, v12, 1, v10
    s_add_u32 s52, s43, 53248
    s_add_u32 s37, s43, 106496
    s_cmp_ge_u32 s32, 4
    s_cselect_b32 s43, 162816, s43
    s_cselect_b32 s52, 162816, s52
    s_cselect_b32 s37, 162816, s37
    s_cselect_b32 s50, 0x40000000, 0
    v_add_u32 v198, s50, v198
    s_cmp_eq_u32 s57, 1
    s_cselect_b32 s16, s86, s84
    s_cselect_b32 s17, s87, s85
    s_mov_b32 s18, 2211840
    s_mov_b32 s19, 0x20000
    s_cmp_eq_u32 s58, 1
    s_cselect_b32 s20, s86, s84
    s_cselect_b32 s21, s87, s85
    s_mov_b32 s22, 2211840
    s_mov_b32 s23, 0x20000
    s_cmp_eq_u32 s59, 1
    s_cselect_b32 s24, s86, s84
    s_cselect_b32 s25, s87, s85
    s_mov_b32 s26, 2211840
    s_mov_b32 s27, 0x20000
    s_add_u32 m0, s41, 0
    s_nop 0
    buffer_load_dwordx4 v196, s[16:19], s45 offen lds
    s_add_u32 m0, s42, 0
    s_nop 0
    buffer_load_dwordx4 v197, s[20:23], s45 offen lds
    s_mov_b32 m0, s43
    s_nop 0
    buffer_load_dwordx4 v198, s[24:27], s45 offen lds
    s_cmp_lg_u32 s32, 6
    s_cbranch_scc1 Lskip_3
    s_and_b32 s60, s35, 3
    s_mul_i32 s60, s60, 5
    s_add_u32 s60, s60, 1
    s_lshr_b32 s60, s60, 1
    s_lshr_b32 s61, s35, 2
    s_add_u32 s60, s60, s61
    s_mul_i32 s61, s61, 5
    s_add_u32 s61, s61, 12
    s_add_u32 s61, s61, s3
    s_sub_u32 s61, s61, s60
    s_sub_u32 s60, s61, 10
    s_min_u32 s61, s61, s60
    s_sub_u32 s60, s61, 10
    s_min_u32 s61, s61, s60
    s_bitcmp1_b32 s35, 1
    s_cselect_b32 s28, s86, s84
    s_cselect_b32 s29, s87, s85
    s_mov_b32 s30, 2211840
    s_mov_b32 s31, 0x20000
    s_and_b32 s60, s35, 1
    s_lshl_b32 s61, s61, 1
    s_add_u32 s61, s61, s60
    s_mul_i32 s61, s61, 110592
    s_mul_i32 s60, s36, 160
    s_add_u32 s61, s61, s60
    v_lshrrev_b32 v228, 1, v1
    v_mul_u32_u24 v228, 3456, v228
    v_and_b32 v229, 1, v1
    v_mul_u32_u24 v229, 156, v229
    v_add_u32 v228, v228, v229
    buffer_load_dword v254, v228, s[28:31], s61 offen
Lskip_3:
    s_barrier
    s_lshl_b32 s55, s33, 13
    s_add_u32 s55, s55, 0
    v_lshrrev_b32 v7, 1, v3
    v_xor_b32 v7, v7, v4
    v_lshlrev_b32 v7, 4, v7
    v_lshl_add_u32 v7, v3, 7, v7
    v_add_u32 v7, s55, v7
    v_xor_b32 v8, 64, v7
    v_add_u32 v200, 0, v7
    v_add_u32 v201, 0, v8
    v_add_u32 v204, 53248, v7
    v_add_u32 v205, 53248, v8
    v_add_u32 v208, 106496, v7
    v_add_u32 v209, 106496, v8
    v_lshrrev_b32 v7, 5, v1
    v_mul_u32_u24 v7, 1280, v7
    v_bfe_u32 v8, v1, 2, 3
    v_mul_u32_u24 v8, 160, v8
    v_add_u32 v7, v7, v8
    v_add_u32 v7, 32768, v7
    v_and_b32 v8, 3, v1
    s_lshl_b32 s55, s34, 6
    v_lshl_add_u32 v9, v8, 3, v7
    v_add_u32 v9, s55, v9
    v_lshrrev_b32 v10, 1, v8
    v_mul_u32_u24 v11, 10240, v10
    v_xor_b32 v10, s34, v10
    v_lshl_add_u32 v11, v10, 4, v11
    v_and_b32 v10, 1, v8
    v_lshl_add_u32 v11, v10, 3, v11
    v_add3_u32 v11, v11, v7, 64
    v_add_u32 v11, 64, v11
    v_add_u32 v202, 0, v9
    v_add_u32 v203, 0, v11
    v_add_u32 v206, 53248, v9
    v_add_u32 v207, 53248, v11
    v_add_u32 v210, 106496, v9
    v_add_u32 v211, 106496, v11
    v_mov_b32 v188, 0x3f803f80
    v_mov_b32 v189, 0x3f803f80
    v_mov_b32 v190, 0x3f803f80
    v_mov_b32 v191, 0x3f803f80
    v_and_b32 v9, 6, v3
    v_lshlrev_b32 v9, 1, v9
    v_and_b32 v10, 1, v3
    v_lshl_add_u32 v9, v10, 1, v9
    v_lshrrev_b32 v10, 3, v3
    v_add_lshl_u32 v9, v9, v10, 2
    s_lshl_b32 s55, s33, 8
    s_add_u32 s55, s55, 153600
    v_add_u32 v12, s55, v9
    v_add_u32 v14, 162560, v6
    v_mov_b32 v15, 0
    s_mov_b64 exec, 0xff
    ds_write_b32 v14, v15
    s_mov_b64 exec, -1
    s_mov_b32 s28, s88
    s_mov_b32 s29, s89
    s_mov_b32 s30, 2211840
    s_mov_b32 s31, 0x20000
    v_lshrrev_b32 v220, 3, v1
    v_and_b32 v221, 7, v1
    v_lshrrev_b32 v222, 1, v221
    v_and_b32 v223, 1, v1
    v_lshlrev_b32 v223, 4, v223
    v_lshl_add_u32 v223, v220, 5, v223
    v_and_b32 v224, 3, v220
    v_lshrrev_b32 v225, 2, v220
    v_lshl_add_u32 v226, v225, 3, v224
    s_mul_i32 s56, s53, 19419
    s_lshr_b32 s56, s56, 22
    s_mul_i32 s57, s56, 216
    s_sub_u32 s57, s53, s57
    s_lshr_b32 s58, s57, 2
    s_and_b32 s57, s57, 3
    s_lshl_b32 s59, s56, 2
    v_add_u32 v242, s59, v222
    v_mul_u32_u24 v227, 52, v242
    v_lshrrev_b32 v227, 8, v227
    v_mul_u32_u24 v227, 271360, v227
    v_lshl_add_u32 v242, v242, 10, v227
    s_mul_i32 s59, s58, 5120
    s_lshl_b32 s60, s57, 8
    s_add_u32 s59, s59, s60
    s_add_u32 s59, s59, 1048576
    v_add3_u32 v242, v242, v223, s59
    s_mul_i32 s59, s58, 13108
    s_lshr_b32 s59, s59, 16
    s_mul_i32 s60, s59, 5
    s_sub_u32 s60, s58, s60
    s_mul_i32 s59, s59, 160
    s_cmp_eq_u32 s58, 53
    s_cselect_b32 s60, 4, s60
    s_cselect_b32 s58, 48, 80
    s_and_b32 s61, s57, 1
    s_mul_i32 s58, s58, s61
    s_lshr_b32 s61, s57, 1
    s_lshl_b32 s61, s61, 2
    s_add_u32 s58, s58, s61
    s_add_u32 s58, s58, 64
    s_lshr_b32 s61, s60, 1
    s_mul_i32 s61, s61, 80
    s_and_b32 s62, s60, 1
    s_lshl_b32 s62, s62, 5
    s_add_u32 s61, s61, s62
    s_lshl_b32 s62, s57, 3
    s_add_u32 s61, s61, s62
    s_cmp_eq_u32 s60, 4
    s_cselect_b32 s61, s58, s61
    s_cselect_b64 s[62:63], -1, 0
    v_cndmask_b32 v234, v220, v226, s[62:63]
    s_add_u32 s59, s59, s61
    s_mul_i32 s59, s59, 1280
    s_lshl_b32 s56, s56, 7
    s_add_u32 s54, s59, s56
    v_mul_u32_u24 v234, 1280, v234
    v_lshl_add_u32 v234, v221, 4, v234
    s_mul_i32 s56, s53, 6554
    s_lshr_b32 s56, s56, 16
    s_mul_i32 s57, s56, 10
    s_sub_u32 s57, s53, s57
    s_mul_i32 s58, s56, 6554
    s_lshr_b32 s58, s58, 16
    s_mul_i32 s59, s58, 10
    s_sub_u32 s59, s56, s59
    s_lshr_b32 s60, s58, 1
    s_mul_i32 s60, s60, 10
    s_add_u32 s60, s60, s57
    s_mul_i32 s60, s60, 10240
    s_lshl_b32 s59, s59, 7
    s_add_u32 s55, s60, s59
    s_and_b32 s57, s57, 1
    s_lshl_b32 s57, s57, 2
    v_lshrrev_b32 v229, 4, v1
    v_add_u32 v229, s57, v229
    v_xor_b32 v229, v229, v221
    v_mul_u32_u24 v235, 1280, v220
    v_lshl_add_u32 v235, v229, 4, v235
    s_lshl_b32 s59, s53, 10
    s_add_u32 s59, s59, 3260416
    v_add_u32 v243, s59, v5
    s_bitcmp1_b32 s58, 0
    s_cselect_b32 s98, s76, s74
    s_cselect_b32 s99, s77, s75
    s_mov_b32 s97, 819200
    s_cmp_lt_u32 s53, 1600
    s_cbranch_scc1 Lskip_4
    s_lshr_b32 s55, s53, 2
    s_add_u32 s55, s55, 1648
    s_mul_i32 s56, s55, 19419
    s_lshr_b32 s56, s56, 22
    s_mul_i32 s57, s56, 216
    s_sub_u32 s57, s55, s57
    s_lshr_b32 s58, s57, 2
    s_and_b32 s57, s57, 3
    s_lshl_b32 s59, s56, 2
    v_add_u32 v243, s59, v222
    v_mul_u32_u24 v227, 52, v243
    v_lshrrev_b32 v227, 8, v227
    v_mul_u32_u24 v227, 271360, v227
    v_lshl_add_u32 v243, v243, 10, v227
    s_mul_i32 s59, s58, 5120
    s_lshl_b32 s60, s57, 8
    s_add_u32 s59, s59, s60
    s_add_u32 s59, s59, 1048576
    v_add3_u32 v243, v243, v223, s59
    s_mul_i32 s59, s58, 13108
    s_lshr_b32 s59, s59, 16
    s_mul_i32 s60, s59, 5
    s_sub_u32 s60, s58, s60
    s_mul_i32 s59, s59, 160
    s_cmp_eq_u32 s58, 53
    s_cselect_b32 s60, 4, s60
    s_cselect_b32 s58, 48, 80
    s_and_b32 s61, s57, 1
    s_mul_i32 s58, s58, s61
    s_lshr_b32 s61, s57, 1
    s_lshl_b32 s61, s61, 2
    s_add_u32 s58, s58, s61
    s_add_u32 s58, s58, 64
    s_lshr_b32 s61, s60, 1
    s_mul_i32 s61, s61, 80
    s_and_b32 s62, s60, 1
    s_lshl_b32 s62, s62, 5
    s_add_u32 s61, s61, s62
    s_lshl_b32 s62, s57, 3
    s_add_u32 s61, s61, s62
    s_cmp_eq_u32 s60, 4
    s_cselect_b32 s61, s58, s61
    s_cselect_b64 s[62:63], -1, 0
    v_cndmask_b32 v235, v220, v226, s[62:63]
    s_add_u32 s59, s59, s61
    s_mul_i32 s59, s59, 1280
    s_lshl_b32 s56, s56, 7
    s_add_u32 s55, s59, s56
    v_mul_u32_u24 v235, 1280, v235
    v_lshl_add_u32 v235, v221, 4, v235
    s_mov_b32 s98, s88
    s_mov_b32 s99, s89
    s_and_b32 s97, s53, 3
    s_cmp_eq_u32 s97, 0
    s_cselect_b32 s97, 2211840, 0
    s_cselect_b32 s59, 0, 30408704
    v_add_u32 v243, s59, v243
Lskip_4:
    s_mov_b32 s58, s97
    s_mov_b32 s56, s98
    s_mov_b32 s57, s99
    s_mov_b32 s59, 0x20000
    s_lshl_b32 s60, s35, 4
    s_lshl_b32 s61, s33, 2
    s_add_u32 s60, s60, s61
    s_mul_i32 s60, s60, 54
    s_lshr_b32 s61, s36, 1
    s_mul_i32 s61, s61, 5
    s_and_b32 s62, s36, 1
    s_lshl_b32 s62, s62, 1
    s_add_u32 s62, s62, s34
    s_add_u32 s50, s61, s62
    s_add_u32 s50, s50, s60
    s_lshl_b32 s50, s50, 10
    s_add_u32 s50, s50, 5242880
    s_add_u32 s51, s61, 4
    s_min_u32 s51, s51, 53
    s_add_u32 s51, s51, s60
    s_lshl_b32 s51, s51, 10
    s_lshl_b32 s62, s62, 8
    s_add_u32 s51, s51, s62
    s_add_u32 s51, s51, 5242880
    s_cmp_eq_u32 s36, 21
    s_cselect_b32 s60, s34, 0
    s_cmp_eq_u32 s60, 1
    s_cselect_b32 s50, 30408704, s50
    v_and_b32 v11, 1, v4
    v_lshrrev_b32 v10, 1, v4
    v_lshl_add_u32 v11, v11, 1, v10
    v_mul_u32_u24 v11, 55296, v11
    v_lshl_add_u32 v11, v3, 4, v11
    s_waitcnt vmcnt(7)
    v_lshlrev_b32 v220, 16, v212
    v_and_b32 v221, 0xffff0000, v212
    v_lshlrev_b32 v222, 16, v213
    v_and_b32 v223, 0xffff0000, v213
    v_lshlrev_b32 v224, 16, v214
    v_and_b32 v225, 0xffff0000, v214
    v_lshlrev_b32 v226, 16, v215
    v_and_b32 v227, 0xffff0000, v215
    v_lshlrev_b32 v228, 16, v216
    v_and_b32 v229, 0xffff0000, v216
    v_add_f32 v230, v220, v221
    v_add_f32 v230, v230, v222
    v_add_f32 v230, v230, v223
    v_add_f32 v230, v230, v224
    v_add_f32 v230, v230, v225
    v_add_f32 v230, v230, v226
    v_add_f32 v230, v230, v227
    v_add_f32 v230, v230, v228
    v_add_f32 v230, v230, v229
    s_nop 1
    v_add_f32_dpp v230, v230, v230 quad_perm:[1,0,3,2] row_mask:0xf bank_mask:0xf
    s_nop 1
    v_add_f32_dpp v230, v230, v230 quad_perm:[2,3,0,1] row_mask:0xf bank_mask:0xf
    s_nop 1
    v_add_f32_dpp v230, v230, v230 row_half_mirror row_mask:0xf bank_mask:0xf
    s_nop 1
    v_add_f32_dpp v230, v230, v230 row_mirror row_mask:0xf bank_mask:0xf
    s_nop 1
    v_add_f32_dpp v230, v230, v230 row_bcast:15 row_mask:0xa bank_mask:0xf
    s_nop 1
    v_add_f32_dpp v230, v230, v230 row_bcast:31 row_mask:0xc bank_mask:0xf
    s_nop 0
    v_readlane_b32 s60, v230, 63
    v_mov_b32 v231, 0x3acccccd
    s_nop 0
    v_mul_f32 v231, s60, v231
    v_sub_f32 v220, v220, v231
    v_sub_f32 v221, v221, v231
    v_sub_f32 v222, v222, v231
    v_sub_f32 v223, v223, v231
    v_sub_f32 v224, v224, v231
    v_sub_f32 v225, v225, v231
    v_sub_f32 v226, v226, v231
    v_sub_f32 v227, v227, v231
    v_sub_f32 v228, v228, v231
    v_sub_f32 v229, v229, v231
    v_mul_f32 v230, v220, v220
    v_fmac_f32 v230, v221, v221
    v_fmac_f32 v230, v222, v222
    v_fmac_f32 v230, v223, v223
    v_fmac_f32 v230, v224, v224
    v_fmac_f32 v230, v225, v225
    v_fmac_f32 v230, v226, v226
    v_fmac_f32 v230, v227, v227
    v_fmac_f32 v230, v228, v228
    v_fmac_f32 v230, v229, v229
    s_nop 1
    v_add_f32_dpp v230, v230, v230 quad_perm:[1,0,3,2] row_mask:0xf bank_mask:0xf
    s_nop 1
    v_add_f32_dpp v230, v230, v230 quad_perm:[2,3,0,1] row_mask:0xf bank_mask:0xf
    s_nop 1
    v_add_f32_dpp v230, v230, v230 row_half_mirror row_mask:0xf bank_mask:0xf
    s_nop 1
    v_add_f32_dpp v230, v230, v230 row_mirror row_mask:0xf bank_mask:0xf
    s_nop 1
    v_add_f32_dpp v230, v230, v230 row_bcast:15 row_mask:0xa bank_mask:0xf
    s_nop 1
    v_add_f32_dpp v230, v230, v230 row_bcast:31 row_mask:0xc bank_mask:0xf
    s_nop 0
    v_readlane_b32 s60, v230, 63
    v_mov_b32 v232, 0x3acccccd
    s_nop 0
    v_mul_f32 v232, s60, v232
    v_cvt_pk_bf16_f32 v231, v231, v231
    v_and_b32 v231, 0xffff0000, v231
    v_cvt_pk_bf16_f32 v232, v232, v232
    v_and_b32 v232, 0xffff0000, v232
    v_add_f32 v232, 0x3727c5ac, v232
    v_cvt_pk_bf16_f32 v232, v232, v232
    v_and_b32 v232, 0xffff0000, v232
    v_sqrt_f32 v232, v232
    s_nop 0
    v_cvt_pk_bf16_f32 v232, v232, v232
    v_and_b32 v232, 0xffff0000, v232
    v_rcp_f32 v232, v232
    s_lshl_b32 s60, s33, 1
    s_add_u32 s60, s60, s34
    s_lshl_b32 s60, s60, 2
    s_add_u32 s60, s60, 159744
    v_mov_b32 v233, s60
    s_mov_b64 exec, 1
    ds_write2_b32 v233, v231, v232 offset0:0 offset1:8
    s_mov_b64 exec, -1
    v_add_u32 v220, 159744, v6
    v_and_b32 v221, 28, v6
    v_bfe_u32 v222, v1, 3, 1
    v_lshl_add_u32 v221, v222, 13, v221
    s_lshl_b32 s63, s53, 2
    v_add_u32 v221, s63, v221
    v_lshrrev_b32 v222, 3, v1
    v_lshlrev_b32 v222, 15, v222
    v_and_b32 v223, 7, v1
    v_lshl_add_u32 v222, v223, 4, v222
    s_lshl_b32 s63, s53, 4
    s_add_u32 s63, s63, 65536
    v_add_u32 v222, s63, v222
    v_cmp_gt_u32 vcc, 16, v1
    s_nop 1
    v_cndmask_b32 v221, v222, v221, vcc
    s_cmp_eq_u32 s32, 0
    s_cselect_b32 s63, 0, 30408704
    v_mov_b32 v222, 0
    s_add_u32 s46, s3, 1
    s_sub_u32 s47, s46, 10
    s_min_u32 s46, s46, s47
    s_mul_i32 s47, s46, 221184
    s_lshl_b32 s46, s46, 7
    s_add_u32 m0, s40, 53248
    s_nop 0
    buffer_load_dwordx4 v192, s[4:7], s46 offen lds
    s_add_u32 m0, s40, 54272
    s_nop 0
    buffer_load_dwordx4 v193, s[4:7], s46 offen lds
    s_add_u32 m0, s40, 55296
    s_nop 0
    buffer_load_dwordx4 v194, s[4:7], s46 offen lds
    s_add_u32 m0, s40, 56320
    s_nop 0
    buffer_load_dwordx4 v195, s[4:7], s46 offen lds
    s_add_u32 m0, s41, 53248
    s_nop 0
    buffer_load_dwordx4 v196, s[16:19], s47 offen lds
    s_add_u32 m0, s42, 53248
    s_nop 0
    buffer_load_dwordx4 v197, s[20:23], s47 offen lds
    s_mov_b32 m0, s52
    s_nop 0
    buffer_load_dwordx4 v198, s[24:27], s47 offen lds
    s_waitcnt vmcnt(7) lgkmcnt(0)
    s_barrier
    ds_read_b64_tr_b16 v[132:133], v202 offset:0
    ds_read_b64_tr_b16 v[134:135], v202 offset:2560
    ds_read_b128 v[116:119], v200 offset:0
    ds_read_b128 v[120:123], v200 offset:2048
    ds_read_b128 v[124:127], v200 offset:4096
    ds_read_b128 v[128:131], v200 offset:6144
    ds_read_b64_tr_b16 v[136:137], v202 offset:32
    ds_read_b64_tr_b16 v[138:139], v202 offset:2592
    ds_read_b64_tr_b16 v[140:141], v202 offset:10240
    ds_read_b64_tr_b16 v[142:143], v202 offset:12800
    ds_read_b64_tr_b16 v[144:145], v202 offset:10272
    ds_read_b64_tr_b16 v[146:147], v202 offset:12832
    ds_read_b64_tr_b16 v[148:149], v203 offset:0
    ds_read_b64_tr_b16 v[150:151], v203 offset:2560
    s_mov_b64 exec, 0xffff
    ds_read_b32 v222, v220
    s_mov_b64 exec, -1
    v_mov_b32 v96, 0
    v_mov_b32 v100, 0
    v_mov_b32 v104, 0
    v_mov_b32 v108, 0
    v_mov_b32 v112, 0
    s_waitcnt lgkmcnt(0)
    v_mfma_f32_16x16x32_bf16 v[16:19], v[132:135], v[116:119], 0
    ds_read_b64_tr_b16 v[168:169], v202 offset:5120
    s_add_u32 s44, s3, 2
    s_sub_u32 s45, s44, 10
    s_min_u32 s44, s44, s45
    s_mul_i32 s45, s44, 221184
    s_lshl_b32 s44, s44, 7
    s_add_u32 m0, s40, 106496
    v_mfma_f32_16x16x32_bf16 v[20:23], v[132:135], v[120:123], 0
    ds_read_b64_tr_b16 v[170:171], v202 offset:7680
    buffer_load_dwordx4 v192, s[4:7], s44 offen lds
    v_mfma_f32_16x16x32_bf16 v[24:27], v[132:135], v[124:127], 0
    ds_read_b128 v[152:155], v201 offset:0
    v_mfma_f32_16x16x32_bf16 v[28:31], v[132:135], v[128:131], 0
    ds_read_b128 v[156:159], v201 offset:2048
    s_add_u32 m0, s40, 107520
    v_mfma_f32_16x16x32_bf16 v[32:35], v[136:139], v[116:119], 0
    ds_read_b128 v[160:163], v201 offset:4096
    buffer_load_dwordx4 v193, s[4:7], s44 offen lds
    v_mfma_f32_16x16x32_bf16 v[36:39], v[136:139], v[120:123], 0
    ds_read_b128 v[164:167], v201 offset:6144
    v_mfma_f32_16x16x32_bf16 v[40:43], v[136:139], v[124:127], 0
    ds_read_b64_tr_b16 v[172:173], v202 offset:5152
    s_add_u32 m0, s40, 108544
    v_mfma_f32_16x16x32_bf16 v[44:47], v[136:139], v[128:131], 0
    ds_read_b64_tr_b16 v[174:175], v202 offset:7712
    buffer_load_dwordx4 v194, s[4:7], s44 offen lds
    v_mfma_f32_16x16x32_bf16 v[48:51], v[140:143], v[116:119], 0
    ds_read_b64_tr_b16 v[176:177], v202 offset:15360
    v_mfma_f32_16x16x32_bf16 v[52:55], v[140:143], v[120:123], 0
    ds_read_b64_tr_b16 v[178:179], v202 offset:17920
    s_add_u32 m0, s40, 109568
    v_mfma_f32_16x16x32_bf16 v[56:59], v[140:143], v[124:127], 0
    ds_read_b64_tr_b16 v[180:181], v202 offset:15392
    buffer_load_dwordx4 v195, s[4:7], s44 offen lds
    v_mfma_f32_16x16x32_bf16 v[60:63], v[140:143], v[128:131], 0
    ds_read_b64_tr_b16 v[182:183], v202 offset:17952
    v_mfma_f32_16x16x32_bf16 v[64:67], v[144:147], v[116:119], 0
    ds_read_b64_tr_b16 v[184:185], v203 offset:5120
    s_add_u32 m0, s41, 106496
    v_mfma_f32_16x16x32_bf16 v[68:71], v[144:147], v[120:123], 0
    ds_read_b64_tr_b16 v[186:187], v203 offset:7680
    buffer_load_dwordx4 v196, s[16:19], s45 offen lds
    v_mfma_f32_16x16x32_bf16 v[72:75], v[144:147], v[124:127], 0
    v_mfma_f32_16x16x32_bf16 v[76:79], v[144:147], v[128:131], 0
    s_add_u32 m0, s42, 106496
    v_mfma_f32_16x16x32_bf16 v[80:83], v[148:151], v[116:119], 0
    buffer_load_dwordx4 v197, s[20:23], s45 offen lds
    v_mfma_f32_16x16x32_bf16 v[84:87], v[148:151], v[120:123], 0
    s_mov_b32 m0, s37
    v_mfma_f32_16x16x32_bf16 v[88:91], v[148:151], v[124:127], 0
    buffer_load_dwordx4 v198, s[24:27], s45 offen lds
    v_mfma_f32_16x16x32_bf16 v[92:95], v[148:151], v[128:131], 0
    s_cmp_lg_u32 s96, 0
    s_cbranch_scc1 Lskip_5
    v_mfma_f32_16x16x32_bf16 v[96:99], v[188:191], v[132:135], 0
    v_mfma_f32_16x16x32_bf16 v[100:103], v[188:191], v[136:139], 0
    v_mfma_f32_16x16x32_bf16 v[104:107], v[188:191], v[140:143], 0
    v_mfma_f32_16x16x32_bf16 v[108:111], v[188:191], v[144:147], 0
    v_mfma_f32_16x16x32_bf16 v[112:115], v[188:191], v[148:151], 0
Lskip_5:
    s_waitcnt vmcnt(7) lgkmcnt(0)
    s_barrier
    s_mov_b32 exec_hi, 0xff
    buffer_store_dword v222, v221, s[8:11], s63 offen sc1
    s_mov_b64 exec, -1
    v_mfma_f32_16x16x32_bf16 v[16:19], v[168:171], v[152:155], v[16:19]
    ds_read_b64_tr_b16 v[132:133], v206 offset:0
    v_mfma_f32_16x16x32_bf16 v[20:23], v[168:171], v[156:159], v[20:23]
    ds_read_b64_tr_b16 v[134:135], v206 offset:2560
    v_mfma_f32_16x16x32_bf16 v[24:27], v[168:171], v[160:163], v[24:27]
    ds_read_b128 v[116:119], v204 offset:0
    s_add_u32 s46, s3, 3
    s_sub_u32 s47, s46, 10
    s_min_u32 s46, s46, s47
    s_mul_i32 s47, s46, 221184
    s_lshl_b32 s46, s46, 7
    s_add_u32 m0, s40, 0
    v_mfma_f32_16x16x32_bf16 v[28:31], v[168:171], v[164:167], v[28:31]
    ds_read_b128 v[120:123], v204 offset:2048
    buffer_load_dwordx4 v192, s[4:7], s46 offen lds
    v_mfma_f32_16x16x32_bf16 v[32:35], v[172:175], v[152:155], v[32:35]
    ds_read_b128 v[124:127], v204 offset:4096
    v_mfma_f32_16x16x32_bf16 v[36:39], v[172:175], v[156:159], v[36:39]
    ds_read_b128 v[128:131], v204 offset:6144
    v_mfma_f32_16x16x32_bf16 v[40:43], v[172:175], v[160:163], v[40:43]
    ds_read_b64_tr_b16 v[136:137], v206 offset:32
    v_mfma_f32_16x16x32_bf16 v[44:47], v[172:175], v[164:167], v[44:47]
    ds_read_b64_tr_b16 v[138:139], v206 offset:2592
    s_add_u32 m0, s40, 1024
    v_mfma_f32_16x16x32_bf16 v[48:51], v[176:179], v[152:155], v[48:51]
    ds_read_b64_tr_b16 v[140:141], v206 offset:10240
    buffer_load_dwordx4 v193, s[4:7], s46 offen lds
    v_mfma_f32_16x16x32_bf16 v[52:55], v[176:179], v[156:159], v[52:55]
    ds_read_b64_tr_b16 v[142:143], v206 offset:12800
    v_mfma_f32_16x16x32_bf16 v[56:59], v[176:179], v[160:163], v[56:59]
    ds_read_b64_tr_b16 v[144:145], v206 offset:10272
    v_mfma_f32_16x16x32_bf16 v[60:63], v[176:179], v[164:167], v[60:63]
    ds_read_b64_tr_b16 v[146:147], v206 offset:12832
    v_mfma_f32_16x16x32_bf16 v[64:67], v[180:183], v[152:155], v[64:67]
    ds_read_b64_tr_b16 v[148:149], v207 offset:0
    s_add_u32 m0, s40, 2048
    v_mfma_f32_16x16x32_bf16 v[68:71], v[180:183], v[156:159], v[68:71]
    ds_read_b64_tr_b16 v[150:151], v207 offset:2560
    buffer_load_dwordx4 v194, s[4:7], s46 offen lds
    v_mfma_f32_16x16x32_bf16 v[72:75], v[180:183], v[160:163], v[72:75]
    v_mfma_f32_16x16x32_bf16 v[76:79], v[180:183], v[164:167], v[76:79]
    v_mfma_f32_16x16x32_bf16 v[80:83], v[184:187], v[152:155], v[80:83]
    v_mfma_f32_16x16x32_bf16 v[84:87], v[184:187], v[156:159], v[84:87]
    s_add_u32 m0, s40, 3072
    v_mfma_f32_16x16x32_bf16 v[88:91], v[184:187], v[160:163], v[88:91]
    buffer_load_dwordx4 v195, s[4:7], s46 offen lds
    v_mfma_f32_16x16x32_bf16 v[92:95], v[184:187], v[164:167], v[92:95]
    s_cmp_lg_u32 s96, 0
    s_cbranch_scc1 Lskip_6
    v_mfma_f32_16x16x32_bf16 v[96:99], v[188:191], v[168:171], v[96:99]
    v_mfma_f32_16x16x32_bf16 v[100:103], v[188:191], v[172:175], v[100:103]
    v_mfma_f32_16x16x32_bf16 v[104:107], v[188:191], v[176:179], v[104:107]
    v_mfma_f32_16x16x32_bf16 v[108:111], v[188:191], v[180:183], v[108:111]
    v_mfma_f32_16x16x32_bf16 v[112:115], v[188:191], v[184:187], v[112:115]
Lskip_6:
    s_waitcnt lgkmcnt(0)
    v_mfma_f32_16x16x32_bf16 v[16:19], v[132:135], v[116:119], v[16:19]
    ds_read_b64_tr_b16 v[168:169], v206 offset:5120
    v_mfma_f32_16x16x32_bf16 v[20:23], v[132:135], v[120:123], v[20:23]
    ds_read_b64_tr_b16 v[170:171], v206 offset:7680
    v_mfma_f32_16x16x32_bf16 v[24:27], v[132:135], v[124:127], v[24:27]
    ds_read_b128 v[152:155], v205 offset:0
    v_mfma_f32_16x16x32_bf16 v[28:31], v[132:135], v[128:131], v[28:31]
    ds_read_b128 v[156:159], v205 offset:2048
    s_add_u32 m0, s41, 0
    v_mfma_f32_16x16x32_bf16 v[32:35], v[136:139], v[116:119], v[32:35]
    ds_read_b128 v[160:163], v205 offset:4096
    buffer_load_dwordx4 v196, s[16:19], s47 offen lds
    v_mfma_f32_16x16x32_bf16 v[36:39], v[136:139], v[120:123], v[36:39]
    ds_read_b128 v[164:167], v205 offset:6144
    v_mfma_f32_16x16x32_bf16 v[40:43], v[136:139], v[124:127], v[40:43]
    ds_read_b64_tr_b16 v[172:173], v206 offset:5152
    v_mfma_f32_16x16x32_bf16 v[44:47], v[136:139], v[128:131], v[44:47]
    ds_read_b64_tr_b16 v[174:175], v206 offset:7712
    v_mfma_f32_16x16x32_bf16 v[48:51], v[140:143], v[116:119], v[48:51]
    ds_read_b64_tr_b16 v[176:177], v206 offset:15360
    v_mfma_f32_16x16x32_bf16 v[52:55], v[140:143], v[120:123], v[52:55]
    ds_read_b64_tr_b16 v[178:179], v206 offset:17920
    s_add_u32 m0, s42, 0
    v_mfma_f32_16x16x32_bf16 v[56:59], v[140:143], v[124:127], v[56:59]
    ds_read_b64_tr_b16 v[180:181], v206 offset:15392
    buffer_load_dwordx4 v197, s[20:23], s47 offen lds
    v_mfma_f32_16x16x32_bf16 v[60:63], v[140:143], v[128:131], v[60:63]
    ds_read_b64_tr_b16 v[182:183], v206 offset:17952
    v_mfma_f32_16x16x32_bf16 v[64:67], v[144:147], v[116:119], v[64:67]
    ds_read_b64_tr_b16 v[184:185], v207 offset:5120
    v_mfma_f32_16x16x32_bf16 v[68:71], v[144:147], v[120:123], v[68:71]
    ds_read_b64_tr_b16 v[186:187], v207 offset:7680
    v_mfma_f32_16x16x32_bf16 v[72:75], v[144:147], v[124:127], v[72:75]
    v_mfma_f32_16x16x32_bf16 v[76:79], v[144:147], v[128:131], v[76:79]
    v_mfma_f32_16x16x32_bf16 v[80:83], v[148:151], v[116:119], v[80:83]
    s_mov_b32 m0, s43
    v_mfma_f32_16x16x32_bf16 v[84:87], v[148:151], v[120:123], v[84:87]
    buffer_load_dwordx4 v198, s[24:27], s47 offen lds
    v_mfma_f32_16x16x32_bf16 v[88:91], v[148:151], v[124:127], v[88:91]
    v_mfma_f32_16x16x32_bf16 v[92:95], v[148:151], v[128:131], v[92:95]
    s_cmp_lg_u32 s96, 1
    s_cbranch_scc1 Lskip_7
    v_mfma_f32_16x16x32_bf16 v[96:99], v[188:191], v[132:135], 0
    v_mfma_f32_16x16x32_bf16 v[100:103], v[188:191], v[136:139], 0
    v_mfma_f32_16x16x32_bf16 v[104:107], v[188:191], v[140:143], 0
    v_mfma_f32_16x16x32_bf16 v[108:111], v[188:191], v[144:147], 0
    v_mfma_f32_16x16x32_bf16 v[112:115], v[188:191], v[148:151], 0
Lskip_7:
    s_waitcnt vmcnt(7)
    s_waitcnt lgkmcnt(0)
    s_barrier
    s_lshr_b32 s63, s53, 1
    s_and_b32 s63, s63, 0xfc
    s_cmp_eq_u32 s32, 0
    s_cselect_b32 s63, s63, 0x1000
    v_mov_b32 v2, 1
    s_mov_b64 exec, 1
    buffer_atomic_add v2, off, s[12:15], s63 sc1
    s_mov_b64 exec, -1
    buffer_load_dwordx4 v[244:247], v234, s[28:31], s54 offen nt
    buffer_load_dwordx4 v[248:251], v235, s[56:59], s55 offen nt
    s_and_b32 s60, s38, 3
    s_lshl_b32 s60, s60, 2
    s_and_b32 s61, s39, 3
    s_add_u32 s60, s60, s61
    s_lshl_b32 s60, s60, 3
    s_lshr_b32 s61, s39, 2
    s_add_u32 s60, s60, s61
    s_lshl_b32 s60, s60, 7
    s_add_u32 s60, s60, 229376
    s_cmp_ge_u32 s38, 4
    s_cselect_b32 s60, 30408704, s60
    buffer_load_dword v217, off, s[8:11], s60 sc1
    v_mfma_f32_16x16x32_bf16 v[16:19], v[168:171], v[152:155], v[16:19]
    ds_read_b64_tr_b16 v[132:133], v210 offset:0
    v_mfma_f32_16x16x32_bf16 v[20:23], v[168:171], v[156:159], v[20:23]
    ds_read_b64_tr_b16 v[134:135], v210 offset:2560
    v_mfma_f32_16x16x32_bf16 v[24:27], v[168:171], v[160:163], v[24:27]
    ds_read_b128 v[116:119], v208 offset:0
    s_add_u32 s44, s3, 4
    s_sub_u32 s45, s44, 10
    s_min_u32 s44, s44, s45
    s_mul_i32 s45, s44, 221184
    s_lshl_b32 s44, s44, 7
    s_add_u32 m0, s40, 53248
    v_mfma_f32_16x16x32_bf16 v[28:31], v[168:171], v[164:167], v[28:31]
    ds_read_b128 v[120:123], v208 offset:2048
    buffer_load_dwordx4 v192, s[4:7], s44 offen lds
    v_mfma_f32_16x16x32_bf16 v[32:35], v[172:175], v[152:155], v[32:35]
    ds_read_b128 v[124:127], v208 offset:4096
    v_mfma_f32_16x16x32_bf16 v[36:39], v[172:175], v[156:159], v[36:39]
    ds_read_b128 v[128:131], v208 offset:6144
    v_mfma_f32_16x16x32_bf16 v[40:43], v[172:175], v[160:163], v[40:43]
    ds_read_b64_tr_b16 v[136:137], v210 offset:32
    v_mfma_f32_16x16x32_bf16 v[44:47], v[172:175], v[164:167], v[44:47]
    ds_read_b64_tr_b16 v[138:139], v210 offset:2592
    s_add_u32 m0, s40, 54272
    v_mfma_f32_16x16x32_bf16 v[48:51], v[176:179], v[152:155], v[48:51]
    ds_read_b64_tr_b16 v[140:141], v210 offset:10240
    buffer_load_dwordx4 v193, s[4:7], s44 offen lds
    v_mfma_f32_16x16x32_bf16 v[52:55], v[176:179], v[156:159], v[52:55]
    ds_read_b64_tr_b16 v[142:143], v210 offset:12800
    v_mfma_f32_16x16x32_bf16 v[56:59], v[176:179], v[160:163], v[56:59]
    ds_read_b64_tr_b16 v[144:145], v210 offset:10272
    v_mfma_f32_16x16x32_bf16 v[60:63], v[176:179], v[164:167], v[60:63]
    ds_read_b64_tr_b16 v[146:147], v210 offset:12832
    v_mfma_f32_16x16x32_bf16 v[64:67], v[180:183], v[152:155], v[64:67]
    ds_read_b64_tr_b16 v[148:149], v211 offset:0
    s_add_u32 m0, s40, 55296
    v_mfma_f32_16x16x32_bf16 v[68:71], v[180:183], v[156:159], v[68:71]
    ds_read_b64_tr_b16 v[150:151], v211 offset:2560
    buffer_load_dwordx4 v194, s[4:7], s44 offen lds
    v_mfma_f32_16x16x32_bf16 v[72:75], v[180:183], v[160:163], v[72:75]
    v_mfma_f32_16x16x32_bf16 v[76:79], v[180:183], v[164:167], v[76:79]
    v_mfma_f32_16x16x32_bf16 v[80:83], v[184:187], v[152:155], v[80:83]
    v_mfma_f32_16x16x32_bf16 v[84:87], v[184:187], v[156:159], v[84:87]
    s_add_u32 m0, s40, 56320
    v_mfma_f32_16x16x32_bf16 v[88:91], v[184:187], v[160:163], v[88:91]
    buffer_load_dwordx4 v195, s[4:7], s44 offen lds
    v_mfma_f32_16x16x32_bf16 v[92:95], v[184:187], v[164:167], v[92:95]
    s_cmp_lg_u32 s96, 1
    s_cbranch_scc1 Lskip_8
    v_mfma_f32_16x16x32_bf16 v[96:99], v[188:191], v[168:171], v[96:99]
    v_mfma_f32_16x16x32_bf16 v[100:103], v[188:191], v[172:175], v[100:103]
    v_mfma_f32_16x16x32_bf16 v[104:107], v[188:191], v[176:179], v[104:107]
    v_mfma_f32_16x16x32_bf16 v[108:111], v[188:191], v[180:183], v[108:111]
    v_mfma_f32_16x16x32_bf16 v[112:115], v[188:191], v[184:187], v[112:115]
Lskip_8:
    s_waitcnt lgkmcnt(0)
    v_mfma_f32_16x16x32_bf16 v[16:19], v[132:135], v[116:119], v[16:19]
    ds_read_b64_tr_b16 v[168:169], v210 offset:5120
    s_nop 0
    v_mov_b32 v232, v96
    v_cmp_eq_u32 vcc, 1, v4
    s_nop 1
    v_cndmask_b32 v232, v232, v100, vcc
    v_mfma_f32_16x16x32_bf16 v[20:23], v[132:135], v[120:123], v[20:23]
    ds_read_b64_tr_b16 v[170:171], v210 offset:7680
    v_cmp_eq_u32 vcc, 2, v4
    s_nop 1
    v_cndmask_b32 v232, v232, v104, vcc
    v_mfma_f32_16x16x32_bf16 v[24:27], v[132:135], v[124:127], v[24:27]
    ds_read_b128 v[152:155], v209 offset:0
    v_cmp_eq_u32 vcc, 3, v4
    s_nop 1
    v_cndmask_b32 v232, v232, v108, vcc
    v_mfma_f32_16x16x32_bf16 v[28:31], v[132:135], v[128:131], v[28:31]
    ds_read_b128 v[156:159], v209 offset:2048
    v_cvt_pk_bf16_f32 v14, v232, v232
    v_lshlrev_b32 v14, 16, v14
    v_sub_f32 v14, v232, v14
    s_add_u32 m0, s41, 53248
    v_mfma_f32_16x16x32_bf16 v[32:35], v[136:139], v[116:119], v[32:35]
    ds_read_b128 v[160:163], v209 offset:4096
    buffer_load_dwordx4 v196, s[16:19], s45 offen lds
    v_mfma_f32_16x16x32_bf16 v[36:39], v[136:139], v[120:123], v[36:39]
    ds_read_b128 v[164:167], v209 offset:6144
    v_cvt_pk_bf16_f32 v232, v232, v14
    v_cvt_pk_bf16_f32 v14, v112, v112
    v_lshlrev_b32 v14, 16, v14
    v_mfma_f32_16x16x32_bf16 v[40:43], v[136:139], v[124:127], v[40:43]
    ds_read_b64_tr_b16 v[172:173], v210 offset:5152
    v_sub_f32 v14, v112, v14
    v_cvt_pk_bf16_f32 v233, v112, v14
    v_lshlrev_b32 v15, 4, v3
    v_mfma_f32_16x16x32_bf16 v[44:47], v[136:139], v[128:131], v[44:47]
    ds_read_b64_tr_b16 v[174:175], v210 offset:7712
    v_lshl_add_u32 v15, v4, 10, v15
    s_bfe_u32 s60, s53, 0x50003
    s_lshl_b32 s60, s60, 1
    v_mfma_f32_16x16x32_bf16 v[48:51], v[140:143], v[116:119], v[48:51]
    ds_read_b64_tr_b16 v[176:177], v210 offset:15360
    s_add_u32 s60, s60, s34
    s_mul_i32 s60, s60, 5120
    s_add_u32 s60, s60, 262144
    v_mfma_f32_16x16x32_bf16 v[52:55], v[140:143], v[120:123], v[52:55]
    ds_read_b64_tr_b16 v[178:179], v210 offset:17920
    s_add_u32 s61, s3, 1
    s_cmp_eq_u32 s61, 10
    s_cselect_b32 s61, 0, s61
    s_and_b32 s62, s35, 5
    s_cmp_eq_u32 s62, 4
    s_cselect_b32 s61, s61, 16
    s_cmp_eq_u32 s96, 0
    s_cselect_b32 s61, s3, s61
    s_add_u32 s62, s35, 10
    s_cmp_eq_u32 s96, 2
    s_cselect_b32 s61, s62, s61
    s_cmp_eq_u32 s96, 3
    s_cselect_b32 s61, 16, s61
    s_cmp_ge_u32 s61, 16
    s_cselect_b32 s60, 30408704, s60
    s_lshr_b32 s62, s61, 2
    s_lshl_b32 s62, s62, 8
    s_add_u32 s60, s60, s62
    s_and_b32 s62, s61, 3
    s_lshl_b32 s62, s62, 2
    s_add_u32 s60, s60, s62
    buffer_store_dword v232, v15, s[8:11], s60 offen sc1
    s_add_u32 s60, s60, 4096
    s_mov_b64 exec, 0xffff
    buffer_store_dword v233, v15, s[8:11], s60 offen sc1
    s_mov_b64 exec, -1
    s_add_u32 m0, s42, 53248
    v_mfma_f32_16x16x32_bf16 v[56:59], v[140:143], v[124:127], v[56:59]
    ds_read_b64_tr_b16 v[180:181], v210 offset:15392
    buffer_load_dwordx4 v197, s[20:23], s45 offen lds
    v_mfma_f32_16x16x32_bf16 v[60:63], v[140:143], v[128:131], v[60:63]
    ds_read_b64_tr_b16 v[182:183], v210 offset:17952
    v_mfma_f32_16x16x32_bf16 v[64:67], v[144:147], v[116:119], v[64:67]
    ds_read_b64_tr_b16 v[184:185], v211 offset:5120
    v_mfma_f32_16x16x32_bf16 v[68:71], v[144:147], v[120:123], v[68:71]
    ds_read_b64_tr_b16 v[186:187], v211 offset:7680
    v_mfma_f32_16x16x32_bf16 v[72:75], v[144:147], v[124:127], v[72:75]
    v_mfma_f32_16x16x32_bf16 v[76:79], v[144:147], v[128:131], v[76:79]
    v_mfma_f32_16x16x32_bf16 v[80:83], v[148:151], v[116:119], v[80:83]
    s_mov_b32 m0, s52
    v_mfma_f32_16x16x32_bf16 v[84:87], v[148:151], v[120:123], v[84:87]
    buffer_load_dwordx4 v198, s[24:27], s45 offen lds
    v_mfma_f32_16x16x32_bf16 v[88:91], v[148:151], v[124:127], v[88:91]
    v_mfma_f32_16x16x32_bf16 v[92:95], v[148:151], v[128:131], v[92:95]
    s_waitcnt vmcnt(13) lgkmcnt(0)
    s_barrier
    v_mfma_f32_16x16x32_bf16 v[16:19], v[168:171], v[152:155], v[16:19]
    ds_read_b64_tr_b16 v[132:133], v202 offset:0
    v_mfma_f32_16x16x32_bf16 v[20:23], v[168:171], v[156:159], v[20:23]
    ds_read_b64_tr_b16 v[134:135], v202 offset:2560
    v_mfma_f32_16x16x32_bf16 v[24:27], v[168:171], v[160:163], v[24:27]
    ds_read_b128 v[116:119], v200 offset:0
    s_add_u32 s46, s3, 5
    s_sub_u32 s47, s46, 10
    s_min_u32 s46, s46, s47
    s_mul_i32 s47, s46, 221184
    s_lshl_b32 s46, s46, 7
    s_add_u32 m0, s40, 106496
    v_mfma_f32_16x16x32_bf16 v[28:31], v[168:171], v[164:167], v[28:31]
    ds_read_b128 v[120:123], v200 offset:2048
    buffer_load_dwordx4 v192, s[4:7], s46 offen lds
    v_mfma_f32_16x16x32_bf16 v[32:35], v[172:175], v[152:155], v[32:35]
    ds_read_b128 v[124:127], v200 offset:4096
    v_mfma_f32_16x16x32_bf16 v[36:39], v[172:175], v[156:159], v[36:39]
    ds_read_b128 v[128:131], v200 offset:6144
    v_mfma_f32_16x16x32_bf16 v[40:43], v[172:175], v[160:163], v[40:43]
    ds_read_b64_tr_b16 v[136:137], v202 offset:32
    v_mfma_f32_16x16x32_bf16 v[44:47], v[172:175], v[164:167], v[44:47]
    ds_read_b64_tr_b16 v[138:139], v202 offset:2592
    s_add_u32 m0, s40, 107520
    v_mfma_f32_16x16x32_bf16 v[48:51], v[176:179], v[152:155], v[48:51]
    ds_read_b64_tr_b16 v[140:141], v202 offset:10240
    buffer_load_dwordx4 v193, s[4:7], s46 offen lds
    v_mfma_f32_16x16x32_bf16 v[52:55], v[176:179], v[156:159], v[52:55]
    ds_read_b64_tr_b16 v[142:143], v202 offset:12800
    v_mfma_f32_16x16x32_bf16 v[56:59], v[176:179], v[160:163], v[56:59]
    ds_read_b64_tr_b16 v[144:145], v202 offset:10272
    v_mfma_f32_16x16x32_bf16 v[60:63], v[176:179], v[164:167], v[60:63]
    ds_read_b64_tr_b16 v[146:147], v202 offset:12832
    v_mfma_f32_16x16x32_bf16 v[64:67], v[180:183], v[152:155], v[64:67]
    ds_read_b64_tr_b16 v[148:149], v203 offset:0
    s_add_u32 m0, s40, 108544
    v_mfma_f32_16x16x32_bf16 v[68:71], v[180:183], v[156:159], v[68:71]
    ds_read_b64_tr_b16 v[150:151], v203 offset:2560
    buffer_load_dwordx4 v194, s[4:7], s46 offen lds
    v_mfma_f32_16x16x32_bf16 v[72:75], v[180:183], v[160:163], v[72:75]
    v_mfma_f32_16x16x32_bf16 v[76:79], v[180:183], v[164:167], v[76:79]
    v_mfma_f32_16x16x32_bf16 v[80:83], v[184:187], v[152:155], v[80:83]
    v_mfma_f32_16x16x32_bf16 v[84:87], v[184:187], v[156:159], v[84:87]
    s_add_u32 m0, s40, 109568
    v_mfma_f32_16x16x32_bf16 v[88:91], v[184:187], v[160:163], v[88:91]
    buffer_load_dwordx4 v195, s[4:7], s46 offen lds
    v_mfma_f32_16x16x32_bf16 v[92:95], v[184:187], v[164:167], v[92:95]
    s_waitcnt lgkmcnt(0)
    v_mfma_f32_16x16x32_bf16 v[16:19], v[132:135], v[116:119], v[16:19]
    ds_read_b64_tr_b16 v[168:169], v202 offset:5120
    v_mfma_f32_16x16x32_bf16 v[20:23], v[132:135], v[120:123], v[20:23]
    ds_read_b64_tr_b16 v[170:171], v202 offset:7680
    v_mfma_f32_16x16x32_bf16 v[24:27], v[132:135], v[124:127], v[24:27]
    ds_read_b128 v[152:155], v201 offset:0
    v_mfma_f32_16x16x32_bf16 v[28:31], v[132:135], v[128:131], v[28:31]
    ds_read_b128 v[156:159], v201 offset:2048
    s_add_u32 m0, s41, 106496
    v_mfma_f32_16x16x32_bf16 v[32:35], v[136:139], v[116:119], v[32:35]
    ds_read_b128 v[160:163], v201 offset:4096
    buffer_load_dwordx4 v196, s[16:19], s47 offen lds
    v_mfma_f32_16x16x32_bf16 v[36:39], v[136:139], v[120:123], v[36:39]
    ds_read_b128 v[164:167], v201 offset:6144
    v_mfma_f32_16x16x32_bf16 v[40:43], v[136:139], v[124:127], v[40:43]
    ds_read_b64_tr_b16 v[172:173], v202 offset:5152
    v_mfma_f32_16x16x32_bf16 v[44:47], v[136:139], v[128:131], v[44:47]
    ds_read_b64_tr_b16 v[174:175], v202 offset:7712
    v_mfma_f32_16x16x32_bf16 v[48:51], v[140:143], v[116:119], v[48:51]
    ds_read_b64_tr_b16 v[176:177], v202 offset:15360
    v_mfma_f32_16x16x32_bf16 v[52:55], v[140:143], v[120:123], v[52:55]
    ds_read_b64_tr_b16 v[178:179], v202 offset:17920
    s_add_u32 m0, s42, 106496
    v_mfma_f32_16x16x32_bf16 v[56:59], v[140:143], v[124:127], v[56:59]
    ds_read_b64_tr_b16 v[180:181], v202 offset:15392
    buffer_load_dwordx4 v197, s[20:23], s47 offen lds
    v_mfma_f32_16x16x32_bf16 v[60:63], v[140:143], v[128:131], v[60:63]
    ds_read_b64_tr_b16 v[182:183], v202 offset:17952
    v_mfma_f32_16x16x32_bf16 v[64:67], v[144:147], v[116:119], v[64:67]
    ds_read_b64_tr_b16 v[184:185], v203 offset:5120
    v_mfma_f32_16x16x32_bf16 v[68:71], v[144:147], v[120:123], v[68:71]
    ds_read_b64_tr_b16 v[186:187], v203 offset:7680
    v_mfma_f32_16x16x32_bf16 v[72:75], v[144:147], v[124:127], v[72:75]
    v_mfma_f32_16x16x32_bf16 v[76:79], v[144:147], v[128:131], v[76:79]
    v_mfma_f32_16x16x32_bf16 v[80:83], v[148:151], v[116:119], v[80:83]
    s_mov_b32 m0, s37
    v_mfma_f32_16x16x32_bf16 v[84:87], v[148:151], v[120:123], v[84:87]
    buffer_load_dwordx4 v198, s[24:27], s47 offen lds
    v_mfma_f32_16x16x32_bf16 v[88:91], v[148:151], v[124:127], v[88:91]
    v_mfma_f32_16x16x32_bf16 v[92:95], v[148:151], v[128:131], v[92:95]
    s_waitcnt vmcnt(7) lgkmcnt(0)
    s_barrier
    s_and_b32 s60, s38, 3
    s_lshl_b32 s60, s60, 2
    s_and_b32 s61, s39, 3
    s_add_u32 s60, s60, s61
    s_lshl_b32 s60, s60, 3
    s_lshr_b32 s61, s39, 2
    s_add_u32 s60, s60, s61
    s_lshl_b32 s60, s60, 7
    s_add_u32 s60, s60, 229376
    s_lshr_b32 s61, s38, 2
    s_or_b32 s61, s61, s32
    s_cmp_eq_u32 s61, 0
    s_cselect_b32 s60, s60, 30408704
    v_add_u32 v217, 1, v217
    s_mov_b64 exec, 1
    buffer_store_dword v217, off, s[8:11], s60 sc1
    s_mov_b64 exec, -1
    v_readfirstlane_b32 s49, v217
    buffer_store_dwordx4 v[244:247], v242, s[8:11], 0 offen sc1
    buffer_store_dwordx4 v[248:251], v243, s[8:11], 0 offen sc1
    v_mfma_f32_16x16x32_bf16 v[16:19], v[168:171], v[152:155], v[16:19]
    ds_read_b64_tr_b16 v[132:133], v206 offset:0
    v_mfma_f32_16x16x32_bf16 v[20:23], v[168:171], v[156:159], v[20:23]
    ds_read_b64_tr_b16 v[134:135], v206 offset:2560
    v_mfma_f32_16x16x32_bf16 v[24:27], v[168:171], v[160:163], v[24:27]
    ds_read_b128 v[116:119], v204 offset:0
    s_add_u32 s44, s3, 6
    s_sub_u32 s45, s44, 10
    s_min_u32 s44, s44, s45
    s_mul_i32 s45, s44, 221184
    s_lshl_b32 s44, s44, 7
    s_add_u32 m0, s40, 0
    v_mfma_f32_16x16x32_bf16 v[28:31], v[168:171], v[164:167], v[28:31]
    ds_read_b128 v[120:123], v204 offset:2048
    buffer_load_dwordx4 v192, s[4:7], s44 offen lds
    v_mfma_f32_16x16x32_bf16 v[32:35], v[172:175], v[152:155], v[32:35]
    ds_read_b128 v[124:127], v204 offset:4096
    v_mfma_f32_16x16x32_bf16 v[36:39], v[172:175], v[156:159], v[36:39]
    ds_read_b128 v[128:131], v204 offset:6144
    v_mfma_f32_16x16x32_bf16 v[40:43], v[172:175], v[160:163], v[40:43]
    ds_read_b64_tr_b16 v[136:137], v206 offset:32
    v_mfma_f32_16x16x32_bf16 v[44:47], v[172:175], v[164:167], v[44:47]
    ds_read_b64_tr_b16 v[138:139], v206 offset:2592
    s_add_u32 m0, s40, 1024
    v_mfma_f32_16x16x32_bf16 v[48:51], v[176:179], v[152:155], v[48:51]
    ds_read_b64_tr_b16 v[140:141], v206 offset:10240
    buffer_load_dwordx4 v193, s[4:7], s44 offen lds
    v_mfma_f32_16x16x32_bf16 v[52:55], v[176:179], v[156:159], v[52:55]
    ds_read_b64_tr_b16 v[142:143], v206 offset:12800
    v_mfma_f32_16x16x32_bf16 v[56:59], v[176:179], v[160:163], v[56:59]
    ds_read_b64_tr_b16 v[144:145], v206 offset:10272
    v_mfma_f32_16x16x32_bf16 v[60:63], v[176:179], v[164:167], v[60:63]
    ds_read_b64_tr_b16 v[146:147], v206 offset:12832
    v_mfma_f32_16x16x32_bf16 v[64:67], v[180:183], v[152:155], v[64:67]
    ds_read_b64_tr_b16 v[148:149], v207 offset:0
    s_add_u32 m0, s40, 2048
    v_mfma_f32_16x16x32_bf16 v[68:71], v[180:183], v[156:159], v[68:71]
    ds_read_b64_tr_b16 v[150:151], v207 offset:2560
    buffer_load_dwordx4 v194, s[4:7], s44 offen lds
    v_mfma_f32_16x16x32_bf16 v[72:75], v[180:183], v[160:163], v[72:75]
    v_mfma_f32_16x16x32_bf16 v[76:79], v[180:183], v[164:167], v[76:79]
    v_mfma_f32_16x16x32_bf16 v[80:83], v[184:187], v[152:155], v[80:83]
    v_mfma_f32_16x16x32_bf16 v[84:87], v[184:187], v[156:159], v[84:87]
    s_add_u32 m0, s40, 3072
    v_mfma_f32_16x16x32_bf16 v[88:91], v[184:187], v[160:163], v[88:91]
    buffer_load_dwordx4 v195, s[4:7], s44 offen lds
    v_mfma_f32_16x16x32_bf16 v[92:95], v[184:187], v[164:167], v[92:95]
    s_waitcnt lgkmcnt(0)
    v_mfma_f32_16x16x32_bf16 v[16:19], v[132:135], v[116:119], v[16:19]
    ds_read_b64_tr_b16 v[168:169], v206 offset:5120
    v_mfma_f32_16x16x32_bf16 v[20:23], v[132:135], v[120:123], v[20:23]
    ds_read_b64_tr_b16 v[170:171], v206 offset:7680
    v_mfma_f32_16x16x32_bf16 v[24:27], v[132:135], v[124:127], v[24:27]
    ds_read_b128 v[152:155], v205 offset:0
    v_mfma_f32_16x16x32_bf16 v[28:31], v[132:135], v[128:131], v[28:31]
    ds_read_b128 v[156:159], v205 offset:2048
    s_add_u32 m0, s41, 0
    v_mfma_f32_16x16x32_bf16 v[32:35], v[136:139], v[116:119], v[32:35]
    ds_read_b128 v[160:163], v205 offset:4096
    buffer_load_dwordx4 v196, s[16:19], s45 offen lds
    v_mfma_f32_16x16x32_bf16 v[36:39], v[136:139], v[120:123], v[36:39]
    ds_read_b128 v[164:167], v205 offset:6144
    v_mfma_f32_16x16x32_bf16 v[40:43], v[136:139], v[124:127], v[40:43]
    ds_read_b64_tr_b16 v[172:173], v206 offset:5152
    v_mfma_f32_16x16x32_bf16 v[44:47], v[136:139], v[128:131], v[44:47]
    ds_read_b64_tr_b16 v[174:175], v206 offset:7712
    v_mfma_f32_16x16x32_bf16 v[48:51], v[140:143], v[116:119], v[48:51]
    ds_read_b64_tr_b16 v[176:177], v206 offset:15360
    v_mfma_f32_16x16x32_bf16 v[52:55], v[140:143], v[120:123], v[52:55]
    ds_read_b64_tr_b16 v[178:179], v206 offset:17920
    s_add_u32 m0, s42, 0
    v_mfma_f32_16x16x32_bf16 v[56:59], v[140:143], v[124:127], v[56:59]
    ds_read_b64_tr_b16 v[180:181], v206 offset:15392
    buffer_load_dwordx4 v197, s[20:23], s45 offen lds
    v_mfma_f32_16x16x32_bf16 v[60:63], v[140:143], v[128:131], v[60:63]
    ds_read_b64_tr_b16 v[182:183], v206 offset:17952
    v_mfma_f32_16x16x32_bf16 v[64:67], v[144:147], v[116:119], v[64:67]
    ds_read_b64_tr_b16 v[184:185], v207 offset:5120
    v_mfma_f32_16x16x32_bf16 v[68:71], v[144:147], v[120:123], v[68:71]
    ds_read_b64_tr_b16 v[186:187], v207 offset:7680
    v_mfma_f32_16x16x32_bf16 v[72:75], v[144:147], v[124:127], v[72:75]
    v_mfma_f32_16x16x32_bf16 v[76:79], v[144:147], v[128:131], v[76:79]
    v_mfma_f32_16x16x32_bf16 v[80:83], v[148:151], v[116:119], v[80:83]
    s_mov_b32 m0, s43
    v_mfma_f32_16x16x32_bf16 v[84:87], v[148:151], v[120:123], v[84:87]
    buffer_load_dwordx4 v198, s[24:27], s45 offen lds
    v_mfma_f32_16x16x32_bf16 v[88:91], v[148:151], v[124:127], v[88:91]
    v_mfma_f32_16x16x32_bf16 v[92:95], v[148:151], v[128:131], v[92:95]
    s_waitcnt vmcnt(7)
    s_waitcnt lgkmcnt(0)
    s_barrier
    s_lshl_b32 s63, s53, 4
    s_add_u32 s63, s63, 196608
    s_cmp_eq_u32 s32, 0
    s_cselect_b32 s63, s63, 30408704
    v_mov_b32 v2, 4
    s_mov_b64 exec, 1
    buffer_store_dword v2, off, s[8:11], s63 sc1
    s_mov_b64 exec, -1
    v_mfma_f32_16x16x32_bf16 v[16:19], v[168:171], v[152:155], v[16:19]
    ds_read_b64_tr_b16 v[132:133], v210 offset:0
    s_and_b32 s28, s38, 3
    s_lshl_b32 s28, s28, 2
    v_mfma_f32_16x16x32_bf16 v[20:23], v[168:171], v[156:159], v[20:23]
    ds_read_b64_tr_b16 v[134:135], v210 offset:2560
    s_and_b32 s60, s39, 3
    s_add_u32 s28, s28, s60
    v_mfma_f32_16x16x32_bf16 v[24:27], v[168:171], v[160:163], v[24:27]
    ds_read_b128 v[116:119], v208 offset:0
    s_lshr_b32 s29, s39, 2
    s_cmp_ge_u32 s38, 4
    s_cselect_b32 s60, 20, 27
    s_cselect_b32 s61, 2211840, 0
    s_cselect_b32 s97, 8, 0
    s_cselect_b64 s[58:59], -1, 0
    s_add_u32 s46, s3, 7
    s_sub_u32 s47, s46, 10
    s_min_u32 s46, s46, s47
    s_mul_i32 s47, s46, 221184
    s_lshl_b32 s46, s46, 7
    s_add_u32 m0, s40, 53248
    v_mfma_f32_16x16x32_bf16 v[28:31], v[168:171], v[164:167], v[28:31]
    ds_read_b128 v[120:123], v208 offset:2048
    buffer_load_dwordx4 v192, s[4:7], s46 offen lds
    v_mfma_f32_16x16x32_bf16 v[32:35], v[172:175], v[152:155], v[32:35]
    ds_read_b128 v[124:127], v208 offset:4096
    s_add_u32 s97, s97, s32
    s_mul_i32 s31, s60, 10240
    v_mfma_f32_16x16x32_bf16 v[36:39], v[172:175], v[156:159], v[36:39]
    ds_read_b128 v[128:131], v208 offset:6144
    s_mul_i32 s62, s29, s31
    s_add_u32 s61, s61, s62
    v_mfma_f32_16x16x32_bf16 v[40:43], v[172:175], v[160:163], v[40:43]
    ds_read_b64_tr_b16 v[136:137], v210 offset:32
    s_mul_i32 s62, s29, 5
    s_lshr_b32 s62, s62, 2
    v_mfma_f32_16x16x32_bf16 v[44:47], v[172:175], v[164:167], v[44:47]
    ds_read_b64_tr_b16 v[138:139], v210 offset:2592
    s_mul_i32 s62, s62, 27
    s_min_u32 s62, s62, 200
    s_add_u32 m0, s40, 54272
    v_mfma_f32_16x16x32_bf16 v[48:51], v[176:179], v[152:155], v[48:51]
    ds_read_b64_tr_b16 v[140:141], v210 offset:10240
    buffer_load_dwordx4 v193, s[4:7], s46 offen lds
    v_mfma_f32_16x16x32_bf16 v[52:55], v[176:179], v[156:159], v[52:55]
    ds_read_b64_tr_b16 v[142:143], v210 offset:12800
    v_min_u32 v13, 55, v1
    v_add_u32 v13, s62, v13
    v_mfma_f32_16x16x32_bf16 v[56:59], v[176:179], v[160:163], v[56:59]
    ds_read_b64_tr_b16 v[144:145], v210 offset:10272
    s_mul_i32 s62, s29, 25
    v_min_u32 v14, 24, v1
    v_mfma_f32_16x16x32_bf16 v[60:63], v[176:179], v[164:167], v[60:63]
    ds_read_b64_tr_b16 v[146:147], v210 offset:12832
    v_add_u32 v14, s62, v14
    s_lshr_b32 s62, s53, 3
    v_mfma_f32_16x16x32_bf16 v[64:67], v[180:183], v[152:155], v[64:67]
    ds_read_b64_tr_b16 v[148:149], v211 offset:0
    s_sub_u32 s62, s62, 16
    v_writelane_b32 v14, s62, 55
    s_add_u32 m0, s40, 55296
    v_mfma_f32_16x16x32_bf16 v[68:71], v[180:183], v[156:159], v[68:71]
    ds_read_b64_tr_b16 v[150:151], v211 offset:2560
    buffer_load_dwordx4 v194, s[4:7], s46 offen lds
    v_mfma_f32_16x16x32_bf16 v[72:75], v[180:183], v[160:163], v[72:75]
    v_cndmask_b32 v13, v13, v14, s[58:59]
    s_bfe_u32 s62, s53, 0x50003
    v_mfma_f32_16x16x32_bf16 v[76:79], v[180:183], v[164:167], v[76:79]
    v_and_b32 v14, 7, v1
    v_lshl_add_u32 v14, v14, 5, s62
    v_mfma_f32_16x16x32_bf16 v[80:83], v[184:187], v[152:155], v[80:83]
    v_cmp_lt_u32 vcc, 55, v1
    s_nop 1
    v_cndmask_b32 v13, v13, v14, vcc
    v_mfma_f32_16x16x32_bf16 v[84:87], v[184:187], v[156:159], v[84:87]
    v_lshlrev_b32 v13, 7, v13
    v_add_u32 v13, 196608, v13
    s_add_u32 m0, s40, 56320
    v_mfma_f32_16x16x32_bf16 v[88:91], v[184:187], v[160:163], v[88:91]
    buffer_load_dwordx4 v195, s[4:7], s46 offen lds
    v_mfma_f32_16x16x32_bf16 v[92:95], v[184:187], v[164:167], v[92:95]
    s_add_u32 s61, s61, 1048576
    v_add_u32 v247, s61, v5
    s_waitcnt lgkmcnt(0)
    v_mfma_f32_16x16x32_bf16 v[16:19], v[132:135], v[116:119], v[16:19]
    ds_read_b64_tr_b16 v[168:169], v210 offset:5120
    s_and_b32 s62, s39, 3
    s_lshl_b32 s62, s62, 1
    v_mfma_f32_16x16x32_bf16 v[20:23], v[132:135], v[120:123], v[20:23]
    ds_read_b64_tr_b16 v[170:171], v210 offset:7680
    s_add_u32 s62, s62, s29
    s_and_b32 s62, s62, 7
    v_mfma_f32_16x16x32_bf16 v[24:27], v[132:135], v[124:127], v[24:27]
    ds_read_b128 v[152:155], v209 offset:0
    s_mul_i32 s62, s62, s60
    s_lshr_b32 s62, s62, 3
    v_mfma_f32_16x16x32_bf16 v[28:31], v[132:135], v[128:131], v[28:31]
    ds_read_b128 v[156:159], v209 offset:2048
    s_mov_b32 s62, 0
    s_lshl_b32 s54, s62, 11
    s_add_u32 m0, s41, 53248
    v_mfma_f32_16x16x32_bf16 v[32:35], v[136:139], v[116:119], v[32:35]
    ds_read_b128 v[160:163], v209 offset:4096
    buffer_load_dwordx4 v196, s[16:19], s47 offen lds
    v_mfma_f32_16x16x32_bf16 v[36:39], v[136:139], v[120:123], v[36:39]
    ds_read_b128 v[164:167], v209 offset:6144
    s_mul_i32 s30, s62, 10240
    s_lshl_b32 s62, s32, 10
    v_mfma_f32_16x16x32_bf16 v[40:43], v[136:139], v[124:127], v[40:43]
    ds_read_b64_tr_b16 v[172:173], v210 offset:5152
    s_add_u32 s30, s30, s62
    v_mfma_f32_16x16x32_bf16 v[44:47], v[136:139], v[128:131], v[44:47]
    ds_read_b64_tr_b16 v[174:175], v210 offset:7712
    v_mfma_f32_16x16x32_bf16 v[48:51], v[140:143], v[116:119], v[48:51]
    ds_read_b64_tr_b16 v[176:177], v210 offset:15360
    v_mfma_f32_16x16x32_bf16 v[52:55], v[140:143], v[120:123], v[52:55]
    ds_read_b64_tr_b16 v[178:179], v210 offset:17920
    s_add_u32 m0, s42, 53248
    v_mfma_f32_16x16x32_bf16 v[56:59], v[140:143], v[124:127], v[56:59]
    ds_read_b64_tr_b16 v[180:181], v210 offset:15392
    buffer_load_dwordx4 v197, s[20:23], s47 offen lds
    v_mfma_f32_16x16x32_bf16 v[60:63], v[140:143], v[128:131], v[60:63]
    ds_read_b64_tr_b16 v[182:183], v210 offset:17952
    v_mfma_f32_16x16x32_bf16 v[64:67], v[144:147], v[116:119], v[64:67]
    ds_read_b64_tr_b16 v[184:185], v211 offset:5120
    v_mfma_f32_16x16x32_bf16 v[68:71], v[144:147], v[120:123], v[68:71]
    ds_read_b64_tr_b16 v[186:187], v211 offset:7680
    v_mfma_f32_16x16x32_bf16 v[72:75], v[144:147], v[124:127], v[72:75]
    v_mfma_f32_16x16x32_bf16 v[76:79], v[144:147], v[128:131], v[76:79]
    v_mfma_f32_16x16x32_bf16 v[80:83], v[148:151], v[116:119], v[80:83]
    s_mov_b32 m0, s52
    v_mfma_f32_16x16x32_bf16 v[84:87], v[148:151], v[120:123], v[84:87]
    buffer_load_dwordx4 v198, s[24:27], s47 offen lds
    v_mfma_f32_16x16x32_bf16 v[88:91], v[148:151], v[124:127], v[88:91]
    v_mfma_f32_16x16x32_bf16 v[92:95], v[148:151], v[128:131], v[92:95]
    s_waitcnt vmcnt(8) lgkmcnt(0)
    s_barrier
    s_cmp_eq_u32 s32, 1
    s_cselect_b32 s63, 0, 30408704
    buffer_load_dword v2, v6, s[12:15], s63 offen sc1
    v_mfma_f32_16x16x32_bf16 v[16:19], v[168:171], v[152:155], v[16:19]
    ds_read_b64_tr_b16 v[132:133], v202 offset:0
    v_mfma_f32_16x16x32_bf16 v[20:23], v[168:171], v[156:159], v[20:23]
    ds_read_b64_tr_b16 v[134:135], v202 offset:2560
    v_mfma_f32_16x16x32_bf16 v[24:27], v[168:171], v[160:163], v[24:27]
    ds_read_b128 v[116:119], v200 offset:0
    s_add_u32 s44, s3, 8
    s_sub_u32 s45, s44, 10
    s_min_u32 s44, s44, s45
    s_mul_i32 s45, s44, 221184
    s_lshl_b32 s44, s44, 7
    s_add_u32 m0, s40, 106496
    v_mfma_f32_16x16x32_bf16 v[28:31], v[168:171], v[164:167], v[28:31]
    ds_read_b128 v[120:123], v200 offset:2048
    buffer_load_dwordx4 v192, s[4:7], s44 offen lds
    v_mfma_f32_16x16x32_bf16 v[32:35], v[172:175], v[152:155], v[32:35]
    ds_read_b128 v[124:127], v200 offset:4096
    v_mfma_f32_16x16x32_bf16 v[36:39], v[172:175], v[156:159], v[36:39]
    ds_read_b128 v[128:131], v200 offset:6144
    v_mfma_f32_16x16x32_bf16 v[40:43], v[172:175], v[160:163], v[40:43]
    ds_read_b64_tr_b16 v[136:137], v202 offset:32
    v_mfma_f32_16x16x32_bf16 v[44:47], v[172:175], v[164:167], v[44:47]
    ds_read_b64_tr_b16 v[138:139], v202 offset:2592
    s_add_u32 m0, s40, 107520
    v_mfma_f32_16x16x32_bf16 v[48:51], v[176:179], v[152:155], v[48:51]
    ds_read_b64_tr_b16 v[140:141], v202 offset:10240
    buffer_load_dwordx4 v193, s[4:7], s44 offen lds
    v_mfma_f32_16x16x32_bf16 v[52:55], v[176:179], v[156:159], v[52:55]
    ds_read_b64_tr_b16 v[142:143], v202 offset:12800
    v_mfma_f32_16x16x32_bf16 v[56:59], v[176:179], v[160:163], v[56:59]
    ds_read_b64_tr_b16 v[144:145], v202 offset:10272
    v_mfma_f32_16x16x32_bf16 v[60:63], v[176:179], v[164:167], v[60:63]
    ds_read_b64_tr_b16 v[146:147], v202 offset:12832
    v_mfma_f32_16x16x32_bf16 v[64:67], v[180:183], v[152:155], v[64:67]
    ds_read_b64_tr_b16 v[148:149], v203 offset:0
    s_add_u32 m0, s40, 108544
    v_mfma_f32_16x16x32_bf16 v[68:71], v[180:183], v[156:159], v[68:71]
    ds_read_b64_tr_b16 v[150:151], v203 offset:2560
    buffer_load_dwordx4 v194, s[4:7], s44 offen lds
    v_mfma_f32_16x16x32_bf16 v[72:75], v[180:183], v[160:163], v[72:75]
    v_mfma_f32_16x16x32_bf16 v[76:79], v[180:183], v[164:167], v[76:79]
    v_mfma_f32_16x16x32_bf16 v[80:83], v[184:187], v[152:155], v[80:83]
    v_mfma_f32_16x16x32_bf16 v[84:87], v[184:187], v[156:159], v[84:87]
    s_add_u32 m0, s40, 109568
    v_mfma_f32_16x16x32_bf16 v[88:91], v[184:187], v[160:163], v[88:91]
    buffer_load_dwordx4 v195, s[4:7], s44 offen lds
    v_mfma_f32_16x16x32_bf16 v[92:95], v[184:187], v[164:167], v[92:95]
    s_waitcnt lgkmcnt(0)
    v_mfma_f32_16x16x32_bf16 v[16:19], v[132:135], v[116:119], v[16:19]
    ds_read_b64_tr_b16 v[168:169], v202 offset:5120
    v_mfma_f32_16x16x32_bf16 v[20:23], v[132:135], v[120:123], v[20:23]
    ds_read_b64_tr_b16 v[170:171], v202 offset:7680
    v_mfma_f32_16x16x32_bf16 v[24:27], v[132:135], v[124:127], v[24:27]
    ds_read_b128 v[152:155], v201 offset:0
    v_mfma_f32_16x16x32_bf16 v[28:31], v[132:135], v[128:131], v[28:31]
    ds_read_b128 v[156:159], v201 offset:2048
    s_add_u32 m0, s41, 106496
    v_mfma_f32_16x16x32_bf16 v[32:35], v[136:139], v[116:119], v[32:35]
    ds_read_b128 v[160:163], v201 offset:4096
    buffer_load_dwordx4 v196, s[16:19], s45 offen lds
    v_mfma_f32_16x16x32_bf16 v[36:39], v[136:139], v[120:123], v[36:39]
    ds_read_b128 v[164:167], v201 offset:6144
    v_mfma_f32_16x16x32_bf16 v[40:43], v[136:139], v[124:127], v[40:43]
    ds_read_b64_tr_b16 v[172:173], v202 offset:5152
    v_mfma_f32_16x16x32_bf16 v[44:47], v[136:139], v[128:131], v[44:47]
    ds_read_b64_tr_b16 v[174:175], v202 offset:7712
    v_mfma_f32_16x16x32_bf16 v[48:51], v[140:143], v[116:119], v[48:51]
    ds_read_b64_tr_b16 v[176:177], v202 offset:15360
    v_mfma_f32_16x16x32_bf16 v[52:55], v[140:143], v[120:123], v[52:55]
    ds_read_b64_tr_b16 v[178:179], v202 offset:17920
    s_add_u32 m0, s42, 106496
    v_mfma_f32_16x16x32_bf16 v[56:59], v[140:143], v[124:127], v[56:59]
    ds_read_b64_tr_b16 v[180:181], v202 offset:15392
    buffer_load_dwordx4 v197, s[20:23], s45 offen lds
    v_mfma_f32_16x16x32_bf16 v[60:63], v[140:143], v[128:131], v[60:63]
    ds_read_b64_tr_b16 v[182:183], v202 offset:17952
    v_mfma_f32_16x16x32_bf16 v[64:67], v[144:147], v[116:119], v[64:67]
    ds_read_b64_tr_b16 v[184:185], v203 offset:5120
    v_mfma_f32_16x16x32_bf16 v[68:71], v[144:147], v[120:123], v[68:71]
    ds_read_b64_tr_b16 v[186:187], v203 offset:7680
    v_mfma_f32_16x16x32_bf16 v[72:75], v[144:147], v[124:127], v[72:75]
    v_mfma_f32_16x16x32_bf16 v[76:79], v[144:147], v[128:131], v[76:79]
    v_mfma_f32_16x16x32_bf16 v[80:83], v[148:151], v[116:119], v[80:83]
    s_mov_b32 m0, s37
    v_mfma_f32_16x16x32_bf16 v[84:87], v[148:151], v[120:123], v[84:87]
    buffer_load_dwordx4 v198, s[24:27], s45 offen lds
    v_mfma_f32_16x16x32_bf16 v[88:91], v[148:151], v[124:127], v[88:91]
    v_mfma_f32_16x16x32_bf16 v[92:95], v[148:151], v[128:131], v[92:95]
    s_waitcnt vmcnt(7)
    s_cmp_lg_u32 s32, 1
    s_cbranch_scc1 Lp0d_10
    s_mov_b32 s101, 0
Lp0_9:
    v_cmp_gt_u32 vcc, 4, v2
    s_nop 1
    s_cmp_eq_u64 vcc, 0
    s_cbranch_scc1 Lp0d_10
    s_mov_b64 exec, vcc
    s_sleep 16
    buffer_load_dword v2, v6, s[12:15], 0 offen sc1
    s_add_u32 s101, s101, 1
    s_cmp_lt_u32 s101, 100000
    s_waitcnt vmcnt(0)
    s_cbranch_scc1 Lp0_9
Lp0d_10:
    s_mov_b64 exec, -1
    s_waitcnt lgkmcnt(0)
    s_barrier
    s_cmp_eq_u32 s32, 1
    s_cselect_b32 s63, 0, 30408704
    buffer_load_dword v2, v13, s[8:11], s63 offen sc1
    v_mfma_f32_16x16x32_bf16 v[16:19], v[168:171], v[152:155], v[16:19]
    ds_read_b64_tr_b16 v[132:133], v206 offset:0
    v_mfma_f32_16x16x32_bf16 v[20:23], v[168:171], v[156:159], v[20:23]
    ds_read_b64_tr_b16 v[134:135], v206 offset:2560
    v_mfma_f32_16x16x32_bf16 v[24:27], v[168:171], v[160:163], v[24:27]
    ds_read_b128 v[116:119], v204 offset:0
    s_add_u32 s46, s3, 9
    s_sub_u32 s47, s46, 10
    s_min_u32 s46, s46, s47
    s_mul_i32 s47, s46, 221184
    s_lshl_b32 s46, s46, 7
    s_add_u32 m0, s40, 0
    v_mfma_f32_16x16x32_bf16 v[28:31], v[168:171], v[164:167], v[28:31]
    ds_read_b128 v[120:123], v204 offset:2048
    buffer_load_dwordx4 v192, s[4:7], s46 offen lds
    v_mfma_f32_16x16x32_bf16 v[32:35], v[172:175], v[152:155], v[32:35]
    ds_read_b128 v[124:127], v204 offset:4096
    v_mfma_f32_16x16x32_bf16 v[36:39], v[172:175], v[156:159], v[36:39]
    ds_read_b128 v[128:131], v204 offset:6144
    v_mfma_f32_16x16x32_bf16 v[40:43], v[172:175], v[160:163], v[40:43]
    ds_read_b64_tr_b16 v[136:137], v206 offset:32
    v_mfma_f32_16x16x32_bf16 v[44:47], v[172:175], v[164:167], v[44:47]
    ds_read_b64_tr_b16 v[138:139], v206 offset:2592
    s_add_u32 m0, s40, 1024
    v_mfma_f32_16x16x32_bf16 v[48:51], v[176:179], v[152:155], v[48:51]
    ds_read_b64_tr_b16 v[140:141], v206 offset:10240
    buffer_load_dwordx4 v193, s[4:7], s46 offen lds
    v_mfma_f32_16x16x32_bf16 v[52:55], v[176:179], v[156:159], v[52:55]
    ds_read_b64_tr_b16 v[142:143], v206 offset:12800
    v_mfma_f32_16x16x32_bf16 v[56:59], v[176:179], v[160:163], v[56:59]
    ds_read_b64_tr_b16 v[144:145], v206 offset:10272
    v_mfma_f32_16x16x32_bf16 v[60:63], v[176:179], v[164:167], v[60:63]
    ds_read_b64_tr_b16 v[146:147], v206 offset:12832
    v_mfma_f32_16x16x32_bf16 v[64:67], v[180:183], v[152:155], v[64:67]
    ds_read_b64_tr_b16 v[148:149], v207 offset:0
    s_add_u32 m0, s40, 2048
    v_mfma_f32_16x16x32_bf16 v[68:71], v[180:183], v[156:159], v[68:71]
    ds_read_b64_tr_b16 v[150:151], v207 offset:2560
    buffer_load_dwordx4 v194, s[4:7], s46 offen lds
    v_mfma_f32_16x16x32_bf16 v[72:75], v[180:183], v[160:163], v[72:75]
    v_mfma_f32_16x16x32_bf16 v[76:79], v[180:183], v[164:167], v[76:79]
    v_mfma_f32_16x16x32_bf16 v[80:83], v[184:187], v[152:155], v[80:83]
    v_mfma_f32_16x16x32_bf16 v[84:87], v[184:187], v[156:159], v[84:87]
    s_add_u32 m0, s40, 3072
    v_mfma_f32_16x16x32_bf16 v[88:91], v[184:187], v[160:163], v[88:91]
    buffer_load_dwordx4 v195, s[4:7], s46 offen lds
    v_mfma_f32_16x16x32_bf16 v[92:95], v[184:187], v[164:167], v[92:95]
    s_waitcnt lgkmcnt(0)
    v_mfma_f32_16x16x32_bf16 v[16:19], v[132:135], v[116:119], v[16:19]
    ds_read_b64_tr_b16 v[168:169], v206 offset:5120
    v_mfma_f32_16x16x32_bf16 v[20:23], v[132:135], v[120:123], v[20:23]
    ds_read_b64_tr_b16 v[170:171], v206 offset:7680
    v_mfma_f32_16x16x32_bf16 v[24:27], v[132:135], v[124:127], v[24:27]
    ds_read_b128 v[152:155], v205 offset:0
    v_mfma_f32_16x16x32_bf16 v[28:31], v[132:135], v[128:131], v[28:31]
    ds_read_b128 v[156:159], v205 offset:2048
    s_add_u32 m0, s41, 0
    v_mfma_f32_16x16x32_bf16 v[32:35], v[136:139], v[116:119], v[32:35]
    ds_read_b128 v[160:163], v205 offset:4096
    buffer_load_dwordx4 v196, s[16:19], s47 offen lds
    v_mfma_f32_16x16x32_bf16 v[36:39], v[136:139], v[120:123], v[36:39]
    ds_read_b128 v[164:167], v205 offset:6144
    v_mfma_f32_16x16x32_bf16 v[40:43], v[136:139], v[124:127], v[40:43]
    ds_read_b64_tr_b16 v[172:173], v206 offset:5152
    v_mfma_f32_16x16x32_bf16 v[44:47], v[136:139], v[128:131], v[44:47]
    ds_read_b64_tr_b16 v[174:175], v206 offset:7712
    v_mfma_f32_16x16x32_bf16 v[48:51], v[140:143], v[116:119], v[48:51]
    ds_read_b64_tr_b16 v[176:177], v206 offset:15360
    v_mfma_f32_16x16x32_bf16 v[52:55], v[140:143], v[120:123], v[52:55]
    ds_read_b64_tr_b16 v[178:179], v206 offset:17920
    s_add_u32 m0, s42, 0
    v_mfma_f32_16x16x32_bf16 v[56:59], v[140:143], v[124:127], v[56:59]
    ds_read_b64_tr_b16 v[180:181], v206 offset:15392
    buffer_load_dwordx4 v197, s[20:23], s47 offen lds
    v_mfma_f32_16x16x32_bf16 v[60:63], v[140:143], v[128:131], v[60:63]
    ds_read_b64_tr_b16 v[182:183], v206 offset:17952
    v_mfma_f32_16x16x32_bf16 v[64:67], v[144:147], v[116:119], v[64:67]
    ds_read_b64_tr_b16 v[184:185], v207 offset:5120
    v_mfma_f32_16x16x32_bf16 v[68:71], v[144:147], v[120:123], v[68:71]
    ds_read_b64_tr_b16 v[186:187], v207 offset:7680
    v_mfma_f32_16x16x32_bf16 v[72:75], v[144:147], v[124:127], v[72:75]
    v_mfma_f32_16x16x32_bf16 v[76:79], v[144:147], v[128:131], v[76:79]
    v_mfma_f32_16x16x32_bf16 v[80:83], v[148:151], v[116:119], v[80:83]
    s_mov_b32 m0, s43
    v_mfma_f32_16x16x32_bf16 v[84:87], v[148:151], v[120:123], v[84:87]
    buffer_load_dwordx4 v198, s[24:27], s47 offen lds
    v_mfma_f32_16x16x32_bf16 v[88:91], v[148:151], v[124:127], v[88:91]
    v_mfma_f32_16x16x32_bf16 v[92:95], v[148:151], v[128:131], v[92:95]
    s_waitcnt vmcnt(7)
    s_cmp_lg_u32 s32, 1
    s_cbranch_scc1 Lp0d_12
    s_mov_b32 s101, 0
Lp0_11:
    v_cmp_gt_u32 vcc, 4, v2
    s_nop 1
    s_cmp_eq_u64 vcc, 0
    s_cbranch_scc1 Lp0d_12
    s_mov_b64 exec, vcc
    s_sleep 4
    buffer_load_dword v2, v13, s[8:11], 0 offen sc1
    s_add_u32 s101, s101, 1
    s_cmp_lt_u32 s101, 100000
    s_waitcnt vmcnt(0)
    s_cbranch_scc1 Lp0_11
Lp0d_12:
    s_mov_b64 exec, -1
    s_waitcnt lgkmcnt(0)
    s_barrier
    s_lshl_b32 s40, s32, 10
    v_mfma_f32_16x16x32_bf16 v[16:19], v[168:171], v[152:155], v[16:19]
    ds_read_b64_tr_b16 v[132:133], v210 offset:0
    s_lshl_b32 s60, s28, 3
    s_lshl_b32 s61, s33, 1
    s_add_u32 s60, s60, s61
    v_mfma_f32_16x16x32_bf16 v[20:23], v[168:171], v[156:159], v[20:23]
    ds_read_b64_tr_b16 v[134:135], v210 offset:2560
    s_add_u32 s60, s60, s34
    s_mul_i32 s60, s60, 20480
    s_mul_i32 s61, s29, 160
    v_mfma_f32_16x16x32_bf16 v[24:27], v[168:171], v[160:163], v[24:27]
    ds_read_b128 v[116:119], v208 offset:0
    s_add_u32 s60, s60, s61
    s_cmp_ge_u32 s38, 4
    s_cselect_b32 s60, 0x1000000, s60
    v_mfma_f32_16x16x32_bf16 v[28:31], v[168:171], v[164:167], v[28:31]
    ds_read_b128 v[120:123], v208 offset:2048
    v_mul_u32_u24 v252, 1280, v3
    v_lshl_add_u32 v252, v4, 4, v252
    buffer_load_dwordx4 v[232:235], v252, s[4:7], s60 offen offset:0
    buffer_load_dwordx4 v[236:239], v252, s[4:7], s60 offen offset:64
    s_mov_b32 exec_hi, 0
    buffer_load_dwordx4 v[240:243], v252, s[4:7], s60 offen offset:128
    s_mov_b32 exec_hi, -1
    v_mfma_f32_16x16x32_bf16 v[32:35], v[172:175], v[152:155], v[32:35]
    ds_read_b128 v[124:127], v208 offset:4096
    s_lshl_b32 s16, s28, 3
    s_lshl_b32 s60, s33, 1
    s_add_u32 s16, s16, s60
    v_mfma_f32_16x16x32_bf16 v[36:39], v[172:175], v[156:159], v[36:39]
    ds_read_b128 v[128:131], v208 offset:6144
    s_add_u32 s16, s16, s34
    s_cmp_ge_u32 s38, 4
    s_cselect_b32 s61, 40, 54
    s_cselect_b32 s62, 7340032, 0
    s_cselect_b32 s23, 2816, 0
    s_cselect_b32 s25, 2, 10
    s_cselect_b32 s26, 11, 4
    s_add_u32 s44, s30, 0
    s_sub_u32 s45, s44, s31
    s_min_u32 s44, s44, s45
    s_add_u32 m0, s40, 61440
    v_mfma_f32_16x16x32_bf16 v[40:43], v[172:175], v[160:163], v[40:43]
    ds_read_b64_tr_b16 v[136:137], v210 offset:32
    buffer_load_dwordx4 v247, s[8:11], s44 offen sc1 lds
    v_mfma_f32_16x16x32_bf16 v[44:47], v[172:175], v[164:167], v[44:47]
    ds_read_b64_tr_b16 v[138:139], v210 offset:2592
    s_mul_i32 s25, s25, 10240
    s_mul_i32 s26, s26, 10240
    s_add_u32 s62, s62, 5242880
    v_mfma_f32_16x16x32_bf16 v[48:51], v[176:179], v[152:155], v[48:51]
    ds_read_b64_tr_b16 v[140:141], v210 offset:10240
    s_xor_b32 s60, s16, 0
    s_mul_i32 s60, s60, s61
    s_add_u32 s60, s60, s34
    v_mfma_f32_16x16x32_bf16 v[52:55], v[176:179], v[156:159], v[52:55]
    ds_read_b64_tr_b16 v[142:143], v210 offset:12800
    s_lshl_b32 s60, s60, 10
    s_add_u32 s60, s60, s62
    v_add_u32 v248, s60, v5
    v_mfma_f32_16x16x32_bf16 v[56:59], v[176:179], v[160:163], v[56:59]
    ds_read_b64_tr_b16 v[144:145], v210 offset:10272
    s_xor_b32 s60, s16, 1
    s_mul_i32 s60, s60, s61
    s_add_u32 s60, s60, s34
    v_mfma_f32_16x16x32_bf16 v[60:63], v[176:179], v[164:167], v[60:63]
    ds_read_b64_tr_b16 v[146:147], v210 offset:12832
    s_lshl_b32 s60, s60, 10
    s_add_u32 s60, s60, s62
    v_add_u32 v249, s60, v5
    v_mfma_f32_16x16x32_bf16 v[64:67], v[180:183], v[152:155], v[64:67]
    ds_read_b64_tr_b16 v[148:149], v211 offset:0
    s_xor_b32 s60, s34, 0
    s_mul_i32 s60, s60, s25
    s_mul_i32 s63, s33, 5120
    v_mfma_f32_16x16x32_bf16 v[68:71], v[180:183], v[156:159], v[68:71]
    ds_read_b64_tr_b16 v[150:151], v211 offset:2560
    s_add_u32 s60, s60, s63
    s_add_u32 s60, s60, s26
    v_add_u32 v250, s60, v5
    v_mfma_f32_16x16x32_bf16 v[72:75], v[180:183], v[160:163], v[72:75]
    s_xor_b32 s60, s34, 1
    s_mul_i32 s60, s60, s25
    s_mul_i32 s63, s33, 5120
    v_mfma_f32_16x16x32_bf16 v[76:79], v[180:183], v[164:167], v[76:79]
    s_add_u32 s60, s60, s63
    s_add_u32 s60, s60, s26
    v_add_u32 v251, s60, v5
    s_add_u32 s44, s30, 8192
    s_sub_u32 s45, s44, s31
    s_min_u32 s44, s44, s45
    s_add_u32 m0, s40, 69632
    v_mfma_f32_16x16x32_bf16 v[80:83], v[184:187], v[152:155], v[80:83]
    buffer_load_dwordx4 v247, s[8:11], s44 offen sc1 lds
    v_mfma_f32_16x16x32_bf16 v[84:87], v[184:187], v[156:159], v[84:87]
    s_mul_i32 s60, s34, 5120
    v_lshlrev_b32 v14, 3, v1
    v_add_u32 v14, s60, v14
    v_mfma_f32_16x16x32_bf16 v[88:91], v[184:187], v[160:163], v[88:91]
    s_lshl_b32 s60, s34, 2
    v_add_u32 v15, s60, v4
    v_lshrrev_b32 v254, 1, v3
    v_mfma_f32_16x16x32_bf16 v[92:95], v[184:187], v[164:167], v[92:95]
    v_xor_b32 v15, v15, v254
    v_lshlrev_b32 v15, 4, v15
    v_lshl_add_u32 v15, v3, 7, v15
    s_waitcnt lgkmcnt(0)
    v_mfma_f32_16x16x32_bf16 v[16:19], v[132:135], v[116:119], v[16:19]
    ds_read_b64_tr_b16 v[168:169], v210 offset:5120
    v_cndmask_b32 v244, v14, v15, s[58:59]
    v_add_u32 v245, 51200, v244
    v_add_u32 v246, 102400, v244
    v_mfma_f32_16x16x32_bf16 v[20:23], v[132:135], v[120:123], v[20:23]
    ds_read_b64_tr_b16 v[170:171], v210 offset:7680
    s_mul_i32 s17, s16, 20480
    s_mul_i32 s18, s29, 160
    s_add_u32 s17, s17, s18
    v_mfma_f32_16x16x32_bf16 v[24:27], v[132:135], v[124:127], v[24:27]
    ds_read_b128 v[152:155], v209 offset:0
    s_lshl_b32 s24, s17, 1
    v_mul_u32_u24 v252, 1280, v3
    v_lshl_add_u32 v252, v4, 3, v252
    v_mfma_f32_16x16x32_bf16 v[28:31], v[132:135], v[128:131], v[28:31]
    ds_read_b128 v[156:159], v209 offset:2048
    v_lshlrev_b32 v253, 1, v252
    s_lshl_b32 s19, s16, 6
    s_lshl_b32 s60, s28, 3
    s_add_u32 s44, s30, 16384
    s_sub_u32 s45, s44, s31
    s_min_u32 s44, s44, s45
    s_add_u32 m0, s40, 77824
    v_mfma_f32_16x16x32_bf16 v[32:35], v[136:139], v[116:119], v[32:35]
    ds_read_b128 v[160:163], v209 offset:4096
    buffer_load_dwordx4 v247, s[8:11], s44 offen sc1 lds
    v_mfma_f32_16x16x32_bf16 v[36:39], v[136:139], v[120:123], v[36:39]
    ds_read_b128 v[164:167], v209 offset:6144
    s_add_u32 s60, s60, s29
    s_lshl_b32 s60, s60, 3
    s_add_u32 s60, s60, s32
    v_mfma_f32_16x16x32_bf16 v[40:43], v[136:139], v[124:127], v[40:43]
    ds_read_b64_tr_b16 v[172:173], v210 offset:5152
    s_mul_i32 s20, s60, 10240
    s_add_u32 s20, s20, 18874368
    s_xor_b32 s60, s60, 4
    v_mfma_f32_16x16x32_bf16 v[44:47], v[136:139], v[128:131], v[44:47]
    ds_read_b64_tr_b16 v[174:175], v210 offset:7712
    s_mul_i32 s21, s60, 10240
    s_add_u32 s21, s21, 18879488
    s_lshr_b32 s60, s28, 1
    v_mfma_f32_16x16x32_bf16 v[48:51], v[140:143], v[116:119], v[48:51]
    ds_read_b64_tr_b16 v[176:177], v210 offset:15360
    s_lshl_b32 s60, s60, 12
    s_add_u32 s23, s23, s60
    s_add_u32 s23, s23, 163840
    v_mfma_f32_16x16x32_bf16 v[52:55], v[140:143], v[120:123], v[52:55]
    ds_read_b64_tr_b16 v[178:179], v210 offset:17920
    s_add_u32 s44, s30, 24576
    s_sub_u32 s45, s44, s31
    s_min_u32 s44, s44, s45
    s_add_u32 m0, s40, 86016
    v_mfma_f32_16x16x32_bf16 v[56:59], v[140:143], v[124:127], v[56:59]
    ds_read_b64_tr_b16 v[180:181], v210 offset:15392
    buffer_load_dwordx4 v247, s[8:11], s44 offen sc1 lds
    v_mfma_f32_16x16x32_bf16 v[60:63], v[140:143], v[128:131], v[60:63]
    ds_read_b64_tr_b16 v[182:183], v210 offset:17952
    v_mfma_f32_16x16x32_bf16 v[64:67], v[144:147], v[116:119], v[64:67]
    ds_read_b64_tr_b16 v[184:185], v211 offset:5120
    v_mfma_f32_16x16x32_bf16 v[68:71], v[144:147], v[120:123], v[68:71]
    ds_read_b64_tr_b16 v[186:187], v211 offset:7680
    v_mfma_f32_16x16x32_bf16 v[72:75], v[144:147], v[124:127], v[72:75]
    v_mfma_f32_16x16x32_bf16 v[76:79], v[144:147], v[128:131], v[76:79]
    v_mfma_f32_16x16x32_bf16 v[80:83], v[148:151], v[116:119], v[80:83]
    s_add_u32 s44, s30, 32768
    s_sub_u32 s45, s44, s31
    s_min_u32 s44, s44, s45
    s_add_u32 m0, s40, 94208
    v_mfma_f32_16x16x32_bf16 v[84:87], v[148:151], v[120:123], v[84:87]
    buffer_load_dwordx4 v247, s[8:11], s44 offen sc1 lds
    v_mfma_f32_16x16x32_bf16 v[88:91], v[148:151], v[124:127], v[88:91]
    v_mfma_f32_16x16x32_bf16 v[92:95], v[148:151], v[128:131], v[92:95]
    s_waitcnt vmcnt(8) lgkmcnt(0)
    s_barrier
    s_setprio 2
    s_cmp_lt_u32 s32, 4
    s_cbranch_scc1 Lskip_13
    s_setprio 1
Lskip_13:
    s_mov_b32 s12, s80
    s_mov_b32 s13, s81
    s_mov_b32 s14, 1280
    s_mov_b32 s15, 0x20000
    s_cmp_lg_u32 s32, 4
    s_cbranch_scc1 Lskip_14
    s_mov_b32 m0, 157696
    s_nop 0
    buffer_load_dwordx4 v5, s[12:15], s18 offen lds
Lskip_14:
    s_lshl_b32 s60, s35, 10
    s_lshl_b32 s61, s28, 9
    s_cmp_lt_u32 s32, 2
    s_cselect_b32 s60, s60, s61
    s_and_b32 s61, s32, 1
    s_lshl_b32 s61, s61, 13
    s_add_u32 s60, s60, s61
    s_cmp_lt_u32 s32, 4
    s_cselect_b32 s60, s60, 30408704
    s_cselect_b32 s61, s40, 5120
    s_add_u32 m0, s61, 153600
    s_nop 0
    buffer_load_dwordx4 v5, s[8:11], s60 offen sc1 lds
    v_mfma_f32_16x16x32_bf16 v[16:19], v[168:171], v[152:155], v[16:19]
    ds_read_b64_tr_b16 v[132:133], v202 offset:0
    s_bfe_u32 s56, s53, 0x50003
    s_lshl_b32 s56, s56, 1
    s_add_u32 s56, s56, s34
    s_mul_i32 s56, s56, 5120
    s_add_u32 s56, s56, 262144
    s_add_u32 s57, s56, 4096
    v_mfma_f32_16x16x32_bf16 v[20:23], v[168:171], v[156:159], v[20:23]
    ds_read_b64_tr_b16 v[134:135], v202 offset:2560
    buffer_load_dwordx4 v[96:99], v5, s[8:11], s56 offen offset:0 sc1
    v_mfma_f32_16x16x32_bf16 v[24:27], v[168:171], v[160:163], v[24:27]
    ds_read_b128 v[116:119], v200 offset:0
    v_mfma_f32_16x16x32_bf16 v[28:31], v[168:171], v[164:167], v[28:31]
    ds_read_b128 v[120:123], v200 offset:2048
    buffer_load_dwordx4 v[100:103], v5, s[8:11], s56 offen offset:1024 sc1
    s_add_u32 s44, s30, 90112
    s_sub_u32 s45, s44, s31
    s_min_u32 s44, s44, s45
    s_add_u32 m0, s40, 151552
    v_mfma_f32_16x16x32_bf16 v[32:35], v[172:175], v[152:155], v[32:35]
    ds_read_b128 v[124:127], v200 offset:4096
    s_cmp_ge_u32 s32, 2
    s_cbranch_scc1 Lskip_15
    buffer_load_dwordx4 v247, s[8:11], s44 offen sc1 lds
Lskip_15:
    v_mfma_f32_16x16x32_bf16 v[36:39], v[172:175], v[156:159], v[36:39]
    ds_read_b128 v[128:131], v200 offset:6144
    v_mfma_f32_16x16x32_bf16 v[40:43], v[172:175], v[160:163], v[40:43]
    ds_read_b64_tr_b16 v[136:137], v202 offset:32
    buffer_load_dwordx4 v[104:107], v5, s[8:11], s56 offen offset:2048 sc1
    v_mfma_f32_16x16x32_bf16 v[44:47], v[172:175], v[164:167], v[44:47]
    ds_read_b64_tr_b16 v[138:139], v202 offset:2592
    v_mfma_f32_16x16x32_bf16 v[48:51], v[176:179], v[152:155], v[48:51]
    ds_read_b64_tr_b16 v[140:141], v202 offset:10240
    buffer_load_dwordx4 v[108:111], v5, s[8:11], s56 offen offset:3072 sc1
    v_mfma_f32_16x16x32_bf16 v[52:55], v[176:179], v[156:159], v[52:55]
    ds_read_b64_tr_b16 v[142:143], v202 offset:12800
    s_add_u32 s44, s30, 40960
    s_sub_u32 s45, s44, s31
    s_min_u32 s44, s44, s45
    s_add_u32 m0, s40, 102400
    v_mfma_f32_16x16x32_bf16 v[56:59], v[176:179], v[160:163], v[56:59]
    ds_read_b64_tr_b16 v[144:145], v202 offset:10272
    buffer_load_dwordx4 v247, s[8:11], s44 offen sc1 lds
    v_mfma_f32_16x16x32_bf16 v[60:63], v[176:179], v[164:167], v[60:63]
    ds_read_b64_tr_b16 v[146:147], v202 offset:12832
    buffer_load_dwordx4 v[112:115], v5, s[8:11], s57 offen offset:0 sc1
    v_mfma_f32_16x16x32_bf16 v[64:67], v[180:183], v[152:155], v[64:67]
    ds_read_b64_tr_b16 v[148:149], v203 offset:0
    v_mfma_f32_16x16x32_bf16 v[68:71], v[180:183], v[156:159], v[68:71]
    ds_read_b64_tr_b16 v[150:151], v203 offset:2560
    v_mfma_f32_16x16x32_bf16 v[72:75], v[180:183], v[160:163], v[72:75]
    v_mfma_f32_16x16x32_bf16 v[76:79], v[180:183], v[164:167], v[76:79]
    v_mfma_f32_16x16x32_bf16 v[80:83], v[184:187], v[152:155], v[80:83]
    s_add_u32 s44, s30, 49152
    s_sub_u32 s45, s44, s31
    s_min_u32 s44, s44, s45
    s_add_u32 m0, s40, 110592
    v_mfma_f32_16x16x32_bf16 v[84:87], v[184:187], v[156:159], v[84:87]
    buffer_load_dwordx4 v247, s[8:11], s44 offen sc1 lds
    v_mfma_f32_16x16x32_bf16 v[88:91], v[184:187], v[160:163], v[88:91]
    v_mfma_f32_16x16x32_bf16 v[92:95], v[184:187], v[164:167], v[92:95]
    s_waitcnt lgkmcnt(0)
    v_mfma_f32_16x16x32_bf16 v[16:19], v[132:135], v[116:119], v[16:19]
    ds_read_b64_tr_b16 v[168:169], v202 offset:5120
    v_mfma_f32_16x16x32_bf16 v[20:23], v[132:135], v[120:123], v[20:23]
    ds_read_b64_tr_b16 v[170:171], v202 offset:7680
    v_mfma_f32_16x16x32_bf16 v[24:27], v[132:135], v[124:127], v[24:27]
    ds_read_b128 v[152:155], v201 offset:0
    v_mfma_f32_16x16x32_bf16 v[28:31], v[132:135], v[128:131], v[28:31]
    ds_read_b128 v[156:159], v201 offset:2048
    s_add_u32 s44, s30, 57344
    s_sub_u32 s45, s44, s31
    s_min_u32 s44, s44, s45
    s_add_u32 m0, s40, 118784
    v_mfma_f32_16x16x32_bf16 v[32:35], v[136:139], v[116:119], v[32:35]
    ds_read_b128 v[160:163], v201 offset:4096
    buffer_load_dwordx4 v247, s[8:11], s44 offen sc1 lds
    v_mfma_f32_16x16x32_bf16 v[36:39], v[136:139], v[120:123], v[36:39]
    ds_read_b128 v[164:167], v201 offset:6144
    v_mfma_f32_16x16x32_bf16 v[40:43], v[136:139], v[124:127], v[40:43]
    ds_read_b64_tr_b16 v[172:173], v202 offset:5152
    v_mfma_f32_16x16x32_bf16 v[44:47], v[136:139], v[128:131], v[44:47]
    ds_read_b64_tr_b16 v[174:175], v202 offset:7712
    v_mfma_f32_16x16x32_bf16 v[48:51], v[140:143], v[116:119], v[48:51]
    ds_read_b64_tr_b16 v[176:177], v202 offset:15360
    v_mfma_f32_16x16x32_bf16 v[52:55], v[140:143], v[120:123], v[52:55]
    ds_read_b64_tr_b16 v[178:179], v202 offset:17920
    s_add_u32 s44, s30, 65536
    s_sub_u32 s45, s44, s31
    s_min_u32 s44, s44, s45
    s_add_u32 m0, s40, 126976
    v_mfma_f32_16x16x32_bf16 v[56:59], v[140:143], v[124:127], v[56:59]
    ds_read_b64_tr_b16 v[180:181], v202 offset:15392
    buffer_load_dwordx4 v247, s[8:11], s44 offen sc1 lds
    v_mfma_f32_16x16x32_bf16 v[60:63], v[140:143], v[128:131], v[60:63]
    ds_read_b64_tr_b16 v[182:183], v202 offset:17952
    v_mfma_f32_16x16x32_bf16 v[64:67], v[144:147], v[116:119], v[64:67]
    ds_read_b64_tr_b16 v[184:185], v203 offset:5120
    v_mfma_f32_16x16x32_bf16 v[68:71], v[144:147], v[120:123], v[68:71]
    ds_read_b64_tr_b16 v[186:187], v203 offset:7680
    v_mfma_f32_16x16x32_bf16 v[72:75], v[144:147], v[124:127], v[72:75]
    v_mfma_f32_16x16x32_bf16 v[76:79], v[144:147], v[128:131], v[76:79]
    v_mfma_f32_16x16x32_bf16 v[80:83], v[148:151], v[116:119], v[80:83]
    s_add_u32 s44, s30, 73728
    s_sub_u32 s45, s44, s31
    s_min_u32 s44, s44, s45
    s_add_u32 m0, s40, 135168
    v_mfma_f32_16x16x32_bf16 v[84:87], v[148:151], v[120:123], v[84:87]
    buffer_load_dwordx4 v247, s[8:11], s44 offen sc1 lds
    v_mfma_f32_16x16x32_bf16 v[88:91], v[148:151], v[124:127], v[88:91]
    v_mfma_f32_16x16x32_bf16 v[92:95], v[148:151], v[128:131], v[92:95]
    s_waitcnt lgkmcnt(0)
    s_waitcnt vmcnt(4)
    v_mfma_f32_16x16x32_bf16 v[96:99], v[96:99], v[188:191], 0
    v_mfma_f32_16x16x32_bf16 v[100:103], v[100:103], v[188:191], 0
    v_mfma_f32_16x16x32_bf16 v[104:107], v[104:107], v[188:191], 0
    v_mfma_f32_16x16x32_bf16 v[108:111], v[108:111], v[188:191], 0
    v_mfma_f32_16x16x32_bf16 v[112:115], v[112:115], v[188:191], 0
    v_mfma_f32_16x16x32_bf16 v[16:19], v[168:171], v[152:155], v[16:19]
    v_mfma_f32_16x16x32_bf16 v[20:23], v[168:171], v[156:159], v[20:23]
    s_add_u32 s44, s30, 81920
    s_sub_u32 s45, s44, s31
    s_min_u32 s44, s44, s45
    s_add_u32 m0, s40, 143360
    v_mfma_f32_16x16x32_bf16 v[24:27], v[168:171], v[160:163], v[24:27]
    buffer_load_dwordx4 v247, s[8:11], s44 offen sc1 lds
    v_mfma_f32_16x16x32_bf16 v[28:31], v[168:171], v[164:167], v[28:31]
    v_mfma_f32_16x16x32_bf16 v[32:35], v[172:175], v[152:155], v[32:35]
    v_mfma_f32_16x16x32_bf16 v[36:39], v[172:175], v[156:159], v[36:39]
    v_mfma_f32_16x16x32_bf16 v[40:43], v[172:175], v[160:163], v[40:43]
    v_mfma_f32_16x16x32_bf16 v[44:47], v[172:175], v[164:167], v[44:47]
    v_mfma_f32_16x16x32_bf16 v[48:51], v[176:179], v[152:155], v[48:51]
    v_mfma_f32_16x16x32_bf16 v[52:55], v[176:179], v[156:159], v[52:55]
    v_mfma_f32_16x16x32_bf16 v[56:59], v[176:179], v[160:163], v[56:59]
    s_mov_b64 exec, 1
    s_lshl_b32 s60, s32, 2
    s_add_u32 s60, s60, 162560
    v_mov_b32 v14, s60
    v_mov_b32 v15, 1
    ds_write_b32 v14, v15
    s_mov_b64 exec, -1
    v_mfma_f32_16x16x32_bf16 v[60:63], v[176:179], v[164:167], v[60:63]
    v_mfma_f32_16x16x32_bf16 v[64:67], v[180:183], v[152:155], v[64:67]
    v_mfma_f32_16x16x32_bf16 v[68:71], v[180:183], v[156:159], v[68:71]
    v_mfma_f32_16x16x32_bf16 v[72:75], v[180:183], v[160:163], v[72:75]
    v_mfma_f32_16x16x32_bf16 v[76:79], v[180:183], v[164:167], v[76:79]
    v_mfma_f32_16x16x32_bf16 v[80:83], v[184:187], v[152:155], v[80:83]
    v_mfma_f32_16x16x32_bf16 v[84:87], v[184:187], v[156:159], v[84:87]
    v_mfma_f32_16x16x32_bf16 v[88:91], v[184:187], v[160:163], v[88:91]
    v_mfma_f32_16x16x32_bf16 v[92:95], v[184:187], v[164:167], v[92:95]
    s_setprio 0
    v_add_u32 v14, 162560, v6
    s_mov_b64 exec, 3
    s_mov_b32 s60, 0
Llf_16:
    ds_read_b32 v15, v14
    s_add_u32 s60, s60, 1
    s_waitcnt lgkmcnt(0)
    v_cmp_ne_u32 vcc, 1, v15
    s_cmp_ge_u32 s60, 1000000
    s_cbranch_scc1 Llfd_17
    s_cmp_lg_u64 vcc, 0
    s_cbranch_scc1 Llf_16
Llfd_17:
    s_mov_b64 exec, -1
    ds_read2st64_b32 v[188:189], v12 offset0:0 offset1:4
    v_add_u32 v205, 64, v12
    ds_read2st64_b32 v[190:191], v205 offset0:0 offset1:4
    v_add_u32 v206, 128, v12
    ds_read2st64_b32 v[192:193], v206 offset0:0 offset1:4
    v_add_u32 v207, 192, v12
    ds_read2st64_b32 v[194:195], v207 offset0:0 offset1:4
    s_waitcnt lgkmcnt(0)
    v_mul_f32 v196, v189, v189
    v_rcp_f32 v196, v196
    v_mul_f32 v189, 0xbfb8aa3b, v189
    v_mul_f32 v198, v191, v191
    v_rcp_f32 v198, v198
    v_mul_f32 v191, 0xbfb8aa3b, v191
    v_mul_f32 v200, v193, v193
    v_rcp_f32 v200, v200
    v_mul_f32 v193, 0xbfb8aa3b, v193
    v_mul_f32 v202, v195, v195
    v_rcp_f32 v202, v202
    v_mul_f32 v195, 0xbfb8aa3b, v195
    v_pk_fma_f32 v[16:17], v[96:97], v[188:189], v[16:17] op_sel_hi:[1,0,1] neg_lo:[0,1,0] neg_hi:[0,1,0]
    v_pk_fma_f32 v[18:19], v[98:99], v[188:189], v[18:19] op_sel_hi:[1,0,1] neg_lo:[0,1,0] neg_hi:[0,1,0]
    v_pk_fma_f32 v[32:33], v[100:101], v[188:189], v[32:33] op_sel_hi:[1,0,1] neg_lo:[0,1,0] neg_hi:[0,1,0]
    v_pk_fma_f32 v[34:35], v[102:103], v[188:189], v[34:35] op_sel_hi:[1,0,1] neg_lo:[0,1,0] neg_hi:[0,1,0]
    v_pk_fma_f32 v[48:49], v[104:105], v[188:189], v[48:49] op_sel_hi:[1,0,1] neg_lo:[0,1,0] neg_hi:[0,1,0]
    v_pk_fma_f32 v[50:51], v[106:107], v[188:189], v[50:51] op_sel_hi:[1,0,1] neg_lo:[0,1,0] neg_hi:[0,1,0]
    v_pk_fma_f32 v[64:65], v[108:109], v[188:189], v[64:65] op_sel_hi:[1,0,1] neg_lo:[0,1,0] neg_hi:[0,1,0]
    v_pk_fma_f32 v[66:67], v[110:111], v[188:189], v[66:67] op_sel_hi:[1,0,1] neg_lo:[0,1,0] neg_hi:[0,1,0]
    v_pk_mul_f32 v[116:117], v[188:189], v[16:17] op_sel:[1,0] op_sel_hi:[1,1]
    v_pk_mul_f32 v[118:119], v[188:189], v[18:19] op_sel:[1,0] op_sel_hi:[1,1]
    v_pk_mul_f32 v[120:121], v[188:189], v[32:33] op_sel:[1,0] op_sel_hi:[1,1]
    v_pk_mul_f32 v[122:123], v[188:189], v[34:35] op_sel:[1,0] op_sel_hi:[1,1]
    v_exp_f32 v116, v116
    v_exp_f32 v117, v117
    v_exp_f32 v118, v118
    v_exp_f32 v119, v119
    v_exp_f32 v120, v120
    v_exp_f32 v121, v121
    v_exp_f32 v122, v122
    v_exp_f32 v123, v123
    v_pk_mul_f32 v[16:17], v[16:17], v[48:49]
    v_pk_mul_f32 v[18:19], v[18:19], v[50:51]
    v_pk_mul_f32 v[32:33], v[32:33], v[64:65]
    v_pk_mul_f32 v[34:35], v[34:35], v[66:67]
    v_pk_fma_f32 v[116:117], v[116:117], v[196:197], v[196:197] op_sel_hi:[1,0,0]
    v_pk_fma_f32 v[118:119], v[118:119], v[196:197], v[196:197] op_sel_hi:[1,0,0]
    v_pk_fma_f32 v[120:121], v[120:121], v[196:197], v[196:197] op_sel_hi:[1,0,0]
    v_pk_fma_f32 v[122:123], v[122:123], v[196:197], v[196:197] op_sel_hi:[1,0,0]
    v_rcp_f32 v116, v116
    v_rcp_f32 v117, v117
    v_rcp_f32 v118, v118
    v_rcp_f32 v119, v119
    v_rcp_f32 v120, v120
    v_rcp_f32 v121, v121
    v_rcp_f32 v122, v122
    v_rcp_f32 v123, v123
    v_pk_mul_f32 v[16:17], v[16:17], v[116:117]
    v_pk_mul_f32 v[18:19], v[18:19], v[118:119]
    v_pk_mul_f32 v[32:33], v[32:33], v[120:121]
    v_pk_mul_f32 v[34:35], v[34:35], v[122:123]
    v_cvt_pk_bf16_f32 v124, v16, v17
    v_cvt_pk_bf16_f32 v125, v18, v19
    v_cvt_pk_bf16_f32 v126, v32, v33
    v_cvt_pk_bf16_f32 v127, v34, v35
    buffer_store_dwordx4 v[124:127], v5, s[8:11], s50 offen sc1
    s_add_u32 s50, s50, 55296
    v_pk_fma_f32 v[20:21], v[96:97], v[190:191], v[20:21] op_sel_hi:[1,0,1] neg_lo:[0,1,0] neg_hi:[0,1,0]
    v_pk_fma_f32 v[22:23], v[98:99], v[190:191], v[22:23] op_sel_hi:[1,0,1] neg_lo:[0,1,0] neg_hi:[0,1,0]
    v_pk_fma_f32 v[36:37], v[100:101], v[190:191], v[36:37] op_sel_hi:[1,0,1] neg_lo:[0,1,0] neg_hi:[0,1,0]
    v_pk_fma_f32 v[38:39], v[102:103], v[190:191], v[38:39] op_sel_hi:[1,0,1] neg_lo:[0,1,0] neg_hi:[0,1,0]
    v_pk_fma_f32 v[52:53], v[104:105], v[190:191], v[52:53] op_sel_hi:[1,0,1] neg_lo:[0,1,0] neg_hi:[0,1,0]
    v_pk_fma_f32 v[54:55], v[106:107], v[190:191], v[54:55] op_sel_hi:[1,0,1] neg_lo:[0,1,0] neg_hi:[0,1,0]
    v_pk_fma_f32 v[68:69], v[108:109], v[190:191], v[68:69] op_sel_hi:[1,0,1] neg_lo:[0,1,0] neg_hi:[0,1,0]
    v_pk_fma_f32 v[70:71], v[110:111], v[190:191], v[70:71] op_sel_hi:[1,0,1] neg_lo:[0,1,0] neg_hi:[0,1,0]
    v_pk_mul_f32 v[116:117], v[190:191], v[20:21] op_sel:[1,0] op_sel_hi:[1,1]
    v_pk_mul_f32 v[118:119], v[190:191], v[22:23] op_sel:[1,0] op_sel_hi:[1,1]
    v_pk_mul_f32 v[120:121], v[190:191], v[36:37] op_sel:[1,0] op_sel_hi:[1,1]
    v_pk_mul_f32 v[122:123], v[190:191], v[38:39] op_sel:[1,0] op_sel_hi:[1,1]
    v_exp_f32 v116, v116
    v_exp_f32 v117, v117
    v_exp_f32 v118, v118
    v_exp_f32 v119, v119
    v_exp_f32 v120, v120
    v_exp_f32 v121, v121
    v_exp_f32 v122, v122
    v_exp_f32 v123, v123
    v_pk_mul_f32 v[20:21], v[20:21], v[52:53]
    v_pk_mul_f32 v[22:23], v[22:23], v[54:55]
    v_pk_mul_f32 v[36:37], v[36:37], v[68:69]
    v_pk_mul_f32 v[38:39], v[38:39], v[70:71]
    v_pk_fma_f32 v[116:117], v[116:117], v[198:199], v[198:199] op_sel_hi:[1,0,0]
    v_pk_fma_f32 v[118:119], v[118:119], v[198:199], v[198:199] op_sel_hi:[1,0,0]
    v_pk_fma_f32 v[120:121], v[120:121], v[198:199], v[198:199] op_sel_hi:[1,0,0]
    v_pk_fma_f32 v[122:123], v[122:123], v[198:199], v[198:199] op_sel_hi:[1,0,0]
    v_rcp_f32 v116, v116
    v_rcp_f32 v117, v117
    v_rcp_f32 v118, v118
    v_rcp_f32 v119, v119
    v_rcp_f32 v120, v120
    v_rcp_f32 v121, v121
    v_rcp_f32 v122, v122
    v_rcp_f32 v123, v123
    v_pk_mul_f32 v[20:21], v[20:21], v[116:117]
    v_pk_mul_f32 v[22:23], v[22:23], v[118:119]
    v_pk_mul_f32 v[36:37], v[36:37], v[120:121]
    v_pk_mul_f32 v[38:39], v[38:39], v[122:123]
    v_cvt_pk_bf16_f32 v128, v20, v21
    v_cvt_pk_bf16_f32 v129, v22, v23
    v_cvt_pk_bf16_f32 v130, v36, v37
    v_cvt_pk_bf16_f32 v131, v38, v39
    buffer_store_dwordx4 v[128:131], v5, s[8:11], s50 offen sc1
    s_add_u32 s50, s50, 55296
    v_add_u32 v14, 162560, v6
    s_mov_b64 exec, 0xff
    s_mov_b32 s60, 0
Llf_18:
    ds_read_b32 v15, v14
    s_add_u32 s60, s60, 1
    s_waitcnt lgkmcnt(0)
    v_cmp_ne_u32 vcc, 1, v15
    s_cmp_ge_u32 s60, 1000000
    s_cbranch_scc1 Llfd_19
    s_cmp_lg_u64 vcc, 0
    s_cbranch_scc1 Llf_18
Llfd_19:
    s_mov_b64 exec, -1
    s_add_u32 s44, s30, 149504
    s_sub_u32 s45, s44, s31
    s_min_u32 s44, s44, s45
    s_add_u32 m0, s40, 57344
    s_cmp_ge_u32 s32, 4
    s_cbranch_scc1 Lskip_20
    buffer_load_dwordx4 v247, s[8:11], s44 offen sc1 lds
Lskip_20:
    s_add_u32 s44, s30, 133120
    s_sub_u32 s45, s44, s31
    s_min_u32 s44, s44, s45
    s_add_u32 m0, s40, 40960
    s_nop 0
    buffer_load_dwordx4 v247, s[8:11], s44 offen sc1 lds
    s_add_u32 s44, s30, 141312
    s_sub_u32 s45, s44, s31
    s_min_u32 s44, s44, s45
    s_add_u32 m0, s40, 49152
    s_nop 0
    buffer_load_dwordx4 v247, s[8:11], s44 offen sc1 lds
    v_pk_fma_f32 v[24:25], v[96:97], v[192:193], v[24:25] op_sel_hi:[1,0,1] neg_lo:[0,1,0] neg_hi:[0,1,0]
    v_pk_fma_f32 v[26:27], v[98:99], v[192:193], v[26:27] op_sel_hi:[1,0,1] neg_lo:[0,1,0] neg_hi:[0,1,0]
    v_pk_fma_f32 v[40:41], v[100:101], v[192:193], v[40:41] op_sel_hi:[1,0,1] neg_lo:[0,1,0] neg_hi:[0,1,0]
    v_pk_fma_f32 v[42:43], v[102:103], v[192:193], v[42:43] op_sel_hi:[1,0,1] neg_lo:[0,1,0] neg_hi:[0,1,0]
    v_pk_fma_f32 v[56:57], v[104:105], v[192:193], v[56:57] op_sel_hi:[1,0,1] neg_lo:[0,1,0] neg_hi:[0,1,0]
    v_pk_fma_f32 v[58:59], v[106:107], v[192:193], v[58:59] op_sel_hi:[1,0,1] neg_lo:[0,1,0] neg_hi:[0,1,0]
    v_pk_fma_f32 v[72:73], v[108:109], v[192:193], v[72:73] op_sel_hi:[1,0,1] neg_lo:[0,1,0] neg_hi:[0,1,0]
    v_pk_fma_f32 v[74:75], v[110:111], v[192:193], v[74:75] op_sel_hi:[1,0,1] neg_lo:[0,1,0] neg_hi:[0,1,0]
    v_pk_mul_f32 v[116:117], v[192:193], v[24:25] op_sel:[1,0] op_sel_hi:[1,1]
    v_pk_mul_f32 v[118:119], v[192:193], v[26:27] op_sel:[1,0] op_sel_hi:[1,1]
    v_pk_mul_f32 v[120:121], v[192:193], v[40:41] op_sel:[1,0] op_sel_hi:[1,1]
    v_pk_mul_f32 v[122:123], v[192:193], v[42:43] op_sel:[1,0] op_sel_hi:[1,1]
    v_exp_f32 v116, v116
    v_exp_f32 v117, v117
    v_exp_f32 v118, v118
    v_exp_f32 v119, v119
    v_exp_f32 v120, v120
    v_exp_f32 v121, v121
    v_exp_f32 v122, v122
    v_exp_f32 v123, v123
    v_pk_mul_f32 v[24:25], v[24:25], v[56:57]
    v_pk_mul_f32 v[26:27], v[26:27], v[58:59]
    v_pk_mul_f32 v[40:41], v[40:41], v[72:73]
    v_pk_mul_f32 v[42:43], v[42:43], v[74:75]
    v_pk_fma_f32 v[116:117], v[116:117], v[200:201], v[200:201] op_sel_hi:[1,0,0]
    v_pk_fma_f32 v[118:119], v[118:119], v[200:201], v[200:201] op_sel_hi:[1,0,0]
    v_pk_fma_f32 v[120:121], v[120:121], v[200:201], v[200:201] op_sel_hi:[1,0,0]
    v_pk_fma_f32 v[122:123], v[122:123], v[200:201], v[200:201] op_sel_hi:[1,0,0]
    v_rcp_f32 v116, v116
    v_rcp_f32 v117, v117
    v_rcp_f32 v118, v118
    v_rcp_f32 v119, v119
    v_rcp_f32 v120, v120
    v_rcp_f32 v121, v121
    v_rcp_f32 v122, v122
    v_rcp_f32 v123, v123
    v_pk_mul_f32 v[24:25], v[24:25], v[116:117]
    v_pk_mul_f32 v[26:27], v[26:27], v[118:119]
    v_pk_mul_f32 v[40:41], v[40:41], v[120:121]
    v_pk_mul_f32 v[42:43], v[42:43], v[122:123]
    v_cvt_pk_bf16_f32 v124, v24, v25
    v_cvt_pk_bf16_f32 v125, v26, v27
    v_cvt_pk_bf16_f32 v126, v40, v41
    v_cvt_pk_bf16_f32 v127, v42, v43
    buffer_store_dwordx4 v[124:127], v5, s[8:11], s50 offen sc1
    s_add_u32 s50, s50, 55296
    s_add_u32 s44, s30, 92160
    s_sub_u32 s45, s44, s31
    s_min_u32 s44, s44, s45
    s_add_u32 m0, s40, 0
    s_nop 0
    buffer_load_dwordx4 v247, s[8:11], s44 offen sc1 lds
    s_add_u32 s44, s30, 100352
    s_sub_u32 s45, s44, s31
    s_min_u32 s44, s44, s45
    s_add_u32 m0, s40, 8192
    s_nop 0
    buffer_load_dwordx4 v247, s[8:11], s44 offen sc1 lds
    s_add_u32 s44, s30, 108544
    s_sub_u32 s45, s44, s31
    s_min_u32 s44, s44, s45
    s_add_u32 m0, s40, 16384
    s_nop 0
    buffer_load_dwordx4 v247, s[8:11], s44 offen sc1 lds
    v_pk_fma_f32 v[28:29], v[96:97], v[194:195], v[28:29] op_sel_hi:[1,0,1] neg_lo:[0,1,0] neg_hi:[0,1,0]
    v_pk_fma_f32 v[30:31], v[98:99], v[194:195], v[30:31] op_sel_hi:[1,0,1] neg_lo:[0,1,0] neg_hi:[0,1,0]
    v_pk_fma_f32 v[44:45], v[100:101], v[194:195], v[44:45] op_sel_hi:[1,0,1] neg_lo:[0,1,0] neg_hi:[0,1,0]
    v_pk_fma_f32 v[46:47], v[102:103], v[194:195], v[46:47] op_sel_hi:[1,0,1] neg_lo:[0,1,0] neg_hi:[0,1,0]
    v_pk_fma_f32 v[60:61], v[104:105], v[194:195], v[60:61] op_sel_hi:[1,0,1] neg_lo:[0,1,0] neg_hi:[0,1,0]
    v_pk_fma_f32 v[62:63], v[106:107], v[194:195], v[62:63] op_sel_hi:[1,0,1] neg_lo:[0,1,0] neg_hi:[0,1,0]
    v_pk_fma_f32 v[76:77], v[108:109], v[194:195], v[76:77] op_sel_hi:[1,0,1] neg_lo:[0,1,0] neg_hi:[0,1,0]
    v_pk_fma_f32 v[78:79], v[110:111], v[194:195], v[78:79] op_sel_hi:[1,0,1] neg_lo:[0,1,0] neg_hi:[0,1,0]
    v_pk_mul_f32 v[116:117], v[194:195], v[28:29] op_sel:[1,0] op_sel_hi:[1,1]
    v_pk_mul_f32 v[118:119], v[194:195], v[30:31] op_sel:[1,0] op_sel_hi:[1,1]
    v_pk_mul_f32 v[120:121], v[194:195], v[44:45] op_sel:[1,0] op_sel_hi:[1,1]
    v_pk_mul_f32 v[122:123], v[194:195], v[46:47] op_sel:[1,0] op_sel_hi:[1,1]
    v_exp_f32 v116, v116
    v_exp_f32 v117, v117
    v_exp_f32 v118, v118
    v_exp_f32 v119, v119
    v_exp_f32 v120, v120
    v_exp_f32 v121, v121
    v_exp_f32 v122, v122
    v_exp_f32 v123, v123
    v_pk_mul_f32 v[28:29], v[28:29], v[60:61]
    v_pk_mul_f32 v[30:31], v[30:31], v[62:63]
    v_pk_mul_f32 v[44:45], v[44:45], v[76:77]
    v_pk_mul_f32 v[46:47], v[46:47], v[78:79]
    v_pk_fma_f32 v[116:117], v[116:117], v[202:203], v[202:203] op_sel_hi:[1,0,0]
    v_pk_fma_f32 v[118:119], v[118:119], v[202:203], v[202:203] op_sel_hi:[1,0,0]
    v_pk_fma_f32 v[120:121], v[120:121], v[202:203], v[202:203] op_sel_hi:[1,0,0]
    v_pk_fma_f32 v[122:123], v[122:123], v[202:203], v[202:203] op_sel_hi:[1,0,0]
    v_rcp_f32 v116, v116
    v_rcp_f32 v117, v117
    v_rcp_f32 v118, v118
    v_rcp_f32 v119, v119
    v_rcp_f32 v120, v120
    v_rcp_f32 v121, v121
    v_rcp_f32 v122, v122
    v_rcp_f32 v123, v123
    v_pk_mul_f32 v[28:29], v[28:29], v[116:117]
    v_pk_mul_f32 v[30:31], v[30:31], v[118:119]
    v_pk_mul_f32 v[44:45], v[44:45], v[120:121]
    v_pk_mul_f32 v[46:47], v[46:47], v[122:123]
    v_cvt_pk_bf16_f32 v128, v28, v29
    v_cvt_pk_bf16_f32 v129, v30, v31
    v_cvt_pk_bf16_f32 v130, v44, v45
    v_cvt_pk_bf16_f32 v131, v46, v47
    buffer_store_dwordx4 v[128:131], v5, s[8:11], s50 offen sc1
    s_add_u32 s44, s30, 116736
    s_sub_u32 s45, s44, s31
    s_min_u32 s44, s44, s45
    s_add_u32 m0, s40, 24576
    s_nop 0
    buffer_load_dwordx4 v247, s[8:11], s44 offen sc1 lds
    s_add_u32 s44, s30, 124928
    s_sub_u32 s45, s44, s31
    s_min_u32 s44, s44, s45
    s_add_u32 m0, s40, 32768
    s_nop 0
    buffer_load_dwordx4 v247, s[8:11], s44 offen sc1 lds
    v_pk_fma_f32 v[80:81], v[112:113], v[188:189], v[80:81] op_sel_hi:[1,0,1] neg_lo:[0,1,0] neg_hi:[0,1,0]
    v_pk_fma_f32 v[82:83], v[114:115], v[188:189], v[82:83] op_sel_hi:[1,0,1] neg_lo:[0,1,0] neg_hi:[0,1,0]
    v_pk_fma_f32 v[84:85], v[112:113], v[190:191], v[84:85] op_sel_hi:[1,0,1] neg_lo:[0,1,0] neg_hi:[0,1,0]
    v_pk_fma_f32 v[86:87], v[114:115], v[190:191], v[86:87] op_sel_hi:[1,0,1] neg_lo:[0,1,0] neg_hi:[0,1,0]
    v_pk_fma_f32 v[88:89], v[112:113], v[192:193], v[88:89] op_sel_hi:[1,0,1] neg_lo:[0,1,0] neg_hi:[0,1,0]
    v_pk_fma_f32 v[90:91], v[114:115], v[192:193], v[90:91] op_sel_hi:[1,0,1] neg_lo:[0,1,0] neg_hi:[0,1,0]
    v_pk_fma_f32 v[92:93], v[112:113], v[194:195], v[92:93] op_sel_hi:[1,0,1] neg_lo:[0,1,0] neg_hi:[0,1,0]
    v_pk_fma_f32 v[94:95], v[114:115], v[194:195], v[94:95] op_sel_hi:[1,0,1] neg_lo:[0,1,0] neg_hi:[0,1,0]
    v_cmp_gt_u32 vcc, 32, v1
    v_permlane32_swap_b32 v80, v84
    v_permlane32_swap_b32 v81, v85
    v_permlane32_swap_b32 v82, v86
    v_permlane32_swap_b32 v83, v87
    v_cndmask_b32 v189, v191, v189, vcc
    v_cndmask_b32 v196, v198, v196, vcc
    v_permlane32_swap_b32 v88, v92
    v_permlane32_swap_b32 v89, v93
    v_permlane32_swap_b32 v90, v94
    v_permlane32_swap_b32 v91, v95
    v_cndmask_b32 v193, v195, v193, vcc
    v_cndmask_b32 v200, v202, v200, vcc
    v_pk_mul_f32 v[132:133], v[188:189], v[80:81] op_sel:[1,0] op_sel_hi:[1,1]
    v_pk_mul_f32 v[134:135], v[188:189], v[82:83] op_sel:[1,0] op_sel_hi:[1,1]
    v_pk_mul_f32 v[136:137], v[192:193], v[88:89] op_sel:[1,0] op_sel_hi:[1,1]
    v_pk_mul_f32 v[138:139], v[192:193], v[90:91] op_sel:[1,0] op_sel_hi:[1,1]
    v_exp_f32 v132, v132
    v_exp_f32 v133, v133
    v_exp_f32 v134, v134
    v_exp_f32 v135, v135
    v_exp_f32 v136, v136
    v_exp_f32 v137, v137
    v_exp_f32 v138, v138
    v_exp_f32 v139, v139
    v_pk_mul_f32 v[80:81], v[80:81], v[84:85]
    v_pk_mul_f32 v[82:83], v[82:83], v[86:87]
    v_pk_mul_f32 v[88:89], v[88:89], v[92:93]
    v_pk_mul_f32 v[90:91], v[90:91], v[94:95]
    v_pk_fma_f32 v[132:133], v[132:133], v[196:197], v[196:197] op_sel_hi:[1,0,0]
    v_pk_fma_f32 v[134:135], v[134:135], v[196:197], v[196:197] op_sel_hi:[1,0,0]
    v_pk_fma_f32 v[136:137], v[136:137], v[200:201], v[200:201] op_sel_hi:[1,0,0]
    v_pk_fma_f32 v[138:139], v[138:139], v[200:201], v[200:201] op_sel_hi:[1,0,0]
    v_rcp_f32 v132, v132
    v_rcp_f32 v133, v133
    v_rcp_f32 v134, v134
    v_rcp_f32 v135, v135
    v_rcp_f32 v136, v136
    v_rcp_f32 v137, v137
    v_rcp_f32 v138, v138
    v_rcp_f32 v139, v139
    v_pk_mul_f32 v[80:81], v[80:81], v[132:133]
    v_pk_mul_f32 v[82:83], v[82:83], v[134:135]
    v_pk_mul_f32 v[88:89], v[88:89], v[136:137]
    v_pk_mul_f32 v[90:91], v[90:91], v[138:139]
    v_cvt_pk_bf16_f32 v140, v80, v81
    v_cvt_pk_bf16_f32 v141, v82, v83
    v_cvt_pk_bf16_f32 v142, v88, v89
    v_cvt_pk_bf16_f32 v143, v90, v91
    s_nop 0
    v_permlane16_swap_b32 v140, v142
    v_permlane16_swap_b32 v141, v143
    buffer_store_dwordx4 v[140:143], v11, s[8:11], s51 offen sc1
    s_setprio 0
    s_waitcnt vmcnt(0)
    s_barrier
    s_cmp_lg_u32 s32, 0
    s_cbranch_scc1 Lskip_21
    s_lshl_b32 s60, s35, 5
    s_add_u32 s60, s60, s36
    s_lshl_b32 s60, s60, 7
    s_add_u32 s60, s60, 163840
    v_mov_b32 v2, 1
    s_mov_b64 exec, 1
    buffer_store_dword v2, off, s[8:11], s60 sc1
    s_mov_b64 exec, -1
Lskip_21:
    s_branch L_p2
L_ssm:
    s_nop 7
    s_nop 1
    s_mov_b32 s36, s48
    s_lshl_b32 s45, s3, 7
    s_lshl_b32 s55, s36, 6
    s_lshl_b32 s56, s34, 5
    s_add_u32 s55, s55, s56
    s_lshl_b32 s50, s55, 1
    s_and_b32 s56, s32, 1
    s_lshl_b32 s56, s56, 4
    s_add_u32 s55, s55, s56
    s_lshl_b32 s41, s32, 11
    s_add_u32 s41, s41, 32768
    s_add_u32 s42, s41, 1024
    v_lshrrev_b32 v7, 3, v1
    v_and_b32 v8, 7, v1
    v_add_u32 v9, 0, v7
    v_lshrrev_b32 v10, 1, v9
    v_xor_b32 v10, v10, v8
    v_add_u32 v9, s55, v9
    v_mul_u32_u24 v9, 1280, v9
    v_lshl_add_u32 v196, v10, 4, v9
    v_add_u32 v9, 8, v7
    v_lshrrev_b32 v10, 1, v9
    v_xor_b32 v10, v10, v8
    v_add_u32 v9, s55, v9
    v_mul_u32_u24 v9, 1280, v9
    v_lshl_add_u32 v197, v10, 4, v9
    v_lshlrev_b32 v7, 1, v3
    s_bitcmp1_b32 s32, 1
    s_cselect_b32 s16, s72, s70
    s_cselect_b32 s17, s73, s71
    s_mov_b32 s18, 819200
    s_mov_b32 s19, 0x20000
    s_cselect_b32 s20, s72, s70
    s_cselect_b32 s21, s73, s71
    s_mov_b32 s22, 819200
    s_mov_b32 s23, 0x20000
    s_add_u32 m0, s41, 0
    s_nop 0
    buffer_load_dwordx4 v196, s[16:19], s45 offen lds
    s_add_u32 m0, s42, 0
    s_nop 0
    buffer_load_dwordx4 v197, s[20:23], s45 offen lds
    s_cmp_lg_u32 s32, 6
    s_cbranch_scc1 Lskip_22
    s_and_b32 s60, s35, 3
    s_mul_i32 s60, s60, 5
    s_add_u32 s60, s60, 1
    s_lshr_b32 s60, s60, 1
    s_lshr_b32 s61, s35, 2
    s_add_u32 s60, s60, s61
    s_mul_i32 s61, s61, 5
    s_add_u32 s61, s61, 12
    s_add_u32 s61, s61, s3
    s_sub_u32 s61, s61, s60
    s_sub_u32 s60, s61, 10
    s_min_u32 s61, s61, s60
    s_sub_u32 s60, s61, 10
    s_min_u32 s61, s61, s60
    s_bitcmp1_b32 s35, 1
    s_cselect_b32 s28, s72, s70
    s_cselect_b32 s29, s73, s71
    s_mov_b32 s30, 819200
    s_mov_b32 s31, 0x20000
    s_and_b32 s60, s35, 1
    s_lshl_b32 s61, s61, 7
    s_lshl_b32 s62, s36, 1
    s_add_u32 s60, s60, s62
    s_mul_i32 s60, s60, 40960
    s_add_u32 s61, s61, s60
    v_and_b32 v228, 31, v1
    v_mul_u32_u24 v228, 1280, v228
    buffer_load_dword v254, v228, s[28:31], s61 offen
Lskip_22:
    s_barrier
    s_lshl_b32 s55, s33, 13
    s_add_u32 s55, s55, 0
    v_lshrrev_b32 v7, 1, v3
    v_xor_b32 v7, v7, v4
    v_lshlrev_b32 v7, 4, v7
    v_lshl_add_u32 v7, v3, 7, v7
    v_add_u32 v7, s55, v7
    v_xor_b32 v8, 64, v7
    v_add_u32 v200, 0, v7
    v_add_u32 v201, 0, v8
    v_add_u32 v204, 53248, v7
    v_add_u32 v205, 53248, v8
    v_add_u32 v208, 106496, v7
    v_add_u32 v209, 106496, v8
    s_lshl_b32 s55, s34, 13
    s_add_u32 s55, s55, 32768
    v_lshrrev_b32 v7, 1, v3
    v_xor_b32 v7, v7, v4
    v_lshlrev_b32 v7, 4, v7
    v_lshl_add_u32 v7, v3, 7, v7
    v_add_u32 v7, s55, v7
    v_xor_b32 v8, 64, v7
    v_add_u32 v202, 0, v7
    v_add_u32 v203, 0, v8
    v_add_u32 v206, 53248, v7
    v_add_u32 v207, 53248, v8
    v_add_u32 v210, 106496, v7
    v_add_u32 v211, 106496, v8
    v_mov_b32 v188, 0x3f803f80
    v_mov_b32 v189, 0x3f803f80
    v_mov_b32 v190, 0x3f803f80
    v_mov_b32 v191, 0x3f803f80
    s_mul_i32 s51, s35, 5120
    s_lshl_b32 s52, s36, 1
    s_add_u32 s52, s52, s34
    s_lshl_b32 s52, s52, 8
    s_add_u32 s51, s51, s52
    s_add_u32 s51, s51, 65536
    s_add_u32 s52, s52, 65536
    v_mov_b32 v160, -1
    v_mov_b32 v161, -1
    v_mov_b32 v162, -1
    v_mov_b32 v163, -1
    s_mov_b64 exec, 0xffff
    buffer_store_dwordx4 v[160:163], v5, s[8:11], s51 offen sc1
    s_mov_b64 exec, -1
    s_lshl_b32 s55, s32, 8
    s_add_u32 s55, s55, 159744
    v_lshlrev_b32 v7, 4, v3
    v_add_u32 v10, s55, v7
    s_lshl_b32 s55, s34, 10
    s_add_u32 s55, s55, 159744
    v_add_u32 v8, s55, v7
    v_lshlrev_b32 v9, 6, v4
    s_lshl_b32 s55, s33, 8
    s_add_u32 s55, s55, 153600
    v_add_u32 v9, s55, v9
    v_add_u32 v14, 160768, v6
    v_mov_b32 v15, 0
    s_mov_b64 exec, 0xffff
    ds_write_b32 v14, v15
    s_mov_b64 exec, -1
    s_mov_b32 s28, s88
    s_mov_b32 s29, s89
    s_mov_b32 s30, 2211840
    s_mov_b32 s31, 0x20000
    v_lshrrev_b32 v220, 3, v1
    v_and_b32 v221, 7, v1
    v_lshrrev_b32 v222, 1, v221
    v_and_b32 v223, 1, v1
    v_lshlrev_b32 v223, 4, v223
    v_lshl_add_u32 v223, v220, 5, v223
    v_and_b32 v224, 3, v220
    v_lshrrev_b32 v225, 2, v220
    v_lshl_add_u32 v226, v225, 3, v224
    s_mul_i32 s56, s53, 19419
    s_lshr_b32 s56, s56, 22
    s_mul_i32 s57, s56, 216
    s_sub_u32 s57, s53, s57
    s_lshr_b32 s58, s57, 2
    s_and_b32 s57, s57, 3
    s_lshl_b32 s59, s56, 2
    v_add_u32 v242, s59, v222
    v_mul_u32_u24 v227, 52, v242
    v_lshrrev_b32 v227, 8, v227
    v_mul_u32_u24 v227, 271360, v227
    v_lshl_add_u32 v242, v242, 10, v227
    s_mul_i32 s59, s58, 5120
    s_lshl_b32 s60, s57, 8
    s_add_u32 s59, s59, s60
    s_add_u32 s59, s59, 1048576
    v_add3_u32 v242, v242, v223, s59
    s_mul_i32 s59, s58, 13108
    s_lshr_b32 s59, s59, 16
    s_mul_i32 s60, s59, 5
    s_sub_u32 s60, s58, s60
    s_mul_i32 s59, s59, 160
    s_cmp_eq_u32 s58, 53
    s_cselect_b32 s60, 4, s60
    s_cselect_b32 s58, 48, 80
    s_and_b32 s61, s57, 1
    s_mul_i32 s58, s58, s61
    s_lshr_b32 s61, s57, 1
    s_lshl_b32 s61, s61, 2
    s_add_u32 s58, s58, s61
    s_add_u32 s58, s58, 64
    s_lshr_b32 s61, s60, 1
    s_mul_i32 s61, s61, 80
    s_and_b32 s62, s60, 1
    s_lshl_b32 s62, s62, 5
    s_add_u32 s61, s61, s62
    s_lshl_b32 s62, s57, 3
    s_add_u32 s61, s61, s62
    s_cmp_eq_u32 s60, 4
    s_cselect_b32 s61, s58, s61
    s_cselect_b64 s[62:63], -1, 0
    v_cndmask_b32 v234, v220, v226, s[62:63]
    s_add_u32 s59, s59, s61
    s_mul_i32 s59, s59, 1280
    s_lshl_b32 s56, s56, 7
    s_add_u32 s54, s59, s56
    v_mul_u32_u24 v234, 1280, v234
    v_lshl_add_u32 v234, v221, 4, v234
    s_mul_i32 s56, s53, 6554
    s_lshr_b32 s56, s56, 16
    s_mul_i32 s57, s56, 10
    s_sub_u32 s57, s53, s57
    s_mul_i32 s58, s56, 6554
    s_lshr_b32 s58, s58, 16
    s_mul_i32 s59, s58, 10
    s_sub_u32 s59, s56, s59
    s_lshr_b32 s60, s58, 1
    s_mul_i32 s60, s60, 10
    s_add_u32 s60, s60, s57
    s_mul_i32 s60, s60, 10240
    s_lshl_b32 s59, s59, 7
    s_add_u32 s55, s60, s59
    s_and_b32 s57, s57, 1
    s_lshl_b32 s57, s57, 2
    v_lshrrev_b32 v229, 4, v1
    v_add_u32 v229, s57, v229
    v_xor_b32 v229, v229, v221
    v_mul_u32_u24 v235, 1280, v220
    v_lshl_add_u32 v235, v229, 4, v235
    s_lshl_b32 s59, s53, 10
    s_add_u32 s59, s59, 3260416
    v_add_u32 v243, s59, v5
    s_bitcmp1_b32 s58, 0
    s_cselect_b32 s98, s76, s74
    s_cselect_b32 s99, s77, s75
    s_mov_b32 s97, 819200
    s_cmp_lt_u32 s53, 1600
    s_cbranch_scc1 Lskip_23
    s_lshr_b32 s55, s53, 2
    s_add_u32 s55, s55, 1648
    s_mul_i32 s56, s55, 19419
    s_lshr_b32 s56, s56, 22
    s_mul_i32 s57, s56, 216
    s_sub_u32 s57, s55, s57
    s_lshr_b32 s58, s57, 2
    s_and_b32 s57, s57, 3
    s_lshl_b32 s59, s56, 2
    v_add_u32 v243, s59, v222
    v_mul_u32_u24 v227, 52, v243
    v_lshrrev_b32 v227, 8, v227
    v_mul_u32_u24 v227, 271360, v227
    v_lshl_add_u32 v243, v243, 10, v227
    s_mul_i32 s59, s58, 5120
    s_lshl_b32 s60, s57, 8
    s_add_u32 s59, s59, s60
    s_add_u32 s59, s59, 1048576
    v_add3_u32 v243, v243, v223, s59
    s_mul_i32 s59, s58, 13108
    s_lshr_b32 s59, s59, 16
    s_mul_i32 s60, s59, 5
    s_sub_u32 s60, s58, s60
    s_mul_i32 s59, s59, 160
    s_cmp_eq_u32 s58, 53
    s_cselect_b32 s60, 4, s60
    s_cselect_b32 s58, 48, 80
    s_and_b32 s61, s57, 1
    s_mul_i32 s58, s58, s61
    s_lshr_b32 s61, s57, 1
    s_lshl_b32 s61, s61, 2
    s_add_u32 s58, s58, s61
    s_add_u32 s58, s58, 64
    s_lshr_b32 s61, s60, 1
    s_mul_i32 s61, s61, 80
    s_and_b32 s62, s60, 1
    s_lshl_b32 s62, s62, 5
    s_add_u32 s61, s61, s62
    s_lshl_b32 s62, s57, 3
    s_add_u32 s61, s61, s62
    s_cmp_eq_u32 s60, 4
    s_cselect_b32 s61, s58, s61
    s_cselect_b64 s[62:63], -1, 0
    v_cndmask_b32 v235, v220, v226, s[62:63]
    s_add_u32 s59, s59, s61
    s_mul_i32 s59, s59, 1280
    s_lshl_b32 s56, s56, 7
    s_add_u32 s55, s59, s56
    v_mul_u32_u24 v235, 1280, v235
    v_lshl_add_u32 v235, v221, 4, v235
    s_mov_b32 s98, s88
    s_mov_b32 s99, s89
    s_and_b32 s97, s53, 3
    s_cmp_eq_u32 s97, 0
    s_cselect_b32 s97, 2211840, 0
    s_cselect_b32 s59, 0, 30408704
    v_add_u32 v243, s59, v243
Lskip_23:
    s_mov_b32 s58, s97
    s_mov_b32 s56, s98
    s_mov_b32 s57, s99
    s_mov_b32 s59, 0x20000
    s_waitcnt vmcnt(7)
    v_lshlrev_b32 v220, 16, v212
    v_and_b32 v221, 0xffff0000, v212
    v_lshlrev_b32 v222, 16, v213
    v_and_b32 v223, 0xffff0000, v213
    v_lshlrev_b32 v224, 16, v214
    v_and_b32 v225, 0xffff0000, v214
    v_lshlrev_b32 v226, 16, v215
    v_and_b32 v227, 0xffff0000, v215
    v_lshlrev_b32 v228, 16, v216
    v_and_b32 v229, 0xffff0000, v216
    v_add_f32 v230, v220, v221
    v_add_f32 v230, v230, v222
    v_add_f32 v230, v230, v223
    v_add_f32 v230, v230, v224
    v_add_f32 v230, v230, v225
    v_add_f32 v230, v230, v226
    v_add_f32 v230, v230, v227
    v_add_f32 v230, v230, v228
    v_add_f32 v230, v230, v229
    s_nop 1
    v_add_f32_dpp v230, v230, v230 quad_perm:[1,0,3,2] row_mask:0xf bank_mask:0xf
    s_nop 1
    v_add_f32_dpp v230, v230, v230 quad_perm:[2,3,0,1] row_mask:0xf bank_mask:0xf
    s_nop 1
    v_add_f32_dpp v230, v230, v230 row_half_mirror row_mask:0xf bank_mask:0xf
    s_nop 1
    v_add_f32_dpp v230, v230, v230 row_mirror row_mask:0xf bank_mask:0xf
    s_nop 1
    v_add_f32_dpp v230, v230, v230 row_bcast:15 row_mask:0xa bank_mask:0xf
    s_nop 1
    v_add_f32_dpp v230, v230, v230 row_bcast:31 row_mask:0xc bank_mask:0xf
    s_nop 0
    v_readlane_b32 s60, v230, 63
    v_mov_b32 v231, 0x3acccccd
    s_nop 0
    v_mul_f32 v231, s60, v231
    v_sub_f32 v220, v220, v231
    v_sub_f32 v221, v221, v231
    v_sub_f32 v222, v222, v231
    v_sub_f32 v223, v223, v231
    v_sub_f32 v224, v224, v231
    v_sub_f32 v225, v225, v231
    v_sub_f32 v226, v226, v231
    v_sub_f32 v227, v227, v231
    v_sub_f32 v228, v228, v231
    v_sub_f32 v229, v229, v231
    v_mul_f32 v230, v220, v220
    v_fmac_f32 v230, v221, v221
    v_fmac_f32 v230, v222, v222
    v_fmac_f32 v230, v223, v223
    v_fmac_f32 v230, v224, v224
    v_fmac_f32 v230, v225, v225
    v_fmac_f32 v230, v226, v226
    v_fmac_f32 v230, v227, v227
    v_fmac_f32 v230, v228, v228
    v_fmac_f32 v230, v229, v229
    s_nop 1
    v_add_f32_dpp v230, v230, v230 quad_perm:[1,0,3,2] row_mask:0xf bank_mask:0xf
    s_nop 1
    v_add_f32_dpp v230, v230, v230 quad_perm:[2,3,0,1] row_mask:0xf bank_mask:0xf
    s_nop 1
    v_add_f32_dpp v230, v230, v230 row_half_mirror row_mask:0xf bank_mask:0xf
    s_nop 1
    v_add_f32_dpp v230, v230, v230 row_mirror row_mask:0xf bank_mask:0xf
    s_nop 1
    v_add_f32_dpp v230, v230, v230 row_bcast:15 row_mask:0xa bank_mask:0xf
    s_nop 1
    v_add_f32_dpp v230, v230, v230 row_bcast:31 row_mask:0xc bank_mask:0xf
    s_nop 0
    v_readlane_b32 s60, v230, 63
    v_mov_b32 v232, 0x3acccccd
    s_nop 0
    v_mul_f32 v232, s60, v232
    v_cvt_pk_bf16_f32 v231, v231, v231
    v_and_b32 v231, 0xffff0000, v231
    v_cvt_pk_bf16_f32 v232, v232, v232
    v_and_b32 v232, 0xffff0000, v232
    v_add_f32 v232, 0x3727c5ac, v232
    v_cvt_pk_bf16_f32 v232, v232, v232
    v_and_b32 v232, 0xffff0000, v232
    v_sqrt_f32 v232, v232
    s_nop 0
    v_cvt_pk_bf16_f32 v232, v232, v232
    v_and_b32 v232, 0xffff0000, v232
    v_rcp_f32 v232, v232
    s_lshl_b32 s60, s33, 1
    s_add_u32 s60, s60, s34
    s_lshl_b32 s60, s60, 2
    s_add_u32 s60, s60, 159744
    v_mov_b32 v233, s60
    s_mov_b64 exec, 1
    ds_write2_b32 v233, v231, v232 offset0:0 offset1:8
    s_mov_b64 exec, -1
    v_add_u32 v220, 159744, v6
    v_and_b32 v221, 28, v6
    v_bfe_u32 v222, v1, 3, 1
    v_lshl_add_u32 v221, v222, 13, v221
    s_lshl_b32 s63, s53, 2
    v_add_u32 v221, s63, v221
    v_lshrrev_b32 v222, 3, v1
    v_lshlrev_b32 v222, 15, v222
    v_and_b32 v223, 7, v1
    v_lshl_add_u32 v222, v223, 4, v222
    s_lshl_b32 s63, s53, 4
    s_add_u32 s63, s63, 65536
    v_add_u32 v222, s63, v222
    v_cmp_gt_u32 vcc, 16, v1
    s_nop 1
    v_cndmask_b32 v221, v222, v221, vcc
    s_cmp_eq_u32 s32, 0
    s_cselect_b32 s63, 0, 30408704
    v_mov_b32 v222, 0
    v_lshlrev_b32 v236, 16, v236
    v_lshlrev_b32 v238, 16, v238
    v_lshlrev_b32 v240, 16, v240
    v_mul_f32 v240, 0x3fb8aa3b, v240
    v_exp_f32 v240, v240
    s_nop 0
    v_cvt_pk_bf16_f32 v240, v240, v240
    v_and_b32 v240, 0xffff0000, v240
    v_mul_f32 v160, v240, v236
    v_mul_f32 v160, 0x3fb8aa3b, v160
    v_mul_f32 v162, v240, v238
    v_mul_f32 v162, 0x3e22f983, v162
    v_mul_f32 v224, 0x3f800000, v160
    v_mul_f32 v225, 0x3f800000, v162
    v_exp_f32 v224, v224
    v_fract_f32 v225, v225
    v_cos_f32 v164, v225
    v_sin_f32 v165, v225
    v_mul_f32 v164, v224, v164
    v_mul_f32 v165, v224, v165
    v_mul_f32 v224, 0x41000000, v160
    v_mul_f32 v225, 0x41000000, v162
    v_exp_f32 v224, v224
    v_fract_f32 v225, v225
    v_cos_f32 v168, v225
    v_sin_f32 v169, v225
    v_mul_f32 v168, v224, v168
    v_mul_f32 v169, v224, v169
    v_mul_f32 v224, 0x41800000, v160
    v_mul_f32 v225, 0x41800000, v162
    v_exp_f32 v224, v224
    v_fract_f32 v225, v225
    v_cos_f32 v172, v225
    v_sin_f32 v173, v225
    v_mul_f32 v172, v224, v172
    v_mul_f32 v173, v224, v173
    v_mul_f32 v224, 0x42000000, v160
    v_mul_f32 v225, 0x42000000, v162
    v_exp_f32 v224, v224
    v_fract_f32 v225, v225
    v_cos_f32 v176, v225
    v_sin_f32 v177, v225
    v_mul_f32 v176, v224, v176
    v_mul_f32 v177, v224, v177
    v_mul_f32 v224, 0x42800000, v160
    v_mul_f32 v225, 0x42800000, v162
    v_exp_f32 v224, v224
    v_fract_f32 v225, v225
    v_cos_f32 v180, v225
    v_sin_f32 v181, v225
    v_mul_f32 v180, v224, v180
    v_mul_f32 v181, v224, v181
    v_mul_f32 v226, v236, v236
    v_fmac_f32 v226, v238, v238
    v_rcp_f32 v226, v226
    v_add_f32 v227, -1.0, v164
    v_add_f32 v226, v226, v226
    v_mul_f32 v228, v227, v236
    v_fmac_f32 v228, v165, v238
    v_mul_f32 v229, v165, v236
    v_fma_f32 v229, -v227, v238, v229
    v_mul_f32 v184, v228, v226
    v_mul_f32 v185, v229, v226
    v_lshlrev_b32 v237, 16, v237
    v_lshlrev_b32 v239, 16, v239
    v_lshlrev_b32 v241, 16, v241
    v_mul_f32 v241, 0x3fb8aa3b, v241
    v_exp_f32 v241, v241
    s_nop 0
    v_cvt_pk_bf16_f32 v241, v241, v241
    v_and_b32 v241, 0xffff0000, v241
    v_mul_f32 v161, v241, v237
    v_mul_f32 v161, 0x3fb8aa3b, v161
    v_mul_f32 v163, v241, v239
    v_mul_f32 v163, 0x3e22f983, v163
    v_mul_f32 v224, 0x3f800000, v161
    v_mul_f32 v225, 0x3f800000, v163
    v_exp_f32 v224, v224
    v_fract_f32 v225, v225
    v_cos_f32 v166, v225
    v_sin_f32 v167, v225
    v_mul_f32 v166, v224, v166
    v_mul_f32 v167, v224, v167
    v_mul_f32 v224, 0x41000000, v161
    v_mul_f32 v225, 0x41000000, v163
    v_exp_f32 v224, v224
    v_fract_f32 v225, v225
    v_cos_f32 v170, v225
    v_sin_f32 v171, v225
    v_mul_f32 v170, v224, v170
    v_mul_f32 v171, v224, v171
    v_mul_f32 v224, 0x41800000, v161
    v_mul_f32 v225, 0x41800000, v163
    v_exp_f32 v224, v224
    v_fract_f32 v225, v225
    v_cos_f32 v174, v225
    v_sin_f32 v175, v225
    v_mul_f32 v174, v224, v174
    v_mul_f32 v175, v224, v175
    v_mul_f32 v224, 0x42000000, v161
    v_mul_f32 v225, 0x42000000, v163
    v_exp_f32 v224, v224
    v_fract_f32 v225, v225
    v_cos_f32 v178, v225
    v_sin_f32 v179, v225
    v_mul_f32 v178, v224, v178
    v_mul_f32 v179, v224, v179
    v_mul_f32 v224, 0x42800000, v161
    v_mul_f32 v225, 0x42800000, v163
    v_exp_f32 v224, v224
    v_fract_f32 v225, v225
    v_cos_f32 v182, v225
    v_sin_f32 v183, v225
    v_mul_f32 v182, v224, v182
    v_mul_f32 v183, v224, v183
    v_mul_f32 v226, v237, v237
    v_fmac_f32 v226, v239, v239
    v_rcp_f32 v226, v226
    v_add_f32 v227, -1.0, v166
    v_add_f32 v226, v226, v226
    v_mul_f32 v228, v227, v237
    v_fmac_f32 v228, v167, v239
    v_mul_f32 v229, v167, v237
    v_fma_f32 v229, -v227, v239, v229
    v_mul_f32 v186, v228, v226
    v_mul_f32 v187, v229, v226
    s_add_u32 s46, s3, 1
    s_sub_u32 s47, s46, 10
    s_min_u32 s46, s46, s47
    s_mul_i32 s47, s46, 128
    s_lshl_b32 s46, s46, 7
    s_add_u32 m0, s40, 53248
    s_nop 0
    buffer_load_dwordx4 v192, s[4:7], s46 offen lds
    s_add_u32 m0, s40, 54272
    s_nop 0
    buffer_load_dwordx4 v193, s[4:7], s46 offen lds
    s_add_u32 m0, s40, 55296
    s_nop 0
    buffer_load_dwordx4 v194, s[4:7], s46 offen lds
    s_add_u32 m0, s40, 56320
    s_nop 0
    buffer_load_dwordx4 v195, s[4:7], s46 offen lds
    s_add_u32 m0, s41, 53248
    s_nop 0
    buffer_load_dwordx4 v196, s[16:19], s47 offen lds
    s_add_u32 m0, s42, 53248
    s_nop 0
    buffer_load_dwordx4 v197, s[20:23], s47 offen lds
    s_waitcnt vmcnt(7) lgkmcnt(0)
    s_barrier
    ds_read_b128 v[96:99], v200 offset:0
    ds_read_b128 v[112:115], v202 offset:0
    ds_read_b128 v[100:103], v200 offset:2048
    ds_read_b128 v[116:119], v202 offset:2048
    ds_read_b128 v[104:107], v200 offset:4096
    ds_read_b128 v[120:123], v202 offset:4096
    ds_read_b128 v[108:111], v200 offset:6144
    ds_read_b128 v[124:127], v202 offset:6144
    s_mov_b64 exec, 0xffff
    ds_read_b32 v222, v220
    s_mov_b64 exec, -1
    v_mov_b32 v80, 0
    v_mov_b32 v84, 0
    v_mov_b32 v88, 0
    v_mov_b32 v92, 0
    s_waitcnt lgkmcnt(0)
    v_mfma_f32_16x16x32_bf16 v[16:19], v[96:99], v[112:115], 0
    ds_read_b128 v[128:131], v201 offset:0
    s_add_u32 s44, s3, 2
    s_sub_u32 s45, s44, 10
    s_min_u32 s44, s44, s45
    s_mul_i32 s45, s44, 128
    s_lshl_b32 s44, s44, 7
    s_add_u32 m0, s40, 106496
    v_mfma_f32_16x16x32_bf16 v[32:35], v[100:103], v[112:115], 0
    ds_read_b128 v[144:147], v203 offset:0
    buffer_load_dwordx4 v192, s[4:7], s44 offen lds
    v_mfma_f32_16x16x32_bf16 v[48:51], v[104:107], v[112:115], 0
    ds_read_b128 v[132:135], v201 offset:2048
    v_mfma_f32_16x16x32_bf16 v[64:67], v[108:111], v[112:115], 0
    ds_read_b128 v[148:151], v203 offset:2048
    s_add_u32 m0, s40, 107520
    v_mfma_f32_16x16x32_bf16 v[20:23], v[96:99], v[116:119], 0
    ds_read_b128 v[136:139], v201 offset:4096
    buffer_load_dwordx4 v193, s[4:7], s44 offen lds
    v_mfma_f32_16x16x32_bf16 v[36:39], v[100:103], v[116:119], 0
    ds_read_b128 v[152:155], v203 offset:4096
    s_add_u32 m0, s40, 108544
    v_mfma_f32_16x16x32_bf16 v[52:55], v[104:107], v[116:119], 0
    ds_read_b128 v[140:143], v201 offset:6144
    buffer_load_dwordx4 v194, s[4:7], s44 offen lds
    v_mfma_f32_16x16x32_bf16 v[68:71], v[108:111], v[116:119], 0
    ds_read_b128 v[156:159], v203 offset:6144
    v_mfma_f32_16x16x32_bf16 v[24:27], v[96:99], v[120:123], 0
    s_add_u32 m0, s40, 109568
    v_mfma_f32_16x16x32_bf16 v[40:43], v[100:103], v[120:123], 0
    buffer_load_dwordx4 v195, s[4:7], s44 offen lds
    v_mfma_f32_16x16x32_bf16 v[56:59], v[104:107], v[120:123], 0
    v_mfma_f32_16x16x32_bf16 v[72:75], v[108:111], v[120:123], 0
    s_add_u32 m0, s41, 106496
    v_mfma_f32_16x16x32_bf16 v[28:31], v[96:99], v[124:127], 0
    buffer_load_dwordx4 v196, s[16:19], s45 offen lds
    v_mfma_f32_16x16x32_bf16 v[44:47], v[100:103], v[124:127], 0
    s_add_u32 m0, s42, 106496
    v_mfma_f32_16x16x32_bf16 v[60:63], v[104:107], v[124:127], 0
    buffer_load_dwordx4 v197, s[20:23], s45 offen lds
    v_mfma_f32_16x16x32_bf16 v[76:79], v[108:111], v[124:127], 0
    s_cmp_lg_u32 s96, 0
    s_cbranch_scc1 Lskip_24
    v_mfma_f32_16x16x32_bf16 v[80:83], v[188:191], v[112:115], 0
    v_mfma_f32_16x16x32_bf16 v[84:87], v[188:191], v[116:119], 0
    v_mfma_f32_16x16x32_bf16 v[88:91], v[188:191], v[120:123], 0
    v_mfma_f32_16x16x32_bf16 v[92:95], v[188:191], v[124:127], 0
Lskip_24:
    s_waitcnt vmcnt(6) lgkmcnt(0)
    s_barrier
    s_mov_b32 exec_hi, 0xff
    buffer_store_dword v222, v221, s[8:11], s63 offen sc1
    s_mov_b64 exec, -1
    v_mfma_f32_16x16x32_bf16 v[16:19], v[128:131], v[144:147], v[16:19]
    ds_read_b128 v[96:99], v204 offset:0
    v_mfma_f32_16x16x32_bf16 v[32:35], v[132:135], v[144:147], v[32:35]
    ds_read_b128 v[112:115], v206 offset:0
    v_mfma_f32_16x16x32_bf16 v[48:51], v[136:139], v[144:147], v[48:51]
    ds_read_b128 v[100:103], v204 offset:2048
    s_add_u32 s46, s3, 3
    s_sub_u32 s47, s46, 10
    s_min_u32 s46, s46, s47
    s_mul_i32 s47, s46, 128
    s_lshl_b32 s46, s46, 7
    s_add_u32 m0, s40, 0
    v_mfma_f32_16x16x32_bf16 v[64:67], v[140:143], v[144:147], v[64:67]
    ds_read_b128 v[116:119], v206 offset:2048
    buffer_load_dwordx4 v192, s[4:7], s46 offen lds
    v_mfma_f32_16x16x32_bf16 v[20:23], v[128:131], v[148:151], v[20:23]
    ds_read_b128 v[104:107], v204 offset:4096
    v_mfma_f32_16x16x32_bf16 v[36:39], v[132:135], v[148:151], v[36:39]
    ds_read_b128 v[120:123], v206 offset:4096
    v_mfma_f32_16x16x32_bf16 v[52:55], v[136:139], v[148:151], v[52:55]
    ds_read_b128 v[108:111], v204 offset:6144
    v_mfma_f32_16x16x32_bf16 v[68:71], v[140:143], v[148:151], v[68:71]
    ds_read_b128 v[124:127], v206 offset:6144
    s_add_u32 m0, s40, 1024
    v_mfma_f32_16x16x32_bf16 v[24:27], v[128:131], v[152:155], v[24:27]
    buffer_load_dwordx4 v193, s[4:7], s46 offen lds
    v_mfma_f32_16x16x32_bf16 v[40:43], v[132:135], v[152:155], v[40:43]
    v_mfma_f32_16x16x32_bf16 v[56:59], v[136:139], v[152:155], v[56:59]
    v_mfma_f32_16x16x32_bf16 v[72:75], v[140:143], v[152:155], v[72:75]
    v_mfma_f32_16x16x32_bf16 v[28:31], v[128:131], v[156:159], v[28:31]
    s_add_u32 m0, s40, 2048
    v_mfma_f32_16x16x32_bf16 v[44:47], v[132:135], v[156:159], v[44:47]
    buffer_load_dwordx4 v194, s[4:7], s46 offen lds
    v_mfma_f32_16x16x32_bf16 v[60:63], v[136:139], v[156:159], v[60:63]
    v_mfma_f32_16x16x32_bf16 v[76:79], v[140:143], v[156:159], v[76:79]
    s_cmp_lg_u32 s96, 0
    s_cbranch_scc1 Lskip_25
    v_mfma_f32_16x16x32_bf16 v[80:83], v[188:191], v[144:147], v[80:83]
    v_mfma_f32_16x16x32_bf16 v[84:87], v[188:191], v[148:151], v[84:87]
    v_mfma_f32_16x16x32_bf16 v[88:91], v[188:191], v[152:155], v[88:91]
    v_mfma_f32_16x16x32_bf16 v[92:95], v[188:191], v[156:159], v[92:95]
Lskip_25:
    s_waitcnt lgkmcnt(0)
    v_mfma_f32_16x16x32_bf16 v[16:19], v[96:99], v[112:115], v[16:19]
    ds_read_b128 v[128:131], v205 offset:0
    v_mfma_f32_16x16x32_bf16 v[32:35], v[100:103], v[112:115], v[32:35]
    ds_read_b128 v[144:147], v207 offset:0
    v_mfma_f32_16x16x32_bf16 v[48:51], v[104:107], v[112:115], v[48:51]
    ds_read_b128 v[132:135], v205 offset:2048
    s_add_u32 m0, s40, 3072
    v_mfma_f32_16x16x32_bf16 v[64:67], v[108:111], v[112:115], v[64:67]
    ds_read_b128 v[148:151], v207 offset:2048
    buffer_load_dwordx4 v195, s[4:7], s46 offen lds
    v_mfma_f32_16x16x32_bf16 v[20:23], v[96:99], v[116:119], v[20:23]
    ds_read_b128 v[136:139], v205 offset:4096
    v_mfma_f32_16x16x32_bf16 v[36:39], v[100:103], v[116:119], v[36:39]
    ds_read_b128 v[152:155], v207 offset:4096
    v_mfma_f32_16x16x32_bf16 v[52:55], v[104:107], v[116:119], v[52:55]
    ds_read_b128 v[140:143], v205 offset:6144
    v_mfma_f32_16x16x32_bf16 v[68:71], v[108:111], v[116:119], v[68:71]
    ds_read_b128 v[156:159], v207 offset:6144
    s_add_u32 m0, s41, 0
    v_mfma_f32_16x16x32_bf16 v[24:27], v[96:99], v[120:123], v[24:27]
    buffer_load_dwordx4 v196, s[16:19], s47 offen lds
    v_mfma_f32_16x16x32_bf16 v[40:43], v[100:103], v[120:123], v[40:43]
    v_mfma_f32_16x16x32_bf16 v[56:59], v[104:107], v[120:123], v[56:59]
    v_mfma_f32_16x16x32_bf16 v[72:75], v[108:111], v[120:123], v[72:75]
    v_mfma_f32_16x16x32_bf16 v[28:31], v[96:99], v[124:127], v[28:31]
    s_add_u32 m0, s42, 0
    v_mfma_f32_16x16x32_bf16 v[44:47], v[100:103], v[124:127], v[44:47]
    buffer_load_dwordx4 v197, s[20:23], s47 offen lds
    v_mfma_f32_16x16x32_bf16 v[60:63], v[104:107], v[124:127], v[60:63]
    v_mfma_f32_16x16x32_bf16 v[76:79], v[108:111], v[124:127], v[76:79]
    s_cmp_lg_u32 s96, 1
    s_cbranch_scc1 Lskip_26
    v_mfma_f32_16x16x32_bf16 v[80:83], v[188:191], v[112:115], 0
    v_mfma_f32_16x16x32_bf16 v[84:87], v[188:191], v[116:119], 0
    v_mfma_f32_16x16x32_bf16 v[88:91], v[188:191], v[120:123], 0
    v_mfma_f32_16x16x32_bf16 v[92:95], v[188:191], v[124:127], 0
Lskip_26:
    s_waitcnt vmcnt(6)
    s_waitcnt lgkmcnt(0)
    s_barrier
    s_lshr_b32 s63, s53, 1
    s_and_b32 s63, s63, 0xfc
    s_cmp_eq_u32 s32, 0
    s_cselect_b32 s63, s63, 0x1000
    v_mov_b32 v2, 1
    s_mov_b64 exec, 1
    buffer_atomic_add v2, off, s[12:15], s63 sc1
    s_mov_b64 exec, -1
    buffer_load_dwordx4 v[244:247], v234, s[28:31], s54 offen nt
    buffer_load_dwordx4 v[248:251], v235, s[56:59], s55 offen nt
    v_mfma_f32_16x16x32_bf16 v[16:19], v[128:131], v[144:147], v[16:19]
    ds_read_b128 v[96:99], v208 offset:0
    v_mfma_f32_16x16x32_bf16 v[32:35], v[132:135], v[144:147], v[32:35]
    ds_read_b128 v[112:115], v210 offset:0
    v_mfma_f32_16x16x32_bf16 v[48:51], v[136:139], v[144:147], v[48:51]
    ds_read_b128 v[100:103], v208 offset:2048
    s_add_u32 s44, s3, 4
    s_sub_u32 s45, s44, 10
    s_min_u32 s44, s44, s45
    s_mul_i32 s45, s44, 128
    s_lshl_b32 s44, s44, 7
    s_add_u32 m0, s40, 53248
    v_mfma_f32_16x16x32_bf16 v[64:67], v[140:143], v[144:147], v[64:67]
    ds_read_b128 v[116:119], v210 offset:2048
    buffer_load_dwordx4 v192, s[4:7], s44 offen lds
    v_mfma_f32_16x16x32_bf16 v[20:23], v[128:131], v[148:151], v[20:23]
    ds_read_b128 v[104:107], v208 offset:4096
    v_mfma_f32_16x16x32_bf16 v[36:39], v[132:135], v[148:151], v[36:39]
    ds_read_b128 v[120:123], v210 offset:4096
    v_mfma_f32_16x16x32_bf16 v[52:55], v[136:139], v[148:151], v[52:55]
    ds_read_b128 v[108:111], v208 offset:6144
    v_mfma_f32_16x16x32_bf16 v[68:71], v[140:143], v[148:151], v[68:71]
    ds_read_b128 v[124:127], v210 offset:6144
    s_add_u32 m0, s40, 54272
    v_mfma_f32_16x16x32_bf16 v[24:27], v[128:131], v[152:155], v[24:27]
    buffer_load_dwordx4 v193, s[4:7], s44 offen lds
    v_mfma_f32_16x16x32_bf16 v[40:43], v[132:135], v[152:155], v[40:43]
    v_mfma_f32_16x16x32_bf16 v[56:59], v[136:139], v[152:155], v[56:59]
    v_mfma_f32_16x16x32_bf16 v[72:75], v[140:143], v[152:155], v[72:75]
    v_mfma_f32_16x16x32_bf16 v[28:31], v[128:131], v[156:159], v[28:31]
    s_add_u32 m0, s40, 55296
    v_mfma_f32_16x16x32_bf16 v[44:47], v[132:135], v[156:159], v[44:47]
    buffer_load_dwordx4 v194, s[4:7], s44 offen lds
    v_mfma_f32_16x16x32_bf16 v[60:63], v[136:139], v[156:159], v[60:63]
    v_mfma_f32_16x16x32_bf16 v[76:79], v[140:143], v[156:159], v[76:79]
    s_cmp_lg_u32 s96, 1
    s_cbranch_scc1 Lskip_27
    v_mfma_f32_16x16x32_bf16 v[80:83], v[188:191], v[144:147], v[80:83]
    v_mfma_f32_16x16x32_bf16 v[84:87], v[188:191], v[148:151], v[84:87]
    v_mfma_f32_16x16x32_bf16 v[88:91], v[188:191], v[152:155], v[88:91]
    v_mfma_f32_16x16x32_bf16 v[92:95], v[188:191], v[156:159], v[92:95]
Lskip_27:
    s_waitcnt lgkmcnt(0)
    v_mfma_f32_16x16x32_bf16 v[16:19], v[96:99], v[112:115], v[16:19]
    ds_read_b128 v[128:131], v209 offset:0
    s_nop 1
    v_mov_b32 v232, v80
    v_cmp_eq_u32 vcc, 1, v4
    s_nop 1
    v_cndmask_b32 v232, v232, v84, vcc
    v_mfma_f32_16x16x32_bf16 v[32:35], v[100:103], v[112:115], v[32:35]
    ds_read_b128 v[144:147], v211 offset:0
    v_cmp_eq_u32 vcc, 2, v4
    s_nop 1
    v_cndmask_b32 v232, v232, v88, vcc
    v_mfma_f32_16x16x32_bf16 v[48:51], v[104:107], v[112:115], v[48:51]
    ds_read_b128 v[132:135], v209 offset:2048
    v_cmp_eq_u32 vcc, 3, v4
    s_nop 1
    v_cndmask_b32 v232, v232, v92, vcc
    s_add_u32 m0, s40, 56320
    v_mfma_f32_16x16x32_bf16 v[64:67], v[108:111], v[112:115], v[64:67]
    ds_read_b128 v[148:151], v211 offset:2048
    buffer_load_dwordx4 v195, s[4:7], s44 offen lds
    v_mfma_f32_16x16x32_bf16 v[20:23], v[96:99], v[116:119], v[20:23]
    ds_read_b128 v[136:139], v209 offset:4096
    v_cvt_pk_bf16_f32 v14, v232, v232
    v_lshlrev_b32 v14, 16, v14
    v_sub_f32 v14, v232, v14
    v_mfma_f32_16x16x32_bf16 v[36:39], v[100:103], v[116:119], v[36:39]
    ds_read_b128 v[152:155], v211 offset:4096
    v_cvt_pk_bf16_f32 v232, v232, v14
    v_lshlrev_b32 v15, 4, v3
    v_lshl_add_u32 v15, v4, 10, v15
    v_mfma_f32_16x16x32_bf16 v[52:55], v[104:107], v[116:119], v[52:55]
    ds_read_b128 v[140:143], v209 offset:6144
    s_bfe_u32 s60, s53, 0x50003
    s_lshl_b32 s60, s60, 1
    s_add_u32 s60, s60, s34
    v_mfma_f32_16x16x32_bf16 v[68:71], v[108:111], v[116:119], v[68:71]
    ds_read_b128 v[156:159], v211 offset:6144
    s_mul_i32 s60, s60, 5120
    s_add_u32 s60, s60, 262144
    s_add_u32 s61, s3, 1
    s_cmp_eq_u32 s61, 10
    s_cselect_b32 s61, 0, s61
    s_and_b32 s62, s35, 5
    s_cmp_eq_u32 s62, 4
    s_cselect_b32 s61, s61, 16
    s_cmp_eq_u32 s96, 0
    s_cselect_b32 s61, s3, s61
    s_add_u32 s62, s35, 10
    s_cmp_eq_u32 s96, 2
    s_cselect_b32 s61, s62, s61
    s_cmp_eq_u32 s96, 3
    s_cselect_b32 s61, 16, s61
    s_cmp_ge_u32 s61, 16
    s_cselect_b32 s60, 30408704, s60
    s_lshr_b32 s62, s61, 2
    s_lshl_b32 s62, s62, 8
    s_add_u32 s60, s60, s62
    s_and_b32 s62, s61, 3
    s_lshl_b32 s62, s62, 2
    s_add_u32 s60, s60, s62
    buffer_store_dword v232, v15, s[8:11], s60 offen sc1
    s_add_u32 m0, s41, 53248
    v_mfma_f32_16x16x32_bf16 v[24:27], v[96:99], v[120:123], v[24:27]
    buffer_load_dwordx4 v196, s[16:19], s45 offen lds
    v_mfma_f32_16x16x32_bf16 v[40:43], v[100:103], v[120:123], v[40:43]
    v_mfma_f32_16x16x32_bf16 v[56:59], v[104:107], v[120:123], v[56:59]
    v_mfma_f32_16x16x32_bf16 v[72:75], v[108:111], v[120:123], v[72:75]
    v_mfma_f32_16x16x32_bf16 v[28:31], v[96:99], v[124:127], v[28:31]
    s_add_u32 m0, s42, 53248
    v_mfma_f32_16x16x32_bf16 v[44:47], v[100:103], v[124:127], v[44:47]
    buffer_load_dwordx4 v197, s[20:23], s45 offen lds
    v_mfma_f32_16x16x32_bf16 v[60:63], v[104:107], v[124:127], v[60:63]
    v_mfma_f32_16x16x32_bf16 v[76:79], v[108:111], v[124:127], v[76:79]
    s_waitcnt vmcnt(10) lgkmcnt(0)
    s_barrier
    v_mfma_f32_16x16x32_bf16 v[16:19], v[128:131], v[144:147], v[16:19]
    ds_read_b128 v[96:99], v200 offset:0
    v_mfma_f32_16x16x32_bf16 v[32:35], v[132:135], v[144:147], v[32:35]
    ds_read_b128 v[112:115], v202 offset:0
    v_mfma_f32_16x16x32_bf16 v[48:51], v[136:139], v[144:147], v[48:51]
    ds_read_b128 v[100:103], v200 offset:2048
    s_add_u32 s46, s3, 5
    s_sub_u32 s47, s46, 10
    s_min_u32 s46, s46, s47
    s_mul_i32 s47, s46, 128
    s_lshl_b32 s46, s46, 7
    s_add_u32 m0, s40, 106496
    v_mfma_f32_16x16x32_bf16 v[64:67], v[140:143], v[144:147], v[64:67]
    ds_read_b128 v[116:119], v202 offset:2048
    buffer_load_dwordx4 v192, s[4:7], s46 offen lds
    v_mfma_f32_16x16x32_bf16 v[20:23], v[128:131], v[148:151], v[20:23]
    ds_read_b128 v[104:107], v200 offset:4096
    v_mfma_f32_16x16x32_bf16 v[36:39], v[132:135], v[148:151], v[36:39]
    ds_read_b128 v[120:123], v202 offset:4096
    v_mfma_f32_16x16x32_bf16 v[52:55], v[136:139], v[148:151], v[52:55]
    ds_read_b128 v[108:111], v200 offset:6144
    v_mfma_f32_16x16x32_bf16 v[68:71], v[140:143], v[148:151], v[68:71]
    ds_read_b128 v[124:127], v202 offset:6144
    s_add_u32 m0, s40, 107520
    v_mfma_f32_16x16x32_bf16 v[24:27], v[128:131], v[152:155], v[24:27]
    buffer_load_dwordx4 v193, s[4:7], s46 offen lds
    v_mfma_f32_16x16x32_bf16 v[40:43], v[132:135], v[152:155], v[40:43]
    v_mfma_f32_16x16x32_bf16 v[56:59], v[136:139], v[152:155], v[56:59]
    v_mfma_f32_16x16x32_bf16 v[72:75], v[140:143], v[152:155], v[72:75]
    v_mfma_f32_16x16x32_bf16 v[28:31], v[128:131], v[156:159], v[28:31]
    s_add_u32 m0, s40, 108544
    v_mfma_f32_16x16x32_bf16 v[44:47], v[132:135], v[156:159], v[44:47]
    buffer_load_dwordx4 v194, s[4:7], s46 offen lds
    v_mfma_f32_16x16x32_bf16 v[60:63], v[136:139], v[156:159], v[60:63]
    v_mfma_f32_16x16x32_bf16 v[76:79], v[140:143], v[156:159], v[76:79]
    s_waitcnt lgkmcnt(0)
    v_mfma_f32_16x16x32_bf16 v[16:19], v[96:99], v[112:115], v[16:19]
    ds_read_b128 v[128:131], v201 offset:0
    v_mfma_f32_16x16x32_bf16 v[32:35], v[100:103], v[112:115], v[32:35]
    ds_read_b128 v[144:147], v203 offset:0
    v_mfma_f32_16x16x32_bf16 v[48:51], v[104:107], v[112:115], v[48:51]
    ds_read_b128 v[132:135], v201 offset:2048
    s_add_u32 m0, s40, 109568
    v_mfma_f32_16x16x32_bf16 v[64:67], v[108:111], v[112:115], v[64:67]
    ds_read_b128 v[148:151], v203 offset:2048
    buffer_load_dwordx4 v195, s[4:7], s46 offen lds
    v_mfma_f32_16x16x32_bf16 v[20:23], v[96:99], v[116:119], v[20:23]
    ds_read_b128 v[136:139], v201 offset:4096
    v_mfma_f32_16x16x32_bf16 v[36:39], v[100:103], v[116:119], v[36:39]
    ds_read_b128 v[152:155], v203 offset:4096
    v_mfma_f32_16x16x32_bf16 v[52:55], v[104:107], v[116:119], v[52:55]
    ds_read_b128 v[140:143], v201 offset:6144
    v_mfma_f32_16x16x32_bf16 v[68:71], v[108:111], v[116:119], v[68:71]
    ds_read_b128 v[156:159], v203 offset:6144
    s_add_u32 m0, s41, 106496
    v_mfma_f32_16x16x32_bf16 v[24:27], v[96:99], v[120:123], v[24:27]
    buffer_load_dwordx4 v196, s[16:19], s47 offen lds
    v_mfma_f32_16x16x32_bf16 v[40:43], v[100:103], v[120:123], v[40:43]
    v_mfma_f32_16x16x32_bf16 v[56:59], v[104:107], v[120:123], v[56:59]
    v_mfma_f32_16x16x32_bf16 v[72:75], v[108:111], v[120:123], v[72:75]
    v_mfma_f32_16x16x32_bf16 v[28:31], v[96:99], v[124:127], v[28:31]
    s_add_u32 m0, s42, 106496
    v_mfma_f32_16x16x32_bf16 v[44:47], v[100:103], v[124:127], v[44:47]
    buffer_load_dwordx4 v197, s[20:23], s47 offen lds
    v_mfma_f32_16x16x32_bf16 v[60:63], v[104:107], v[124:127], v[60:63]
    v_mfma_f32_16x16x32_bf16 v[76:79], v[108:111], v[124:127], v[76:79]
    s_waitcnt vmcnt(6) lgkmcnt(0)
    s_barrier
    buffer_store_dwordx4 v[244:247], v242, s[8:11], 0 offen sc1
    buffer_store_dwordx4 v[248:251], v243, s[8:11], 0 offen sc1
    v_mfma_f32_16x16x32_bf16 v[16:19], v[128:131], v[144:147], v[16:19]
    ds_read_b128 v[96:99], v204 offset:0
    v_mfma_f32_16x16x32_bf16 v[32:35], v[132:135], v[144:147], v[32:35]
    ds_read_b128 v[112:115], v206 offset:0
    v_mfma_f32_16x16x32_bf16 v[48:51], v[136:139], v[144:147], v[48:51]
    ds_read_b128 v[100:103], v204 offset:2048
    s_add_u32 s44, s3, 6
    s_sub_u32 s45, s44, 10
    s_min_u32 s44, s44, s45
    s_mul_i32 s45, s44, 128
    s_lshl_b32 s44, s44, 7
    s_add_u32 m0, s40, 0
    v_mfma_f32_16x16x32_bf16 v[64:67], v[140:143], v[144:147], v[64:67]
    ds_read_b128 v[116:119], v206 offset:2048
    buffer_load_dwordx4 v192, s[4:7], s44 offen lds
    v_mfma_f32_16x16x32_bf16 v[20:23], v[128:131], v[148:151], v[20:23]
    ds_read_b128 v[104:107], v204 offset:4096
    v_mfma_f32_16x16x32_bf16 v[36:39], v[132:135], v[148:151], v[36:39]
    ds_read_b128 v[120:123], v206 offset:4096
    v_mfma_f32_16x16x32_bf16 v[52:55], v[136:139], v[148:151], v[52:55]
    ds_read_b128 v[108:111], v204 offset:6144
    v_mfma_f32_16x16x32_bf16 v[68:71], v[140:143], v[148:151], v[68:71]
    ds_read_b128 v[124:127], v206 offset:6144
    s_add_u32 m0, s40, 1024
    v_mfma_f32_16x16x32_bf16 v[24:27], v[128:131], v[152:155], v[24:27]
    buffer_load_dwordx4 v193, s[4:7], s44 offen lds
    v_mfma_f32_16x16x32_bf16 v[40:43], v[132:135], v[152:155], v[40:43]
    v_mfma_f32_16x16x32_bf16 v[56:59], v[136:139], v[152:155], v[56:59]
    v_mfma_f32_16x16x32_bf16 v[72:75], v[140:143], v[152:155], v[72:75]
    v_mfma_f32_16x16x32_bf16 v[28:31], v[128:131], v[156:159], v[28:31]
    s_add_u32 m0, s40, 2048
    v_mfma_f32_16x16x32_bf16 v[44:47], v[132:135], v[156:159], v[44:47]
    buffer_load_dwordx4 v194, s[4:7], s44 offen lds
    v_mfma_f32_16x16x32_bf16 v[60:63], v[136:139], v[156:159], v[60:63]
    v_mfma_f32_16x16x32_bf16 v[76:79], v[140:143], v[156:159], v[76:79]
    s_waitcnt lgkmcnt(0)
    v_mfma_f32_16x16x32_bf16 v[16:19], v[96:99], v[112:115], v[16:19]
    ds_read_b128 v[128:131], v205 offset:0
    v_mfma_f32_16x16x32_bf16 v[32:35], v[100:103], v[112:115], v[32:35]
    ds_read_b128 v[144:147], v207 offset:0
    v_mfma_f32_16x16x32_bf16 v[48:51], v[104:107], v[112:115], v[48:51]
    ds_read_b128 v[132:135], v205 offset:2048
    s_add_u32 m0, s40, 3072
    v_mfma_f32_16x16x32_bf16 v[64:67], v[108:111], v[112:115], v[64:67]
    ds_read_b128 v[148:151], v207 offset:2048
    buffer_load_dwordx4 v195, s[4:7], s44 offen lds
    v_mfma_f32_16x16x32_bf16 v[20:23], v[96:99], v[116:119], v[20:23]
    ds_read_b128 v[136:139], v205 offset:4096
    v_mfma_f32_16x16x32_bf16 v[36:39], v[100:103], v[116:119], v[36:39]
    ds_read_b128 v[152:155], v207 offset:4096
    v_mfma_f32_16x16x32_bf16 v[52:55], v[104:107], v[116:119], v[52:55]
    ds_read_b128 v[140:143], v205 offset:6144
    v_mfma_f32_16x16x32_bf16 v[68:71], v[108:111], v[116:119], v[68:71]
    ds_read_b128 v[156:159], v207 offset:6144
    s_add_u32 m0, s41, 0
    v_mfma_f32_16x16x32_bf16 v[24:27], v[96:99], v[120:123], v[24:27]
    buffer_load_dwordx4 v196, s[16:19], s45 offen lds
    v_mfma_f32_16x16x32_bf16 v[40:43], v[100:103], v[120:123], v[40:43]
    v_mfma_f32_16x16x32_bf16 v[56:59], v[104:107], v[120:123], v[56:59]
    v_mfma_f32_16x16x32_bf16 v[72:75], v[108:111], v[120:123], v[72:75]
    v_mfma_f32_16x16x32_bf16 v[28:31], v[96:99], v[124:127], v[28:31]
    s_add_u32 m0, s42, 0
    v_mfma_f32_16x16x32_bf16 v[44:47], v[100:103], v[124:127], v[44:47]
    buffer_load_dwordx4 v197, s[20:23], s45 offen lds
    v_mfma_f32_16x16x32_bf16 v[60:63], v[104:107], v[124:127], v[60:63]
    v_mfma_f32_16x16x32_bf16 v[76:79], v[108:111], v[124:127], v[76:79]
    s_waitcnt vmcnt(6)
    s_waitcnt lgkmcnt(0)
    s_barrier
    s_lshl_b32 s63, s53, 4
    s_add_u32 s63, s63, 196608
    s_cmp_eq_u32 s32, 0
    s_cselect_b32 s63, s63, 30408704
    v_mov_b32 v2, 4
    s_mov_b64 exec, 1
    buffer_store_dword v2, off, s[8:11], s63 sc1
    s_mov_b64 exec, -1
    v_mfma_f32_16x16x32_bf16 v[16:19], v[128:131], v[144:147], v[16:19]
    ds_read_b128 v[96:99], v208 offset:0
    s_and_b32 s28, s38, 3
    s_lshl_b32 s28, s28, 2
    v_mfma_f32_16x16x32_bf16 v[32:35], v[132:135], v[144:147], v[32:35]
    ds_read_b128 v[112:115], v210 offset:0
    s_and_b32 s60, s39, 3
    s_add_u32 s28, s28, s60
    v_mfma_f32_16x16x32_bf16 v[48:51], v[136:139], v[144:147], v[48:51]
    ds_read_b128 v[100:103], v208 offset:2048
    s_lshr_b32 s29, s39, 2
    s_cmp_ge_u32 s38, 4
    s_cselect_b32 s60, 20, 27
    s_cselect_b32 s61, 2211840, 0
    s_cselect_b32 s97, 8, 0
    s_cselect_b64 s[58:59], -1, 0
    s_add_u32 s46, s3, 7
    s_sub_u32 s47, s46, 10
    s_min_u32 s46, s46, s47
    s_mul_i32 s47, s46, 128
    s_lshl_b32 s46, s46, 7
    s_add_u32 m0, s40, 53248
    v_mfma_f32_16x16x32_bf16 v[64:67], v[140:143], v[144:147], v[64:67]
    ds_read_b128 v[116:119], v210 offset:2048
    buffer_load_dwordx4 v192, s[4:7], s46 offen lds
    v_mfma_f32_16x16x32_bf16 v[20:23], v[128:131], v[148:151], v[20:23]
    ds_read_b128 v[104:107], v208 offset:4096
    s_add_u32 s97, s97, s32
    s_mul_i32 s31, s60, 10240
    v_mfma_f32_16x16x32_bf16 v[36:39], v[132:135], v[148:151], v[36:39]
    ds_read_b128 v[120:123], v210 offset:4096
    s_mul_i32 s62, s29, s31
    s_add_u32 s61, s61, s62
    v_mfma_f32_16x16x32_bf16 v[52:55], v[136:139], v[148:151], v[52:55]
    ds_read_b128 v[108:111], v208 offset:6144
    s_mul_i32 s62, s29, 5
    s_lshr_b32 s62, s62, 2
    v_mfma_f32_16x16x32_bf16 v[68:71], v[140:143], v[148:151], v[68:71]
    ds_read_b128 v[124:127], v210 offset:6144
    s_mul_i32 s62, s62, 27
    s_min_u32 s62, s62, 200
    s_add_u32 m0, s40, 54272
    v_mfma_f32_16x16x32_bf16 v[24:27], v[128:131], v[152:155], v[24:27]
    buffer_load_dwordx4 v193, s[4:7], s46 offen lds
    v_mfma_f32_16x16x32_bf16 v[40:43], v[132:135], v[152:155], v[40:43]
    v_min_u32 v13, 55, v1
    v_add_u32 v13, s62, v13
    v_mfma_f32_16x16x32_bf16 v[56:59], v[136:139], v[152:155], v[56:59]
    s_mul_i32 s62, s29, 25
    v_min_u32 v14, 24, v1
    v_mfma_f32_16x16x32_bf16 v[72:75], v[140:143], v[152:155], v[72:75]
    v_add_u32 v14, s62, v14
    s_lshr_b32 s62, s53, 3
    v_mfma_f32_16x16x32_bf16 v[28:31], v[128:131], v[156:159], v[28:31]
    s_sub_u32 s62, s62, 16
    v_writelane_b32 v14, s62, 55
    s_add_u32 m0, s40, 55296
    v_mfma_f32_16x16x32_bf16 v[44:47], v[132:135], v[156:159], v[44:47]
    buffer_load_dwordx4 v194, s[4:7], s46 offen lds
    v_mfma_f32_16x16x32_bf16 v[60:63], v[136:139], v[156:159], v[60:63]
    v_cndmask_b32 v13, v13, v14, s[58:59]
    s_bfe_u32 s62, s53, 0x50003
    v_mfma_f32_16x16x32_bf16 v[76:79], v[140:143], v[156:159], v[76:79]
    v_and_b32 v14, 7, v1
    v_lshl_add_u32 v14, v14, 5, s62
    s_waitcnt lgkmcnt(0)
    v_mfma_f32_16x16x32_bf16 v[16:19], v[96:99], v[112:115], v[16:19]
    ds_read_b128 v[128:131], v209 offset:0
    v_cmp_lt_u32 vcc, 55, v1
    s_nop 1
    v_cndmask_b32 v13, v13, v14, vcc
    v_mfma_f32_16x16x32_bf16 v[32:35], v[100:103], v[112:115], v[32:35]
    ds_read_b128 v[144:147], v211 offset:0
    v_lshlrev_b32 v13, 7, v13
    v_add_u32 v13, 196608, v13
    v_mfma_f32_16x16x32_bf16 v[48:51], v[104:107], v[112:115], v[48:51]
    ds_read_b128 v[132:135], v209 offset:2048
    s_add_u32 s61, s61, 1048576
    v_add_u32 v247, s61, v5
    s_add_u32 m0, s40, 56320
    v_mfma_f32_16x16x32_bf16 v[64:67], v[108:111], v[112:115], v[64:67]
    ds_read_b128 v[148:151], v211 offset:2048
    buffer_load_dwordx4 v195, s[4:7], s46 offen lds
    v_mfma_f32_16x16x32_bf16 v[20:23], v[96:99], v[116:119], v[20:23]
    ds_read_b128 v[136:139], v209 offset:4096
    s_and_b32 s62, s39, 3
    s_lshl_b32 s62, s62, 1
    v_mfma_f32_16x16x32_bf16 v[36:39], v[100:103], v[116:119], v[36:39]
    ds_read_b128 v[152:155], v211 offset:4096
    s_add_u32 s62, s62, s29
    s_and_b32 s62, s62, 7
    v_mfma_f32_16x16x32_bf16 v[52:55], v[104:107], v[116:119], v[52:55]
    ds_read_b128 v[140:143], v209 offset:6144
    s_mul_i32 s62, s62, s60
    s_lshr_b32 s62, s62, 3
    v_mfma_f32_16x16x32_bf16 v[68:71], v[108:111], v[116:119], v[68:71]
    ds_read_b128 v[156:159], v211 offset:6144
    s_mov_b32 s62, 0
    s_lshl_b32 s54, s62, 11
    s_add_u32 m0, s41, 53248
    v_mfma_f32_16x16x32_bf16 v[24:27], v[96:99], v[120:123], v[24:27]
    buffer_load_dwordx4 v196, s[16:19], s47 offen lds
    v_mfma_f32_16x16x32_bf16 v[40:43], v[100:103], v[120:123], v[40:43]
    s_mul_i32 s30, s62, 10240
    s_lshl_b32 s62, s32, 10
    v_mfma_f32_16x16x32_bf16 v[56:59], v[104:107], v[120:123], v[56:59]
    s_add_u32 s30, s30, s62
    v_mfma_f32_16x16x32_bf16 v[72:75], v[108:111], v[120:123], v[72:75]
    v_lshlrev_b32 v198, 4, v4
    v_cvt_f32_u32 v199, v198
    v_mul_f32 v228, v199, v160
    v_mfma_f32_16x16x32_bf16 v[28:31], v[96:99], v[124:127], v[28:31]
    v_mul_f32 v229, v199, v162
    v_exp_f32 v228, v228
    v_fract_f32 v229, v229
    s_add_u32 m0, s42, 53248
    v_mfma_f32_16x16x32_bf16 v[44:47], v[100:103], v[124:127], v[44:47]
    buffer_load_dwordx4 v197, s[20:23], s47 offen lds
    v_mfma_f32_16x16x32_bf16 v[60:63], v[104:107], v[124:127], v[60:63]
    v_cos_f32 v224, v229
    v_sin_f32 v225, v229
    v_mul_f32 v224, v228, v224
    v_mfma_f32_16x16x32_bf16 v[76:79], v[108:111], v[124:127], v[76:79]
    v_mul_f32 v225, v228, v225
    v_mul_f32 v228, v199, v161
    v_mul_f32 v229, v199, v163
    s_waitcnt vmcnt(7) lgkmcnt(0)
    s_barrier
    v_mfma_f32_16x16x32_bf16 v[16:19], v[128:131], v[144:147], v[16:19]
    ds_read_b128 v[96:99], v200 offset:0
    v_exp_f32 v228, v228
    v_fract_f32 v229, v229
    v_cos_f32 v226, v229
    v_mfma_f32_16x16x32_bf16 v[32:35], v[132:135], v[144:147], v[32:35]
    ds_read_b128 v[112:115], v202 offset:0
    v_sin_f32 v227, v229
    v_mul_f32 v226, v228, v226
    v_mul_f32 v227, v228, v227
    v_mfma_f32_16x16x32_bf16 v[48:51], v[136:139], v[144:147], v[48:51]
    ds_read_b128 v[100:103], v200 offset:2048
    v_add_u32 v198, 1, v4
    v_sub_u32 v199, s35, v198
    v_add_u32 v230, 0, v4
    s_add_u32 s44, s3, 8
    s_sub_u32 s45, s44, 10
    s_min_u32 s44, s44, s45
    s_mul_i32 s45, s44, 128
    s_lshl_b32 s44, s44, 7
    s_add_u32 m0, s40, 106496
    v_mfma_f32_16x16x32_bf16 v[64:67], v[140:143], v[144:147], v[64:67]
    ds_read_b128 v[116:119], v202 offset:2048
    buffer_load_dwordx4 v192, s[4:7], s44 offen lds
    v_mfma_f32_16x16x32_bf16 v[20:23], v[128:131], v[148:151], v[20:23]
    ds_read_b128 v[104:107], v200 offset:4096
    v_mul_u32_u24 v230, 5120, v230
    v_add_u32 v230, v230, v7
    v_mov_b32 v231, 30408704
    v_mfma_f32_16x16x32_bf16 v[36:39], v[132:135], v[148:151], v[36:39]
    ds_read_b128 v[120:123], v202 offset:4096
    v_cmp_ge_u32 vcc, s35, v198
    s_nop 1
    v_cndmask_b32 v199, 0, v199, vcc
    v_cndmask_b32 v11, v231, v230, vcc
    v_mfma_f32_16x16x32_bf16 v[52:55], v[136:139], v[148:151], v[52:55]
    ds_read_b128 v[108:111], v200 offset:6144
    v_lshlrev_b32 v199, 8, v199
    v_cvt_f32_u32 v199, v199
    v_mul_f32 v228, v199, v160
    v_mfma_f32_16x16x32_bf16 v[68:71], v[140:143], v[148:151], v[68:71]
    ds_read_b128 v[124:127], v202 offset:6144
    v_mul_f32 v229, v199, v162
    v_exp_f32 v228, v228
    v_fract_f32 v229, v229
    s_add_u32 m0, s40, 107520
    v_mfma_f32_16x16x32_bf16 v[24:27], v[128:131], v[152:155], v[24:27]
    buffer_load_dwordx4 v193, s[4:7], s44 offen lds
    v_mfma_f32_16x16x32_bf16 v[40:43], v[132:135], v[152:155], v[40:43]
    v_cos_f32 v212, v229
    v_sin_f32 v213, v229
    v_mul_f32 v212, v228, v212
    v_mfma_f32_16x16x32_bf16 v[56:59], v[136:139], v[152:155], v[56:59]
    v_mul_f32 v213, v228, v213
    v_mul_f32 v228, v199, v161
    v_mul_f32 v229, v199, v163
    v_mfma_f32_16x16x32_bf16 v[72:75], v[140:143], v[152:155], v[72:75]
    v_exp_f32 v228, v228
    v_fract_f32 v229, v229
    v_cos_f32 v214, v229
    v_mfma_f32_16x16x32_bf16 v[28:31], v[128:131], v[156:159], v[28:31]
    v_sin_f32 v215, v229
    v_mul_f32 v214, v228, v214
    v_mul_f32 v215, v228, v215
    s_add_u32 m0, s40, 108544
    v_mfma_f32_16x16x32_bf16 v[44:47], v[132:135], v[156:159], v[44:47]
    buffer_load_dwordx4 v194, s[4:7], s44 offen lds
    v_mfma_f32_16x16x32_bf16 v[60:63], v[136:139], v[156:159], v[60:63]
    v_add_u32 v198, 5, v4
    v_sub_u32 v199, s35, v198
    v_add_u32 v230, 4, v4
    v_mfma_f32_16x16x32_bf16 v[76:79], v[140:143], v[156:159], v[76:79]
    v_mul_u32_u24 v230, 5120, v230
    v_add_u32 v230, v230, v7
    v_mov_b32 v231, 30408704
    s_waitcnt lgkmcnt(0)
    v_mfma_f32_16x16x32_bf16 v[16:19], v[96:99], v[112:115], v[16:19]
    ds_read_b128 v[128:131], v201 offset:0
    v_cmp_ge_u32 vcc, s35, v198
    s_nop 1
    v_cndmask_b32 v199, 0, v199, vcc
    v_cndmask_b32 v12, v231, v230, vcc
    v_mfma_f32_16x16x32_bf16 v[32:35], v[100:103], v[112:115], v[32:35]
    ds_read_b128 v[144:147], v203 offset:0
    v_lshlrev_b32 v199, 8, v199
    v_cvt_f32_u32 v199, v199
    v_mul_f32 v228, v199, v160
    v_mfma_f32_16x16x32_bf16 v[48:51], v[104:107], v[112:115], v[48:51]
    ds_read_b128 v[132:135], v201 offset:2048
    v_mul_f32 v229, v199, v162
    v_exp_f32 v228, v228
    v_fract_f32 v229, v229
    s_add_u32 m0, s40, 109568
    v_mfma_f32_16x16x32_bf16 v[64:67], v[108:111], v[112:115], v[64:67]
    ds_read_b128 v[148:151], v203 offset:2048
    buffer_load_dwordx4 v195, s[4:7], s44 offen lds
    v_mfma_f32_16x16x32_bf16 v[20:23], v[96:99], v[116:119], v[20:23]
    ds_read_b128 v[136:139], v201 offset:4096
    v_cos_f32 v216, v229
    v_sin_f32 v217, v229
    v_mul_f32 v216, v228, v216
    v_mfma_f32_16x16x32_bf16 v[36:39], v[100:103], v[116:119], v[36:39]
    ds_read_b128 v[152:155], v203 offset:4096
    v_mul_f32 v217, v228, v217
    v_mul_f32 v228, v199, v161
    v_mul_f32 v229, v199, v163
    v_mfma_f32_16x16x32_bf16 v[52:55], v[104:107], v[116:119], v[52:55]
    ds_read_b128 v[140:143], v201 offset:6144
    v_exp_f32 v228, v228
    v_fract_f32 v229, v229
    v_cos_f32 v218, v229
    v_mfma_f32_16x16x32_bf16 v[68:71], v[108:111], v[116:119], v[68:71]
    ds_read_b128 v[156:159], v203 offset:6144
    v_sin_f32 v219, v229
    v_mul_f32 v218, v228, v218
    v_mul_f32 v219, v228, v219
    s_add_u32 m0, s41, 106496
    v_mfma_f32_16x16x32_bf16 v[24:27], v[96:99], v[120:123], v[24:27]
    buffer_load_dwordx4 v196, s[16:19], s45 offen lds
    v_mfma_f32_16x16x32_bf16 v[40:43], v[100:103], v[120:123], v[40:43]
    s_lshl_b32 s60, s33, 6
    v_lshl_add_u32 v198, v4, 4, s60
    v_cvt_f32_u32 v199, v198
    v_mfma_f32_16x16x32_bf16 v[56:59], v[104:107], v[120:123], v[56:59]
    v_mul_f32 v228, v199, v160
    v_mul_f32 v229, v199, v162
    v_exp_f32 v228, v228
    v_mfma_f32_16x16x32_bf16 v[72:75], v[108:111], v[120:123], v[72:75]
    v_fract_f32 v229, v229
    v_cos_f32 v236, v229
    v_sin_f32 v237, v229
    v_mfma_f32_16x16x32_bf16 v[28:31], v[96:99], v[124:127], v[28:31]
    v_mul_f32 v236, v228, v236
    v_mul_f32 v237, v228, v237
    v_mul_f32 v228, v199, v161
    s_add_u32 m0, s42, 106496
    v_mfma_f32_16x16x32_bf16 v[44:47], v[100:103], v[124:127], v[44:47]
    buffer_load_dwordx4 v197, s[20:23], s45 offen lds
    v_mfma_f32_16x16x32_bf16 v[60:63], v[104:107], v[124:127], v[60:63]
    v_mul_f32 v229, v199, v163
    v_exp_f32 v228, v228
    v_fract_f32 v229, v229
    v_mfma_f32_16x16x32_bf16 v[76:79], v[108:111], v[124:127], v[76:79]
    v_cos_f32 v238, v229
    v_sin_f32 v239, v229
    v_mul_f32 v238, v228, v238
    s_waitcnt vmcnt(6) lgkmcnt(0)
    s_barrier
    v_mfma_f32_16x16x32_bf16 v[16:19], v[128:131], v[144:147], v[16:19]
    ds_read_b128 v[96:99], v204 offset:0
    v_mul_f32 v239, v228, v239
    v_mov_b32 v160, v236
    v_mov_b32 v161, v237
    v_mfma_f32_16x16x32_bf16 v[32:35], v[132:135], v[144:147], v[32:35]
    ds_read_b128 v[112:115], v206 offset:0
    v_mov_b32 v162, v238
    v_mov_b32 v163, v239
    v_pk_mul_f32 v[228:229], v[184:185], v[164:165] op_sel_hi:[1,0]
    v_mfma_f32_16x16x32_bf16 v[48:51], v[136:139], v[144:147], v[48:51]
    ds_read_b128 v[100:103], v204 offset:2048
    v_pk_mul_f32 v[236:237], v[186:187], v[166:167] op_sel_hi:[1,0]
    v_fma_f32 v228, -v185, v165, v228
    v_fma_f32 v236, -v187, v167, v236
    s_add_u32 s46, s3, 9
    s_sub_u32 s47, s46, 10
    s_min_u32 s46, s46, s47
    s_mul_i32 s47, s46, 128
    s_lshl_b32 s46, s46, 7
    s_add_u32 m0, s40, 0
    v_mfma_f32_16x16x32_bf16 v[64:67], v[140:143], v[144:147], v[64:67]
    ds_read_b128 v[116:119], v206 offset:2048
    buffer_load_dwordx4 v192, s[4:7], s46 offen lds
    v_mfma_f32_16x16x32_bf16 v[20:23], v[128:131], v[148:151], v[20:23]
    ds_read_b128 v[104:107], v204 offset:4096
    v_fma_f32 v229, v184, v165, v229
    v_fma_f32 v237, v186, v167, v237
    v_pk_mul_f32 v[230:231], v[228:229], v[164:165] op_sel_hi:[1,0]
    v_mfma_f32_16x16x32_bf16 v[36:39], v[132:135], v[148:151], v[36:39]
    ds_read_b128 v[120:123], v206 offset:4096
    v_pk_mul_f32 v[238:239], v[236:237], v[166:167] op_sel_hi:[1,0]
    v_fma_f32 v230, -v229, v165, v230
    v_fma_f32 v238, -v237, v167, v238
    v_mfma_f32_16x16x32_bf16 v[52:55], v[136:139], v[148:151], v[52:55]
    ds_read_b128 v[108:111], v204 offset:6144
    v_fma_f32 v231, v228, v165, v231
    v_fma_f32 v239, v236, v167, v239
    v_pk_mul_f32 v[232:233], v[230:231], v[164:165] op_sel_hi:[1,0]
    v_mfma_f32_16x16x32_bf16 v[68:71], v[140:143], v[148:151], v[68:71]
    ds_read_b128 v[124:127], v206 offset:6144
    v_pk_mul_f32 v[240:241], v[238:239], v[166:167] op_sel_hi:[1,0]
    v_fma_f32 v232, -v231, v165, v232
    v_fma_f32 v240, -v239, v167, v240
    s_add_u32 m0, s40, 1024
    v_mfma_f32_16x16x32_bf16 v[24:27], v[128:131], v[152:155], v[24:27]
    buffer_load_dwordx4 v193, s[4:7], s46 offen lds
    v_mfma_f32_16x16x32_bf16 v[40:43], v[132:135], v[152:155], v[40:43]
    v_fma_f32 v233, v230, v165, v233
    v_fma_f32 v241, v238, v167, v241
    v_pk_mul_f32 v[234:235], v[232:233], v[164:165] op_sel_hi:[1,0]
    v_mfma_f32_16x16x32_bf16 v[56:59], v[136:139], v[152:155], v[56:59]
    v_pk_mul_f32 v[242:243], v[240:241], v[166:167] op_sel_hi:[1,0]
    v_fma_f32 v234, -v233, v165, v234
    v_fma_f32 v242, -v241, v167, v242
    v_mfma_f32_16x16x32_bf16 v[72:75], v[140:143], v[152:155], v[72:75]
    v_fma_f32 v235, v232, v165, v235
    v_fma_f32 v243, v240, v167, v243
    v_mfma_f32_16x16x32_bf16 v[28:31], v[128:131], v[156:159], v[28:31]
    s_add_u32 m0, s40, 2048
    v_mfma_f32_16x16x32_bf16 v[44:47], v[132:135], v[156:159], v[44:47]
    buffer_load_dwordx4 v194, s[4:7], s46 offen lds
    v_mfma_f32_16x16x32_bf16 v[60:63], v[136:139], v[156:159], v[60:63]
    v_mfma_f32_16x16x32_bf16 v[76:79], v[140:143], v[156:159], v[76:79]
    s_waitcnt lgkmcnt(0)
    s_cmp_eq_u32 s32, 1
    s_cselect_b32 s63, 0, 30408704
    buffer_load_dword v2, v6, s[12:15], s63 offen sc1
    v_mfma_f32_16x16x32_bf16 v[16:19], v[96:99], v[112:115], v[16:19]
    ds_read_b128 v[128:131], v205 offset:0
    v_mfma_f32_16x16x32_bf16 v[32:35], v[100:103], v[112:115], v[32:35]
    ds_read_b128 v[144:147], v207 offset:0
    v_mfma_f32_16x16x32_bf16 v[48:51], v[104:107], v[112:115], v[48:51]
    ds_read_b128 v[132:135], v205 offset:2048
    s_add_u32 m0, s40, 3072
    v_mfma_f32_16x16x32_bf16 v[64:67], v[108:111], v[112:115], v[64:67]
    ds_read_b128 v[148:151], v207 offset:2048
    buffer_load_dwordx4 v195, s[4:7], s46 offen lds
    v_mfma_f32_16x16x32_bf16 v[20:23], v[96:99], v[116:119], v[20:23]
    ds_read_b128 v[136:139], v205 offset:4096
    v_mfma_f32_16x16x32_bf16 v[36:39], v[100:103], v[116:119], v[36:39]
    ds_read_b128 v[152:155], v207 offset:4096
    v_mfma_f32_16x16x32_bf16 v[52:55], v[104:107], v[116:119], v[52:55]
    ds_read_b128 v[140:143], v205 offset:6144
    v_mfma_f32_16x16x32_bf16 v[68:71], v[108:111], v[116:119], v[68:71]
    ds_read_b128 v[156:159], v207 offset:6144
    s_add_u32 m0, s41, 0
    v_mfma_f32_16x16x32_bf16 v[24:27], v[96:99], v[120:123], v[24:27]
    buffer_load_dwordx4 v196, s[16:19], s47 offen lds
    v_mfma_f32_16x16x32_bf16 v[40:43], v[100:103], v[120:123], v[40:43]
    v_mfma_f32_16x16x32_bf16 v[56:59], v[104:107], v[120:123], v[56:59]
    v_mfma_f32_16x16x32_bf16 v[72:75], v[108:111], v[120:123], v[72:75]
    v_mfma_f32_16x16x32_bf16 v[28:31], v[96:99], v[124:127], v[28:31]
    s_add_u32 m0, s42, 0
    v_mfma_f32_16x16x32_bf16 v[44:47], v[100:103], v[124:127], v[44:47]
    buffer_load_dwordx4 v197, s[20:23], s47 offen lds
    v_mfma_f32_16x16x32_bf16 v[60:63], v[104:107], v[124:127], v[60:63]
    v_mfma_f32_16x16x32_bf16 v[76:79], v[108:111], v[124:127], v[76:79]
    s_waitcnt vmcnt(3)
    s_cmp_lg_u32 s32, 1
    s_cbranch_scc1 Lp0d_29
    s_mov_b32 s101, 0
Lp0_28:
    v_cmp_gt_u32 vcc, 4, v2
    s_nop 1
    s_cmp_eq_u64 vcc, 0
    s_cbranch_scc1 Lp0d_29
    s_mov_b64 exec, vcc
    s_sleep 16
    buffer_load_dword v2, v6, s[12:15], 0 offen sc1
    s_add_u32 s101, s101, 1
    s_cmp_lt_u32 s101, 100000
    s_waitcnt vmcnt(0)
    s_cbranch_scc1 Lp0_28
Lp0d_29:
    s_mov_b64 exec, -1
    s_waitcnt lgkmcnt(0)
    s_barrier
    s_cmp_eq_u32 s32, 1
    s_cselect_b32 s63, 0, 30408704
    buffer_load_dword v2, v13, s[8:11], s63 offen sc1
    s_lshl_b32 s40, s32, 10
    v_mfma_f32_16x16x32_bf16 v[16:19], v[128:131], v[144:147], v[16:19]
    ds_read_b128 v[96:99], v208 offset:0
    s_lshl_b32 s16, s28, 3
    s_lshl_b32 s60, s33, 1
    s_add_u32 s16, s16, s60
    v_mfma_f32_16x16x32_bf16 v[32:35], v[132:135], v[144:147], v[32:35]
    ds_read_b128 v[112:115], v210 offset:0
    s_add_u32 s16, s16, s34
    s_cmp_ge_u32 s38, 4
    s_cselect_b32 s61, 40, 54
    s_cselect_b32 s62, 7340032, 0
    s_cselect_b32 s23, 2816, 0
    s_cselect_b32 s25, 2, 10
    s_cselect_b32 s26, 11, 4
    v_mfma_f32_16x16x32_bf16 v[48:51], v[136:139], v[144:147], v[48:51]
    ds_read_b128 v[100:103], v208 offset:2048
    s_mul_i32 s25, s25, 10240
    s_mul_i32 s26, s26, 10240
    s_add_u32 s62, s62, 5242880
    v_mfma_f32_16x16x32_bf16 v[64:67], v[140:143], v[144:147], v[64:67]
    ds_read_b128 v[116:119], v210 offset:2048
    s_xor_b32 s60, s16, 0
    s_mul_i32 s60, s60, s61
    s_add_u32 s60, s60, s34
    v_mfma_f32_16x16x32_bf16 v[20:23], v[128:131], v[148:151], v[20:23]
    ds_read_b128 v[104:107], v208 offset:4096
    s_lshl_b32 s60, s60, 10
    s_add_u32 s60, s60, s62
    v_add_u32 v248, s60, v5
    v_mfma_f32_16x16x32_bf16 v[36:39], v[132:135], v[148:151], v[36:39]
    ds_read_b128 v[120:123], v210 offset:4096
    s_xor_b32 s60, s16, 1
    s_mul_i32 s60, s60, s61
    s_add_u32 s60, s60, s34
    v_mfma_f32_16x16x32_bf16 v[52:55], v[136:139], v[148:151], v[52:55]
    ds_read_b128 v[108:111], v208 offset:6144
    s_lshl_b32 s60, s60, 10
    s_add_u32 s60, s60, s62
    v_add_u32 v249, s60, v5
    v_mfma_f32_16x16x32_bf16 v[68:71], v[140:143], v[148:151], v[68:71]
    ds_read_b128 v[124:127], v210 offset:6144
    s_xor_b32 s60, s34, 0
    s_mul_i32 s60, s60, s25
    s_mul_i32 s63, s33, 5120
    v_mfma_f32_16x16x32_bf16 v[24:27], v[128:131], v[152:155], v[24:27]
    s_add_u32 s60, s60, s63
    s_add_u32 s60, s60, s26
    v_add_u32 v250, s60, v5
    v_mfma_f32_16x16x32_bf16 v[40:43], v[132:135], v[152:155], v[40:43]
    s_xor_b32 s60, s34, 1
    s_mul_i32 s60, s60, s25
    s_mul_i32 s63, s33, 5120
    v_mfma_f32_16x16x32_bf16 v[56:59], v[136:139], v[152:155], v[56:59]
    s_add_u32 s60, s60, s63
    s_add_u32 s60, s60, s26
    v_add_u32 v251, s60, v5
    v_mfma_f32_16x16x32_bf16 v[72:75], v[140:143], v[152:155], v[72:75]
    s_mul_i32 s60, s34, 5120
    v_lshlrev_b32 v14, 3, v1
    v_add_u32 v14, s60, v14
    v_mfma_f32_16x16x32_bf16 v[28:31], v[128:131], v[156:159], v[28:31]
    s_lshl_b32 s60, s34, 2
    v_add_u32 v15, s60, v4
    v_lshrrev_b32 v254, 1, v3
    v_mfma_f32_16x16x32_bf16 v[44:47], v[132:135], v[156:159], v[44:47]
    v_xor_b32 v15, v15, v254
    v_lshlrev_b32 v15, 4, v15
    v_lshl_add_u32 v15, v3, 7, v15
    v_mfma_f32_16x16x32_bf16 v[60:63], v[136:139], v[156:159], v[60:63]
    v_cndmask_b32 v244, v14, v15, s[58:59]
    v_add_u32 v245, 51200, v244
    v_add_u32 v246, 102400, v244
    v_mfma_f32_16x16x32_bf16 v[76:79], v[140:143], v[156:159], v[76:79]
    s_mul_i32 s17, s16, 20480
    s_mul_i32 s18, s29, 160
    s_add_u32 s17, s17, s18
    s_waitcnt lgkmcnt(0)
    v_mfma_f32_16x16x32_bf16 v[16:19], v[96:99], v[112:115], v[16:19]
    ds_read_b128 v[128:131], v209 offset:0
    s_lshl_b32 s24, s17, 1
    v_mul_u32_u24 v252, 1280, v3
    v_lshl_add_u32 v252, v4, 3, v252
    v_mfma_f32_16x16x32_bf16 v[32:35], v[100:103], v[112:115], v[32:35]
    ds_read_b128 v[144:147], v211 offset:0
    v_lshlrev_b32 v253, 1, v252
    s_lshl_b32 s19, s16, 6
    s_lshl_b32 s60, s28, 3
    v_mfma_f32_16x16x32_bf16 v[48:51], v[104:107], v[112:115], v[48:51]
    ds_read_b128 v[132:135], v209 offset:2048
    s_add_u32 s60, s60, s29
    s_lshl_b32 s60, s60, 3
    s_add_u32 s60, s60, s32
    v_mfma_f32_16x16x32_bf16 v[64:67], v[108:111], v[112:115], v[64:67]
    ds_read_b128 v[148:151], v211 offset:2048
    s_mul_i32 s20, s60, 10240
    s_add_u32 s20, s20, 18874368
    s_xor_b32 s60, s60, 4
    v_mfma_f32_16x16x32_bf16 v[20:23], v[96:99], v[116:119], v[20:23]
    ds_read_b128 v[136:139], v209 offset:4096
    s_mul_i32 s21, s60, 10240
    s_add_u32 s21, s21, 18879488
    s_lshr_b32 s60, s28, 1
    v_mfma_f32_16x16x32_bf16 v[36:39], v[100:103], v[116:119], v[36:39]
    ds_read_b128 v[152:155], v211 offset:4096
    s_lshl_b32 s60, s60, 12
    s_add_u32 s23, s23, s60
    s_add_u32 s23, s23, 163840
    v_mfma_f32_16x16x32_bf16 v[52:55], v[104:107], v[116:119], v[52:55]
    ds_read_b128 v[140:143], v209 offset:6144
    v_mfma_f32_16x16x32_bf16 v[68:71], v[108:111], v[116:119], v[68:71]
    ds_read_b128 v[156:159], v211 offset:6144
    v_mfma_f32_16x16x32_bf16 v[24:27], v[96:99], v[120:123], v[24:27]
    v_mfma_f32_16x16x32_bf16 v[40:43], v[100:103], v[120:123], v[40:43]
    v_mfma_f32_16x16x32_bf16 v[56:59], v[104:107], v[120:123], v[56:59]
    v_mfma_f32_16x16x32_bf16 v[72:75], v[108:111], v[120:123], v[72:75]
    v_mfma_f32_16x16x32_bf16 v[28:31], v[96:99], v[124:127], v[28:31]
    v_mfma_f32_16x16x32_bf16 v[44:47], v[100:103], v[124:127], v[44:47]
    v_mfma_f32_16x16x32_bf16 v[60:63], v[104:107], v[124:127], v[60:63]
    v_mfma_f32_16x16x32_bf16 v[76:79], v[108:111], v[124:127], v[76:79]
    s_waitcnt vmcnt(0)
    s_cmp_lg_u32 s32, 1
    s_cbranch_scc1 Lp0d_31
    s_mov_b32 s101, 0
Lp0_30:
    v_cmp_gt_u32 vcc, 4, v2
    s_nop 1
    s_cmp_eq_u64 vcc, 0
    s_cbranch_scc1 Lp0d_31
    s_mov_b64 exec, vcc
    s_sleep 4
    buffer_load_dword v2, v13, s[8:11], 0 offen sc1
    s_add_u32 s101, s101, 1
    s_cmp_lt_u32 s101, 100000
    s_waitcnt vmcnt(0)
    s_cbranch_scc1 Lp0_30
Lp0d_31:
    s_mov_b64 exec, -1
    s_waitcnt lgkmcnt(0)
    s_barrier
    s_mov_b32 s12, s80
    s_mov_b32 s13, s81
    s_mov_b32 s14, 1280
    s_mov_b32 s15, 0x20000
    s_cmp_lg_u32 s32, 4
    s_cbranch_scc1 Lskip_32
    s_mov_b32 m0, 157696
    s_nop 0
    buffer_load_dwordx4 v5, s[12:15], s18 offen lds
Lskip_32:
    s_lshl_b32 s60, s35, 10
    s_lshl_b32 s61, s28, 9
    s_cmp_lt_u32 s32, 2
    s_cselect_b32 s60, s60, s61
    s_and_b32 s61, s32, 1
    s_lshl_b32 s61, s61, 13
    s_add_u32 s60, s60, s61
    s_cmp_lt_u32 s32, 4
    s_cselect_b32 s60, s60, 30408704
    s_cselect_b32 s61, s40, 5120
    s_add_u32 m0, s61, 153600
    s_nop 0
    buffer_load_dwordx4 v5, s[8:11], s60 offen sc1 lds
    v_mfma_f32_16x16x32_bf16 v[16:19], v[128:131], v[144:147], v[16:19]
    ds_read_b128 v[96:99], v200 offset:0
    s_bfe_u32 s56, s53, 0x50003
    s_lshl_b32 s56, s56, 1
    s_add_u32 s56, s56, s34
    s_mul_i32 s56, s56, 5120
    s_add_u32 s56, s56, 262144
    s_add_u32 s57, s56, 4096
    v_mfma_f32_16x16x32_bf16 v[32:35], v[132:135], v[144:147], v[32:35]
    ds_read_b128 v[112:115], v202 offset:0
    buffer_load_dwordx4 v[80:83], v5, s[8:11], s56 offen offset:0 sc1
    s_add_u32 s44, s30, 90112
    s_sub_u32 s45, s44, s31
    s_min_u32 s44, s44, s45
    s_add_u32 m0, s40, 151552
    v_mfma_f32_16x16x32_bf16 v[48:51], v[136:139], v[144:147], v[48:51]
    ds_read_b128 v[100:103], v200 offset:2048
    s_cmp_ge_u32 s32, 2
    s_cbranch_scc1 Lskip_33
    buffer_load_dwordx4 v247, s[8:11], s44 offen sc1 lds
Lskip_33:
    v_mfma_f32_16x16x32_bf16 v[64:67], v[140:143], v[144:147], v[64:67]
    ds_read_b128 v[116:119], v202 offset:2048
    v_mfma_f32_16x16x32_bf16 v[20:23], v[128:131], v[148:151], v[20:23]
    ds_read_b128 v[104:107], v200 offset:4096
    buffer_load_dwordx4 v[84:87], v5, s[8:11], s56 offen offset:1024 sc1
    v_mfma_f32_16x16x32_bf16 v[36:39], v[132:135], v[148:151], v[36:39]
    ds_read_b128 v[120:123], v202 offset:4096
    s_add_u32 s44, s30, 0
    s_sub_u32 s45, s44, s31
    s_min_u32 s44, s44, s45
    s_add_u32 m0, s40, 61440
    v_mfma_f32_16x16x32_bf16 v[52:55], v[136:139], v[148:151], v[52:55]
    ds_read_b128 v[108:111], v200 offset:6144
    buffer_load_dwordx4 v247, s[8:11], s44 offen sc1 lds
    v_mfma_f32_16x16x32_bf16 v[68:71], v[140:143], v[148:151], v[68:71]
    ds_read_b128 v[124:127], v202 offset:6144
    buffer_load_dwordx4 v[88:91], v5, s[8:11], s56 offen offset:2048 sc1
    v_mfma_f32_16x16x32_bf16 v[24:27], v[128:131], v[152:155], v[24:27]
    v_mfma_f32_16x16x32_bf16 v[40:43], v[132:135], v[152:155], v[40:43]
    buffer_load_dwordx4 v[92:95], v5, s[8:11], s56 offen offset:3072 sc1
    s_add_u32 s44, s30, 8192
    s_sub_u32 s45, s44, s31
    s_min_u32 s44, s44, s45
    s_add_u32 m0, s40, 69632
    v_mfma_f32_16x16x32_bf16 v[56:59], v[136:139], v[152:155], v[56:59]
    buffer_load_dwordx4 v247, s[8:11], s44 offen sc1 lds
    v_mfma_f32_16x16x32_bf16 v[72:75], v[140:143], v[152:155], v[72:75]
    v_mfma_f32_16x16x32_bf16 v[28:31], v[128:131], v[156:159], v[28:31]
    v_mfma_f32_16x16x32_bf16 v[44:47], v[132:135], v[156:159], v[44:47]
    s_add_u32 s44, s30, 16384
    s_sub_u32 s45, s44, s31
    s_min_u32 s44, s44, s45
    s_add_u32 m0, s40, 77824
    v_mfma_f32_16x16x32_bf16 v[60:63], v[136:139], v[156:159], v[60:63]
    buffer_load_dwordx4 v247, s[8:11], s44 offen sc1 lds
    v_mfma_f32_16x16x32_bf16 v[76:79], v[140:143], v[156:159], v[76:79]
    s_waitcnt lgkmcnt(0)
    v_mfma_f32_16x16x32_bf16 v[16:19], v[96:99], v[112:115], v[16:19]
    ds_read_b128 v[128:131], v201 offset:0
    s_add_u32 s44, s30, 24576
    s_sub_u32 s45, s44, s31
    s_min_u32 s44, s44, s45
    s_add_u32 m0, s40, 86016
    v_mfma_f32_16x16x32_bf16 v[32:35], v[100:103], v[112:115], v[32:35]
    ds_read_b128 v[144:147], v203 offset:0
    buffer_load_dwordx4 v247, s[8:11], s44 offen sc1 lds
    v_mfma_f32_16x16x32_bf16 v[48:51], v[104:107], v[112:115], v[48:51]
    ds_read_b128 v[132:135], v201 offset:2048
    v_mfma_f32_16x16x32_bf16 v[64:67], v[108:111], v[112:115], v[64:67]
    ds_read_b128 v[148:151], v203 offset:2048
    v_mfma_f32_16x16x32_bf16 v[20:23], v[96:99], v[116:119], v[20:23]
    ds_read_b128 v[136:139], v201 offset:4096
    s_add_u32 s44, s30, 32768
    s_sub_u32 s45, s44, s31
    s_min_u32 s44, s44, s45
    s_add_u32 m0, s40, 94208
    v_mfma_f32_16x16x32_bf16 v[36:39], v[100:103], v[116:119], v[36:39]
    ds_read_b128 v[152:155], v203 offset:4096
    buffer_load_dwordx4 v247, s[8:11], s44 offen sc1 lds
    v_mfma_f32_16x16x32_bf16 v[52:55], v[104:107], v[116:119], v[52:55]
    ds_read_b128 v[140:143], v201 offset:6144
    v_mfma_f32_16x16x32_bf16 v[68:71], v[108:111], v[116:119], v[68:71]
    ds_read_b128 v[156:159], v203 offset:6144
    s_add_u32 s44, s30, 40960
    s_sub_u32 s45, s44, s31
    s_min_u32 s44, s44, s45
    s_add_u32 m0, s40, 102400
    v_mfma_f32_16x16x32_bf16 v[24:27], v[96:99], v[120:123], v[24:27]
    buffer_load_dwordx4 v247, s[8:11], s44 offen sc1 lds
    v_mfma_f32_16x16x32_bf16 v[40:43], v[100:103], v[120:123], v[40:43]
    v_mfma_f32_16x16x32_bf16 v[56:59], v[104:107], v[120:123], v[56:59]
    s_add_u32 s44, s30, 49152
    s_sub_u32 s45, s44, s31
    s_min_u32 s44, s44, s45
    s_add_u32 m0, s40, 110592
    v_mfma_f32_16x16x32_bf16 v[72:75], v[108:111], v[120:123], v[72:75]
    buffer_load_dwordx4 v247, s[8:11], s44 offen sc1 lds
    v_mfma_f32_16x16x32_bf16 v[28:31], v[96:99], v[124:127], v[28:31]
    v_mfma_f32_16x16x32_bf16 v[44:47], v[100:103], v[124:127], v[44:47]
    s_add_u32 s44, s30, 57344
    s_sub_u32 s45, s44, s31
    s_min_u32 s44, s44, s45
    s_add_u32 m0, s40, 118784
    v_mfma_f32_16x16x32_bf16 v[60:63], v[104:107], v[124:127], v[60:63]
    buffer_load_dwordx4 v247, s[8:11], s44 offen sc1 lds
    v_mfma_f32_16x16x32_bf16 v[76:79], v[108:111], v[124:127], v[76:79]
    s_waitcnt lgkmcnt(0)
    s_waitcnt vmcnt(7)
    v_mfma_f32_16x16x32_bf16 v[80:83], v[188:191], v[80:83], 0
    v_mfma_f32_16x16x32_bf16 v[84:87], v[188:191], v[84:87], 0
    v_mfma_f32_16x16x32_bf16 v[88:91], v[188:191], v[88:91], 0
    v_mfma_f32_16x16x32_bf16 v[92:95], v[188:191], v[92:95], 0
    v_mfma_f32_16x16x32_bf16 v[16:19], v[128:131], v[144:147], v[16:19]
    v_mfma_f32_16x16x32_bf16 v[32:35], v[132:135], v[144:147], v[32:35]
    s_add_u32 s44, s30, 65536
    s_sub_u32 s45, s44, s31
    s_min_u32 s44, s44, s45
    s_add_u32 m0, s40, 126976
    v_mfma_f32_16x16x32_bf16 v[48:51], v[136:139], v[144:147], v[48:51]
    buffer_load_dwordx4 v247, s[8:11], s44 offen sc1 lds
    v_mfma_f32_16x16x32_bf16 v[64:67], v[140:143], v[144:147], v[64:67]
    v_mfma_f32_16x16x32_bf16 v[20:23], v[128:131], v[148:151], v[20:23]
    s_add_u32 s44, s30, 73728
    s_sub_u32 s45, s44, s31
    s_min_u32 s44, s44, s45
    s_add_u32 m0, s40, 135168
    v_mfma_f32_16x16x32_bf16 v[36:39], v[132:135], v[148:151], v[36:39]
    buffer_load_dwordx4 v247, s[8:11], s44 offen sc1 lds
    v_mfma_f32_16x16x32_bf16 v[52:55], v[136:139], v[148:151], v[52:55]
    v_mfma_f32_16x16x32_bf16 v[68:71], v[140:143], v[148:151], v[68:71]
    s_add_u32 s44, s30, 81920
    s_sub_u32 s45, s44, s31
    s_min_u32 s44, s44, s45
    s_add_u32 m0, s40, 143360
    v_mfma_f32_16x16x32_bf16 v[24:27], v[128:131], v[152:155], v[24:27]
    buffer_load_dwordx4 v247, s[8:11], s44 offen sc1 lds
    v_mfma_f32_16x16x32_bf16 v[40:43], v[132:135], v[152:155], v[40:43]
    v_mfma_f32_16x16x32_bf16 v[56:59], v[136:139], v[152:155], v[56:59]
    v_mfma_f32_16x16x32_bf16 v[72:75], v[140:143], v[152:155], v[72:75]
    v_mfma_f32_16x16x32_bf16 v[28:31], v[128:131], v[156:159], v[28:31]
    v_mfma_f32_16x16x32_bf16 v[44:47], v[132:135], v[156:159], v[44:47]
    v_mfma_f32_16x16x32_bf16 v[60:63], v[136:139], v[156:159], v[60:63]
    v_mfma_f32_16x16x32_bf16 v[76:79], v[140:143], v[156:159], v[76:79]
    s_waitcnt lgkmcnt(0)
    s_barrier
    ds_read_b128 v[128:131], v9 offset:0
    ds_read_b128 v[144:147], v9 offset:1024
    ds_read_b128 v[132:135], v9 offset:16
    ds_read_b128 v[148:151], v9 offset:1040
    ds_read_b128 v[136:139], v9 offset:32
    ds_read_b128 v[152:155], v9 offset:1056
    ds_read_b128 v[140:143], v9 offset:48
    ds_read_b128 v[156:159], v9 offset:1072
    s_add_u32 s44, s30, 149504
    s_sub_u32 s45, s44, s31
    s_min_u32 s44, s44, s45
    s_add_u32 m0, s40, 57344
    s_cmp_ge_u32 s32, 4
    s_cbranch_scc1 Lskip_34
    buffer_load_dwordx4 v247, s[8:11], s44 offen sc1 lds
Lskip_34:
    s_add_u32 s44, s30, 133120
    s_sub_u32 s45, s44, s31
    s_min_u32 s44, s44, s45
    s_add_u32 m0, s40, 40960
    s_nop 0
    buffer_load_dwordx4 v247, s[8:11], s44 offen sc1 lds
    s_add_u32 s44, s30, 141312
    s_sub_u32 s45, s44, s31
    s_min_u32 s44, s44, s45
    s_add_u32 m0, s40, 49152
    s_nop 0
    buffer_load_dwordx4 v247, s[8:11], s44 offen sc1 lds
    s_waitcnt lgkmcnt(0)
    v_pk_fma_f32 v[16:17], v[80:81], v[128:129], v[16:17] neg_lo:[1,0,0] neg_hi:[1,0,0]
    v_pk_fma_f32 v[20:21], v[84:85], v[128:129], v[20:21] neg_lo:[1,0,0] neg_hi:[1,0,0]
    v_pk_fma_f32 v[24:25], v[88:89], v[128:129], v[24:25] neg_lo:[1,0,0] neg_hi:[1,0,0]
    v_pk_fma_f32 v[28:29], v[92:93], v[128:129], v[28:29] neg_lo:[1,0,0] neg_hi:[1,0,0]
    v_pk_mul_f32 v[16:17], v[16:17], v[144:145]
    v_pk_mul_f32 v[20:21], v[20:21], v[144:145]
    v_pk_mul_f32 v[24:25], v[24:25], v[144:145]
    v_pk_mul_f32 v[28:29], v[28:29], v[144:145]
    v_pk_fma_f32 v[18:19], v[80:81], v[130:131], v[18:19] neg_lo:[1,0,0] neg_hi:[1,0,0]
    v_pk_fma_f32 v[22:23], v[84:85], v[130:131], v[22:23] neg_lo:[1,0,0] neg_hi:[1,0,0]
    v_pk_fma_f32 v[26:27], v[88:89], v[130:131], v[26:27] neg_lo:[1,0,0] neg_hi:[1,0,0]
    v_pk_fma_f32 v[30:31], v[92:93], v[130:131], v[30:31] neg_lo:[1,0,0] neg_hi:[1,0,0]
    v_pk_mul_f32 v[18:19], v[18:19], v[146:147]
    v_pk_mul_f32 v[22:23], v[22:23], v[146:147]
    v_pk_mul_f32 v[26:27], v[26:27], v[146:147]
    v_pk_mul_f32 v[30:31], v[30:31], v[146:147]
    v_pk_fma_f32 v[18:19], v[164:165], v[16:17], v[18:19] op_sel:[0,0,0] op_sel_hi:[0,1,1]
    v_pk_fma_f32 v[26:27], v[164:165], v[24:25], v[26:27] op_sel:[0,0,0] op_sel_hi:[0,1,1]
    v_pk_fma_f32 v[22:23], v[166:167], v[20:21], v[22:23] op_sel:[0,0,0] op_sel_hi:[0,1,1]
    v_pk_fma_f32 v[30:31], v[166:167], v[28:29], v[30:31] op_sel:[0,0,0] op_sel_hi:[0,1,1]
    v_pk_fma_f32 v[18:19], v[164:165], v[24:25], v[18:19] op_sel:[1,0,0] op_sel_hi:[1,1,1] neg_lo:[1,0,0] neg_hi:[1,0,0]
    v_pk_fma_f32 v[26:27], v[164:165], v[16:17], v[26:27] op_sel:[1,0,0] op_sel_hi:[1,1,1]
    v_pk_fma_f32 v[22:23], v[166:167], v[28:29], v[22:23] op_sel:[1,0,0] op_sel_hi:[1,1,1] neg_lo:[1,0,0] neg_hi:[1,0,0]
    v_pk_fma_f32 v[30:31], v[166:167], v[20:21], v[30:31] op_sel:[1,0,0] op_sel_hi:[1,1,1]
    v_pk_fma_f32 v[32:33], v[80:81], v[132:133], v[32:33] neg_lo:[1,0,0] neg_hi:[1,0,0]
    v_pk_fma_f32 v[36:37], v[84:85], v[132:133], v[36:37] neg_lo:[1,0,0] neg_hi:[1,0,0]
    v_pk_fma_f32 v[40:41], v[88:89], v[132:133], v[40:41] neg_lo:[1,0,0] neg_hi:[1,0,0]
    v_pk_fma_f32 v[44:45], v[92:93], v[132:133], v[44:45] neg_lo:[1,0,0] neg_hi:[1,0,0]
    v_pk_mul_f32 v[32:33], v[32:33], v[148:149]
    v_pk_mul_f32 v[36:37], v[36:37], v[148:149]
    v_pk_mul_f32 v[40:41], v[40:41], v[148:149]
    v_pk_mul_f32 v[44:45], v[44:45], v[148:149]
    v_pk_fma_f32 v[32:33], v[164:165], v[18:19], v[32:33] op_sel:[0,0,0] op_sel_hi:[0,1,1]
    v_pk_fma_f32 v[40:41], v[164:165], v[26:27], v[40:41] op_sel:[0,0,0] op_sel_hi:[0,1,1]
    v_pk_fma_f32 v[36:37], v[166:167], v[22:23], v[36:37] op_sel:[0,0,0] op_sel_hi:[0,1,1]
    v_pk_fma_f32 v[44:45], v[166:167], v[30:31], v[44:45] op_sel:[0,0,0] op_sel_hi:[0,1,1]
    v_pk_fma_f32 v[32:33], v[164:165], v[26:27], v[32:33] op_sel:[1,0,0] op_sel_hi:[1,1,1] neg_lo:[1,0,0] neg_hi:[1,0,0]
    v_pk_fma_f32 v[40:41], v[164:165], v[18:19], v[40:41] op_sel:[1,0,0] op_sel_hi:[1,1,1]
    v_pk_fma_f32 v[36:37], v[166:167], v[30:31], v[36:37] op_sel:[1,0,0] op_sel_hi:[1,1,1] neg_lo:[1,0,0] neg_hi:[1,0,0]
    v_pk_fma_f32 v[44:45], v[166:167], v[22:23], v[44:45] op_sel:[1,0,0] op_sel_hi:[1,1,1]
    v_pk_fma_f32 v[34:35], v[80:81], v[134:135], v[34:35] neg_lo:[1,0,0] neg_hi:[1,0,0]
    v_pk_fma_f32 v[38:39], v[84:85], v[134:135], v[38:39] neg_lo:[1,0,0] neg_hi:[1,0,0]
    v_pk_fma_f32 v[42:43], v[88:89], v[134:135], v[42:43] neg_lo:[1,0,0] neg_hi:[1,0,0]
    v_pk_fma_f32 v[46:47], v[92:93], v[134:135], v[46:47] neg_lo:[1,0,0] neg_hi:[1,0,0]
    v_pk_mul_f32 v[34:35], v[34:35], v[150:151]
    v_pk_mul_f32 v[38:39], v[38:39], v[150:151]
    v_pk_mul_f32 v[42:43], v[42:43], v[150:151]
    v_pk_mul_f32 v[46:47], v[46:47], v[150:151]
    v_pk_fma_f32 v[34:35], v[164:165], v[32:33], v[34:35] op_sel:[0,0,0] op_sel_hi:[0,1,1]
    v_pk_fma_f32 v[42:43], v[164:165], v[40:41], v[42:43] op_sel:[0,0,0] op_sel_hi:[0,1,1]
    v_pk_fma_f32 v[38:39], v[166:167], v[36:37], v[38:39] op_sel:[0,0,0] op_sel_hi:[0,1,1]
    v_pk_fma_f32 v[46:47], v[166:167], v[44:45], v[46:47] op_sel:[0,0,0] op_sel_hi:[0,1,1]
    v_pk_fma_f32 v[34:35], v[164:165], v[40:41], v[34:35] op_sel:[1,0,0] op_sel_hi:[1,1,1] neg_lo:[1,0,0] neg_hi:[1,0,0]
    v_pk_fma_f32 v[42:43], v[164:165], v[32:33], v[42:43] op_sel:[1,0,0] op_sel_hi:[1,1,1]
    v_pk_fma_f32 v[38:39], v[166:167], v[44:45], v[38:39] op_sel:[1,0,0] op_sel_hi:[1,1,1] neg_lo:[1,0,0] neg_hi:[1,0,0]
    v_pk_fma_f32 v[46:47], v[166:167], v[36:37], v[46:47] op_sel:[1,0,0] op_sel_hi:[1,1,1]
    v_pk_fma_f32 v[48:49], v[80:81], v[136:137], v[48:49] neg_lo:[1,0,0] neg_hi:[1,0,0]
    v_pk_fma_f32 v[52:53], v[84:85], v[136:137], v[52:53] neg_lo:[1,0,0] neg_hi:[1,0,0]
    v_pk_fma_f32 v[56:57], v[88:89], v[136:137], v[56:57] neg_lo:[1,0,0] neg_hi:[1,0,0]
    v_pk_fma_f32 v[60:61], v[92:93], v[136:137], v[60:61] neg_lo:[1,0,0] neg_hi:[1,0,0]
    v_pk_mul_f32 v[48:49], v[48:49], v[152:153]
    v_pk_mul_f32 v[52:53], v[52:53], v[152:153]
    v_pk_mul_f32 v[56:57], v[56:57], v[152:153]
    v_pk_mul_f32 v[60:61], v[60:61], v[152:153]
    v_pk_fma_f32 v[48:49], v[164:165], v[34:35], v[48:49] op_sel:[0,0,0] op_sel_hi:[0,1,1]
    v_pk_fma_f32 v[56:57], v[164:165], v[42:43], v[56:57] op_sel:[0,0,0] op_sel_hi:[0,1,1]
    v_pk_fma_f32 v[52:53], v[166:167], v[38:39], v[52:53] op_sel:[0,0,0] op_sel_hi:[0,1,1]
    v_pk_fma_f32 v[60:61], v[166:167], v[46:47], v[60:61] op_sel:[0,0,0] op_sel_hi:[0,1,1]
    v_pk_fma_f32 v[48:49], v[164:165], v[42:43], v[48:49] op_sel:[1,0,0] op_sel_hi:[1,1,1] neg_lo:[1,0,0] neg_hi:[1,0,0]
    v_pk_fma_f32 v[56:57], v[164:165], v[34:35], v[56:57] op_sel:[1,0,0] op_sel_hi:[1,1,1]
    v_pk_fma_f32 v[52:53], v[166:167], v[46:47], v[52:53] op_sel:[1,0,0] op_sel_hi:[1,1,1] neg_lo:[1,0,0] neg_hi:[1,0,0]
    v_pk_fma_f32 v[60:61], v[166:167], v[38:39], v[60:61] op_sel:[1,0,0] op_sel_hi:[1,1,1]
    v_pk_fma_f32 v[50:51], v[80:81], v[138:139], v[50:51] neg_lo:[1,0,0] neg_hi:[1,0,0]
    v_pk_fma_f32 v[54:55], v[84:85], v[138:139], v[54:55] neg_lo:[1,0,0] neg_hi:[1,0,0]
    v_pk_fma_f32 v[58:59], v[88:89], v[138:139], v[58:59] neg_lo:[1,0,0] neg_hi:[1,0,0]
    v_pk_fma_f32 v[62:63], v[92:93], v[138:139], v[62:63] neg_lo:[1,0,0] neg_hi:[1,0,0]
    v_pk_mul_f32 v[50:51], v[50:51], v[154:155]
    v_pk_mul_f32 v[54:55], v[54:55], v[154:155]
    v_pk_mul_f32 v[58:59], v[58:59], v[154:155]
    v_pk_mul_f32 v[62:63], v[62:63], v[154:155]
    v_pk_fma_f32 v[50:51], v[164:165], v[48:49], v[50:51] op_sel:[0,0,0] op_sel_hi:[0,1,1]
    v_pk_fma_f32 v[58:59], v[164:165], v[56:57], v[58:59] op_sel:[0,0,0] op_sel_hi:[0,1,1]
    v_pk_fma_f32 v[54:55], v[166:167], v[52:53], v[54:55] op_sel:[0,0,0] op_sel_hi:[0,1,1]
    v_pk_fma_f32 v[62:63], v[166:167], v[60:61], v[62:63] op_sel:[0,0,0] op_sel_hi:[0,1,1]
    v_pk_fma_f32 v[50:51], v[164:165], v[56:57], v[50:51] op_sel:[1,0,0] op_sel_hi:[1,1,1] neg_lo:[1,0,0] neg_hi:[1,0,0]
    v_pk_fma_f32 v[58:59], v[164:165], v[48:49], v[58:59] op_sel:[1,0,0] op_sel_hi:[1,1,1]
    v_pk_fma_f32 v[54:55], v[166:167], v[60:61], v[54:55] op_sel:[1,0,0] op_sel_hi:[1,1,1] neg_lo:[1,0,0] neg_hi:[1,0,0]
    v_pk_fma_f32 v[62:63], v[166:167], v[52:53], v[62:63] op_sel:[1,0,0] op_sel_hi:[1,1,1]
    v_pk_fma_f32 v[64:65], v[80:81], v[140:141], v[64:65] neg_lo:[1,0,0] neg_hi:[1,0,0]
    v_pk_fma_f32 v[68:69], v[84:85], v[140:141], v[68:69] neg_lo:[1,0,0] neg_hi:[1,0,0]
    v_pk_fma_f32 v[72:73], v[88:89], v[140:141], v[72:73] neg_lo:[1,0,0] neg_hi:[1,0,0]
    v_pk_fma_f32 v[76:77], v[92:93], v[140:141], v[76:77] neg_lo:[1,0,0] neg_hi:[1,0,0]
    v_pk_mul_f32 v[64:65], v[64:65], v[156:157]
    v_pk_mul_f32 v[68:69], v[68:69], v[156:157]
    v_pk_mul_f32 v[72:73], v[72:73], v[156:157]
    v_pk_mul_f32 v[76:77], v[76:77], v[156:157]
    v_pk_fma_f32 v[64:65], v[164:165], v[50:51], v[64:65] op_sel:[0,0,0] op_sel_hi:[0,1,1]
    v_pk_fma_f32 v[72:73], v[164:165], v[58:59], v[72:73] op_sel:[0,0,0] op_sel_hi:[0,1,1]
    v_pk_fma_f32 v[68:69], v[166:167], v[54:55], v[68:69] op_sel:[0,0,0] op_sel_hi:[0,1,1]
    v_pk_fma_f32 v[76:77], v[166:167], v[62:63], v[76:77] op_sel:[0,0,0] op_sel_hi:[0,1,1]
    v_pk_fma_f32 v[64:65], v[164:165], v[58:59], v[64:65] op_sel:[1,0,0] op_sel_hi:[1,1,1] neg_lo:[1,0,0] neg_hi:[1,0,0]
    v_pk_fma_f32 v[72:73], v[164:165], v[50:51], v[72:73] op_sel:[1,0,0] op_sel_hi:[1,1,1]
    v_pk_fma_f32 v[68:69], v[166:167], v[62:63], v[68:69] op_sel:[1,0,0] op_sel_hi:[1,1,1] neg_lo:[1,0,0] neg_hi:[1,0,0]
    v_pk_fma_f32 v[76:77], v[166:167], v[54:55], v[76:77] op_sel:[1,0,0] op_sel_hi:[1,1,1]
    v_pk_fma_f32 v[66:67], v[80:81], v[142:143], v[66:67] neg_lo:[1,0,0] neg_hi:[1,0,0]
    v_pk_fma_f32 v[70:71], v[84:85], v[142:143], v[70:71] neg_lo:[1,0,0] neg_hi:[1,0,0]
    v_pk_fma_f32 v[74:75], v[88:89], v[142:143], v[74:75] neg_lo:[1,0,0] neg_hi:[1,0,0]
    v_pk_fma_f32 v[78:79], v[92:93], v[142:143], v[78:79] neg_lo:[1,0,0] neg_hi:[1,0,0]
    v_pk_mul_f32 v[66:67], v[66:67], v[158:159]
    v_pk_mul_f32 v[70:71], v[70:71], v[158:159]
    v_pk_mul_f32 v[74:75], v[74:75], v[158:159]
    v_pk_mul_f32 v[78:79], v[78:79], v[158:159]
    v_pk_fma_f32 v[66:67], v[164:165], v[64:65], v[66:67] op_sel:[0,0,0] op_sel_hi:[0,1,1]
    v_pk_fma_f32 v[74:75], v[164:165], v[72:73], v[74:75] op_sel:[0,0,0] op_sel_hi:[0,1,1]
    v_pk_fma_f32 v[70:71], v[166:167], v[68:69], v[70:71] op_sel:[0,0,0] op_sel_hi:[0,1,1]
    v_pk_fma_f32 v[78:79], v[166:167], v[76:77], v[78:79] op_sel:[0,0,0] op_sel_hi:[0,1,1]
    v_pk_fma_f32 v[66:67], v[164:165], v[72:73], v[66:67] op_sel:[1,0,0] op_sel_hi:[1,1,1] neg_lo:[1,0,0] neg_hi:[1,0,0]
    v_pk_fma_f32 v[74:75], v[164:165], v[64:65], v[74:75] op_sel:[1,0,0] op_sel_hi:[1,1,1]
    v_pk_fma_f32 v[70:71], v[166:167], v[76:77], v[70:71] op_sel:[1,0,0] op_sel_hi:[1,1,1] neg_lo:[1,0,0] neg_hi:[1,0,0]
    v_pk_fma_f32 v[78:79], v[166:167], v[68:69], v[78:79] op_sel:[1,0,0] op_sel_hi:[1,1,1]
    v_mov_b32 v188, v66
    v_mov_b32 v189, v74
    v_mov_b32 v192, v67
    v_mov_b32 v193, v75
    v_mov_b32 v190, v70
    v_mov_b32 v191, v78
    v_mov_b32 v194, v71
    v_mov_b32 v195, v79
    v_pk_fma_f32 v[192:193], v[188:189], v[168:169], v[192:193] op_sel_hi:[1,0,1]
    v_pk_fma_f32 v[194:195], v[190:191], v[170:171], v[194:195] op_sel_hi:[1,0,1]
    v_fma_f32 v192, -v189, v169, v192
    v_fma_f32 v194, -v191, v171, v194
    v_fma_f32 v193, v188, v169, v193
    v_fma_f32 v195, v190, v171, v195
    v_mov_b64 v[196:197], v[192:193]
    v_mov_b64 v[198:199], v[194:195]
    s_nop 0
    v_permlane16_swap_b32 v192, v196
    v_permlane16_swap_b32 v193, v197
    v_permlane16_swap_b32 v194, v198
    v_permlane16_swap_b32 v195, v199
    v_pk_fma_f32 v[200:201], v[192:193], v[172:173], v[196:197] op_sel_hi:[1,0,1]
    v_pk_fma_f32 v[202:203], v[194:195], v[174:175], v[198:199] op_sel_hi:[1,0,1]
    v_fma_f32 v200, -v193, v173, v200
    v_fma_f32 v202, -v195, v175, v202
    v_fma_f32 v201, v192, v173, v201
    v_fma_f32 v203, v194, v175, v203
    v_mov_b64 v[204:205], v[200:201]
    v_mov_b64 v[206:207], v[202:203]
    s_nop 0
    v_permlane32_swap_b32 v200, v204
    v_permlane32_swap_b32 v201, v205
    v_permlane32_swap_b32 v202, v206
    v_permlane32_swap_b32 v203, v207
    v_pk_fma_f32 v[208:209], v[200:201], v[176:177], v[204:205] op_sel_hi:[1,0,1]
    v_pk_fma_f32 v[210:211], v[202:203], v[178:179], v[206:207] op_sel_hi:[1,0,1]
    v_fma_f32 v208, -v201, v177, v208
    v_fma_f32 v210, -v203, v179, v210
    v_fma_f32 v209, v200, v177, v209
    v_fma_f32 v211, v202, v179, v211
    s_mov_b64 exec, 0xffff
    ds_write_b128 v10, v[208:211] offset:2048
    s_mov_b64 exec, -1
    s_waitcnt lgkmcnt(0)
    s_barrier
    ds_read_b128 v[100:103], v8 offset:2048
    ds_read_b128 v[104:107], v8 offset:2304
    ds_read_b128 v[108:111], v8 offset:2560
    ds_read_b128 v[112:115], v8 offset:2816
    s_waitcnt lgkmcnt(0)
    v_pk_fma_f32 v[104:105], v[100:101], v[180:181], v[104:105] op_sel_hi:[1,0,1]
    v_pk_fma_f32 v[106:107], v[102:103], v[182:183], v[106:107] op_sel_hi:[1,0,1]
    v_fma_f32 v104, -v101, v181, v104
    v_fma_f32 v106, -v103, v183, v106
    v_fma_f32 v105, v100, v181, v105
    v_fma_f32 v107, v102, v183, v107
    v_pk_fma_f32 v[108:109], v[104:105], v[180:181], v[108:109] op_sel_hi:[1,0,1]
    v_pk_fma_f32 v[110:111], v[106:107], v[182:183], v[110:111] op_sel_hi:[1,0,1]
    v_fma_f32 v108, -v105, v181, v108
    v_fma_f32 v110, -v107, v183, v110
    v_fma_f32 v109, v104, v181, v109
    v_fma_f32 v111, v106, v183, v111
    v_pk_fma_f32 v[112:113], v[108:109], v[180:181], v[112:113] op_sel_hi:[1,0,1]
    v_pk_fma_f32 v[114:115], v[110:111], v[182:183], v[114:115] op_sel_hi:[1,0,1]
    v_fma_f32 v112, -v109, v181, v112
    v_fma_f32 v114, -v111, v183, v114
    v_fma_f32 v113, v108, v181, v113
    v_fma_f32 v115, v110, v183, v115
    s_cmp_lg_u32 s33, 3
    s_cbranch_scc1 Lskip_35
    v_min_u32 v208, 0xfffffffe, v112
    v_min_u32 v209, 0xfffffffe, v113
    v_min_u32 v210, 0xfffffffe, v114
    v_min_u32 v211, 0xfffffffe, v115
    s_mov_b64 exec, 0xffff
    buffer_store_dwordx4 v[208:211], v5, s[8:11], s51 offen sc1
    s_mov_b64 exec, -1
Lskip_35:
    v_mov_b32 v204, 0
    v_mov_b32 v205, 0
    v_mov_b32 v206, 0
    v_mov_b32 v207, 0
    s_cmp_eq_u32 s33, 1
    s_cselect_b64 s[62:63], -1, 0
    v_cndmask_b32 v204, v204, v100, s[62:63]
    v_cndmask_b32 v205, v205, v101, s[62:63]
    v_cndmask_b32 v206, v206, v102, s[62:63]
    v_cndmask_b32 v207, v207, v103, s[62:63]
    s_cmp_eq_u32 s33, 2
    s_cselect_b64 s[62:63], -1, 0
    v_cndmask_b32 v204, v204, v104, s[62:63]
    v_cndmask_b32 v205, v205, v105, s[62:63]
    v_cndmask_b32 v206, v206, v106, s[62:63]
    v_cndmask_b32 v207, v207, v107, s[62:63]
    s_cmp_eq_u32 s33, 3
    s_cselect_b64 s[62:63], -1, 0
    v_cndmask_b32 v204, v204, v108, s[62:63]
    v_cndmask_b32 v205, v205, v109, s[62:63]
    v_cndmask_b32 v206, v206, v110, s[62:63]
    v_cndmask_b32 v207, v207, v111, s[62:63]
    v_and_b32 v14, 1, v4
    v_cmp_eq_u32 vcc, 1, v14
    v_cmp_lt_u32 s[62:63], 1, v4
    s_nop 0
    v_cndmask_b32 v116, 0, v192, vcc
    v_cndmask_b32 v117, 0, v193, vcc
    v_cndmask_b32 v196, 1.0, v172, vcc
    v_cndmask_b32 v197, 0, v173, vcc
    v_cndmask_b32 v196, 0, v196, s[62:63]
    v_cndmask_b32 v197, 0, v197, s[62:63]
    v_pk_fma_f32 v[116:117], v[200:201], v[196:197], v[116:117] op_sel_hi:[1,0,1]
    s_nop 0
    v_fma_f32 v116, -v201, v197, v116
    v_fma_f32 v117, v200, v197, v117
    v_cndmask_b32 v118, 0, v194, vcc
    v_cndmask_b32 v119, 0, v195, vcc
    v_cndmask_b32 v198, 1.0, v174, vcc
    v_cndmask_b32 v199, 0, v175, vcc
    v_cndmask_b32 v198, 0, v198, s[62:63]
    v_cndmask_b32 v199, 0, v199, s[62:63]
    v_pk_fma_f32 v[118:119], v[202:203], v[198:199], v[118:119] op_sel_hi:[1,0,1]
    s_nop 0
    v_fma_f32 v118, -v203, v199, v118
    v_fma_f32 v119, v202, v199, v119
    v_pk_fma_f32 v[116:117], v[204:205], v[224:225], v[116:117] op_sel_hi:[1,0,1]
    v_pk_fma_f32 v[118:119], v[206:207], v[226:227], v[118:119] op_sel_hi:[1,0,1]
    v_fma_f32 v116, -v205, v225, v116
    v_fma_f32 v118, -v207, v227, v118
    v_fma_f32 v117, v204, v225, v117
    v_fma_f32 v119, v206, v227, v119
    v_pk_mul_f32 v[80:81], v[234:235], v[164:165] op_sel_hi:[1,0]
    v_pk_mul_f32 v[88:89], v[242:243], v[166:167] op_sel_hi:[1,0]
    v_fma_f32 v80, -v235, v165, v80
    v_fma_f32 v88, -v243, v167, v88
    v_fma_f32 v81, v234, v165, v81
    v_fma_f32 v89, v242, v167, v89
    v_pk_mul_f32 v[82:83], v[80:81], v[164:165] op_sel_hi:[1,0]
    v_pk_mul_f32 v[90:91], v[88:89], v[166:167] op_sel_hi:[1,0]
    v_fma_f32 v82, -v81, v165, v82
    v_fma_f32 v90, -v89, v167, v90
    v_fma_f32 v83, v80, v165, v83
    v_fma_f32 v91, v88, v167, v91
    v_pk_mul_f32 v[84:85], v[82:83], v[164:165] op_sel_hi:[1,0]
    v_pk_mul_f32 v[92:93], v[90:91], v[166:167] op_sel_hi:[1,0]
    v_fma_f32 v84, -v83, v165, v84
    v_fma_f32 v92, -v91, v167, v92
    v_fma_f32 v85, v82, v165, v85
    v_fma_f32 v93, v90, v167, v93
    v_pk_mul_f32 v[86:87], v[84:85], v[164:165] op_sel_hi:[1,0]
    v_pk_mul_f32 v[94:95], v[92:93], v[166:167] op_sel_hi:[1,0]
    v_fma_f32 v86, -v85, v165, v86
    v_fma_f32 v94, -v93, v167, v94
    v_fma_f32 v87, v84, v165, v87
    v_fma_f32 v95, v92, v167, v95
    v_pk_mul_f32 v[128:129], v[16:17], v[184:185] op_sel_hi:[1,0]
    v_pk_mul_f32 v[144:145], v[20:21], v[186:187] op_sel_hi:[1,0]
    v_pk_fma_f32 v[128:129], v[184:185], v[24:25], v[128:129] op_sel:[1,0,0] op_sel_hi:[1,1,1] neg_lo:[1,0,0] neg_hi:[1,0,0]
    v_pk_fma_f32 v[144:145], v[186:187], v[28:29], v[144:145] op_sel:[1,0,0] op_sel_hi:[1,1,1] neg_lo:[1,0,0] neg_hi:[1,0,0]
    v_pk_mul_f32 v[24:25], v[24:25], v[184:185] op_sel_hi:[1,0] neg_lo:[1,0] neg_hi:[1,0]
    v_pk_mul_f32 v[28:29], v[28:29], v[186:187] op_sel_hi:[1,0] neg_lo:[1,0] neg_hi:[1,0]
    v_pk_fma_f32 v[24:25], v[184:185], v[16:17], v[24:25] op_sel:[1,0,0] op_sel_hi:[1,1,1] neg_lo:[1,0,0] neg_hi:[1,0,0]
    v_pk_fma_f32 v[28:29], v[186:187], v[20:21], v[28:29] op_sel:[1,0,0] op_sel_hi:[1,1,1] neg_lo:[1,0,0] neg_hi:[1,0,0]
    v_pk_mul_f32 v[130:131], v[18:19], v[184:185] op_sel_hi:[1,0]
    v_pk_mul_f32 v[146:147], v[22:23], v[186:187] op_sel_hi:[1,0]
    v_pk_fma_f32 v[130:131], v[184:185], v[26:27], v[130:131] op_sel:[1,0,0] op_sel_hi:[1,1,1] neg_lo:[1,0,0] neg_hi:[1,0,0]
    v_pk_fma_f32 v[146:147], v[186:187], v[30:31], v[146:147] op_sel:[1,0,0] op_sel_hi:[1,1,1] neg_lo:[1,0,0] neg_hi:[1,0,0]
    v_pk_mul_f32 v[26:27], v[26:27], v[184:185] op_sel_hi:[1,0] neg_lo:[1,0] neg_hi:[1,0]
    v_pk_mul_f32 v[30:31], v[30:31], v[186:187] op_sel_hi:[1,0] neg_lo:[1,0] neg_hi:[1,0]
    v_pk_fma_f32 v[26:27], v[184:185], v[18:19], v[26:27] op_sel:[1,0,0] op_sel_hi:[1,1,1] neg_lo:[1,0,0] neg_hi:[1,0,0]
    v_pk_fma_f32 v[30:31], v[186:187], v[22:23], v[30:31] op_sel:[1,0,0] op_sel_hi:[1,1,1] neg_lo:[1,0,0] neg_hi:[1,0,0]
    v_pk_mul_f32 v[132:133], v[32:33], v[184:185] op_sel_hi:[1,0]
    v_pk_mul_f32 v[148:149], v[36:37], v[186:187] op_sel_hi:[1,0]
    v_pk_fma_f32 v[132:133], v[184:185], v[40:41], v[132:133] op_sel:[1,0,0] op_sel_hi:[1,1,1] neg_lo:[1,0,0] neg_hi:[1,0,0]
    v_pk_fma_f32 v[148:149], v[186:187], v[44:45], v[148:149] op_sel:[1,0,0] op_sel_hi:[1,1,1] neg_lo:[1,0,0] neg_hi:[1,0,0]
    v_pk_mul_f32 v[40:41], v[40:41], v[184:185] op_sel_hi:[1,0] neg_lo:[1,0] neg_hi:[1,0]
    v_pk_mul_f32 v[44:45], v[44:45], v[186:187] op_sel_hi:[1,0] neg_lo:[1,0] neg_hi:[1,0]
    v_pk_fma_f32 v[40:41], v[184:185], v[32:33], v[40:41] op_sel:[1,0,0] op_sel_hi:[1,1,1] neg_lo:[1,0,0] neg_hi:[1,0,0]
    v_pk_fma_f32 v[44:45], v[186:187], v[36:37], v[44:45] op_sel:[1,0,0] op_sel_hi:[1,1,1] neg_lo:[1,0,0] neg_hi:[1,0,0]
    v_pk_mul_f32 v[134:135], v[34:35], v[184:185] op_sel_hi:[1,0]
    v_pk_mul_f32 v[150:151], v[38:39], v[186:187] op_sel_hi:[1,0]
    v_pk_fma_f32 v[134:135], v[184:185], v[42:43], v[134:135] op_sel:[1,0,0] op_sel_hi:[1,1,1] neg_lo:[1,0,0] neg_hi:[1,0,0]
    v_pk_fma_f32 v[150:151], v[186:187], v[46:47], v[150:151] op_sel:[1,0,0] op_sel_hi:[1,1,1] neg_lo:[1,0,0] neg_hi:[1,0,0]
    v_pk_mul_f32 v[42:43], v[42:43], v[184:185] op_sel_hi:[1,0] neg_lo:[1,0] neg_hi:[1,0]
    v_pk_mul_f32 v[46:47], v[46:47], v[186:187] op_sel_hi:[1,0] neg_lo:[1,0] neg_hi:[1,0]
    v_pk_fma_f32 v[42:43], v[184:185], v[34:35], v[42:43] op_sel:[1,0,0] op_sel_hi:[1,1,1] neg_lo:[1,0,0] neg_hi:[1,0,0]
    v_pk_fma_f32 v[46:47], v[186:187], v[38:39], v[46:47] op_sel:[1,0,0] op_sel_hi:[1,1,1] neg_lo:[1,0,0] neg_hi:[1,0,0]
    v_pk_mul_f32 v[136:137], v[48:49], v[184:185] op_sel_hi:[1,0]
    v_pk_mul_f32 v[152:153], v[52:53], v[186:187] op_sel_hi:[1,0]
    v_pk_fma_f32 v[136:137], v[184:185], v[56:57], v[136:137] op_sel:[1,0,0] op_sel_hi:[1,1,1] neg_lo:[1,0,0] neg_hi:[1,0,0]
    v_pk_fma_f32 v[152:153], v[186:187], v[60:61], v[152:153] op_sel:[1,0,0] op_sel_hi:[1,1,1] neg_lo:[1,0,0] neg_hi:[1,0,0]
    v_pk_mul_f32 v[56:57], v[56:57], v[184:185] op_sel_hi:[1,0] neg_lo:[1,0] neg_hi:[1,0]
    v_pk_mul_f32 v[60:61], v[60:61], v[186:187] op_sel_hi:[1,0] neg_lo:[1,0] neg_hi:[1,0]
    v_pk_fma_f32 v[56:57], v[184:185], v[48:49], v[56:57] op_sel:[1,0,0] op_sel_hi:[1,1,1] neg_lo:[1,0,0] neg_hi:[1,0,0]
    v_pk_fma_f32 v[60:61], v[186:187], v[52:53], v[60:61] op_sel:[1,0,0] op_sel_hi:[1,1,1] neg_lo:[1,0,0] neg_hi:[1,0,0]
    v_pk_mul_f32 v[138:139], v[50:51], v[184:185] op_sel_hi:[1,0]
    v_pk_mul_f32 v[154:155], v[54:55], v[186:187] op_sel_hi:[1,0]
    v_pk_fma_f32 v[138:139], v[184:185], v[58:59], v[138:139] op_sel:[1,0,0] op_sel_hi:[1,1,1] neg_lo:[1,0,0] neg_hi:[1,0,0]
    v_pk_fma_f32 v[154:155], v[186:187], v[62:63], v[154:155] op_sel:[1,0,0] op_sel_hi:[1,1,1] neg_lo:[1,0,0] neg_hi:[1,0,0]
    v_pk_mul_f32 v[58:59], v[58:59], v[184:185] op_sel_hi:[1,0] neg_lo:[1,0] neg_hi:[1,0]
    v_pk_mul_f32 v[62:63], v[62:63], v[186:187] op_sel_hi:[1,0] neg_lo:[1,0] neg_hi:[1,0]
    v_pk_fma_f32 v[58:59], v[184:185], v[50:51], v[58:59] op_sel:[1,0,0] op_sel_hi:[1,1,1] neg_lo:[1,0,0] neg_hi:[1,0,0]
    v_pk_fma_f32 v[62:63], v[186:187], v[54:55], v[62:63] op_sel:[1,0,0] op_sel_hi:[1,1,1] neg_lo:[1,0,0] neg_hi:[1,0,0]
    v_pk_mul_f32 v[140:141], v[64:65], v[184:185] op_sel_hi:[1,0]
    v_pk_mul_f32 v[156:157], v[68:69], v[186:187] op_sel_hi:[1,0]
    v_pk_fma_f32 v[140:141], v[184:185], v[72:73], v[140:141] op_sel:[1,0,0] op_sel_hi:[1,1,1] neg_lo:[1,0,0] neg_hi:[1,0,0]
    v_pk_fma_f32 v[156:157], v[186:187], v[76:77], v[156:157] op_sel:[1,0,0] op_sel_hi:[1,1,1] neg_lo:[1,0,0] neg_hi:[1,0,0]
    v_pk_mul_f32 v[72:73], v[72:73], v[184:185] op_sel_hi:[1,0] neg_lo:[1,0] neg_hi:[1,0]
    v_pk_mul_f32 v[76:77], v[76:77], v[186:187] op_sel_hi:[1,0] neg_lo:[1,0] neg_hi:[1,0]
    v_pk_fma_f32 v[72:73], v[184:185], v[64:65], v[72:73] op_sel:[1,0,0] op_sel_hi:[1,1,1] neg_lo:[1,0,0] neg_hi:[1,0,0]
    v_pk_fma_f32 v[76:77], v[186:187], v[68:69], v[76:77] op_sel:[1,0,0] op_sel_hi:[1,1,1] neg_lo:[1,0,0] neg_hi:[1,0,0]
    v_pk_mul_f32 v[142:143], v[66:67], v[184:185] op_sel_hi:[1,0]
    v_pk_mul_f32 v[158:159], v[70:71], v[186:187] op_sel_hi:[1,0]
    v_pk_fma_f32 v[142:143], v[184:185], v[74:75], v[142:143] op_sel:[1,0,0] op_sel_hi:[1,1,1] neg_lo:[1,0,0] neg_hi:[1,0,0]
    v_pk_fma_f32 v[158:159], v[186:187], v[78:79], v[158:159] op_sel:[1,0,0] op_sel_hi:[1,1,1] neg_lo:[1,0,0] neg_hi:[1,0,0]
    v_pk_mul_f32 v[74:75], v[74:75], v[184:185] op_sel_hi:[1,0] neg_lo:[1,0] neg_hi:[1,0]
    v_pk_mul_f32 v[78:79], v[78:79], v[186:187] op_sel_hi:[1,0] neg_lo:[1,0] neg_hi:[1,0]
    v_pk_fma_f32 v[74:75], v[184:185], v[66:67], v[74:75] op_sel:[1,0,0] op_sel_hi:[1,1,1] neg_lo:[1,0,0] neg_hi:[1,0,0]
    v_pk_fma_f32 v[78:79], v[186:187], v[70:71], v[78:79] op_sel:[1,0,0] op_sel_hi:[1,1,1] neg_lo:[1,0,0] neg_hi:[1,0,0]
    buffer_load_dwordx4 v[108:111], v11, s[8:11], s52 offen sc1
    buffer_load_dwordx4 v[112:115], v12, s[8:11], s52 offen sc1
    s_lshl_b32 s55, s32, 12
    s_add_u32 s55, s55, 0
    v_lshl_add_u32 v14, v4, 10, v7
    v_add_u32 v14, s55, v14
    v_xor_b32 v15, 64, v14
    v_add_u32 v15, 512, v15
    v_bfe_u32 v13, v1, 1, 1
    v_bfe_u32 v8, v1, 2, 2
    v_lshl_add_u32 v8, v4, 3, v8
    v_lshlrev_b32 v9, 2, v13
    v_xor_b32 v8, v8, v9
    v_lshlrev_b32 v8, 4, v8
    v_lshl_add_u32 v8, v13, 9, v8
    v_and_b32 v9, 1, v1
    v_lshl_add_u32 v8, v9, 3, v8
    v_add_u32 v8, s55, v8
    v_xor_b32 v9, 64, v8
    s_lshl_b32 s55, s35, 4
    s_lshl_b32 s56, s33, 2
    s_add_u32 s55, s55, s56
    s_mul_i32 s55, s55, 40
    s_lshl_b32 s56, s36, 1
    s_add_u32 s55, s55, s56
    s_add_u32 s55, s55, s34
    s_lshl_b32 s55, s55, 10
    s_add_u32 s58, s55, 12582912
    s_mov_b32 s60, 0
Lag_36:
    s_waitcnt vmcnt(0)
    v_max_u32 v2, v108, v109
    v_max3_u32 v2, v2, v110, v111
    v_max3_u32 v2, v2, v112, v113
    v_max3_u32 v2, v2, v114, v115
    v_cmp_eq_u32 vcc, -1, v2
    s_nop 1
    s_cmp_eq_u64 vcc, 0
    s_cbranch_scc1 Lagd_37
    buffer_load_dwordx4 v[108:111], v11, s[8:11], s52 offen sc1
    buffer_load_dwordx4 v[112:115], v12, s[8:11], s52 offen sc1
    s_add_u32 s60, s60, 1
    s_cmp_lt_u32 s60, 100000
    s_cbranch_scc1 Lag_36
    s_waitcnt vmcnt(0)
Lagd_37:
    v_pk_mul_f32 v[192:193], v[108:109], v[212:213] op_sel_hi:[1,0]
    v_pk_mul_f32 v[194:195], v[110:111], v[214:215] op_sel_hi:[1,0]
    v_fma_f32 v192, -v109, v213, v192
    v_fma_f32 v194, -v111, v215, v194
    v_fma_f32 v193, v108, v213, v193
    v_fma_f32 v195, v110, v215, v195
    v_pk_fma_f32 v[192:193], v[112:113], v[216:217], v[192:193] op_sel_hi:[1,0,1]
    v_pk_fma_f32 v[194:195], v[114:115], v[218:219], v[194:195] op_sel_hi:[1,0,1]
    v_fma_f32 v192, -v113, v217, v192
    v_fma_f32 v194, -v115, v219, v194
    v_fma_f32 v193, v112, v217, v193
    v_fma_f32 v195, v114, v219, v195
    v_mov_b64 v[196:197], v[192:193]
    v_mov_b64 v[198:199], v[194:195]
    s_nop 0
    v_permlane16_swap_b32 v192, v196
    v_permlane16_swap_b32 v193, v197
    v_permlane16_swap_b32 v194, v198
    v_permlane16_swap_b32 v195, v199
    v_pk_add_f32 v[192:193], v[192:193], v[196:197]
    v_pk_add_f32 v[194:195], v[194:195], v[198:199]
    v_mov_b64 v[196:197], v[192:193]
    v_mov_b64 v[198:199], v[194:195]
    s_nop 0
    v_permlane32_swap_b32 v192, v196
    v_permlane32_swap_b32 v193, v197
    v_permlane32_swap_b32 v194, v198
    v_permlane32_swap_b32 v195, v199
    v_pk_add_f32 v[192:193], v[192:193], v[196:197]
    v_pk_add_f32 v[194:195], v[194:195], v[198:199]
    v_pk_fma_f32 v[116:117], v[192:193], v[160:161], v[116:117] op_sel_hi:[1,0,1]
    v_pk_fma_f32 v[118:119], v[194:195], v[162:163], v[118:119] op_sel_hi:[1,0,1]
    v_fma_f32 v116, -v193, v161, v116
    v_fma_f32 v118, -v195, v163, v118
    v_fma_f32 v117, v192, v161, v117
    v_fma_f32 v119, v194, v163, v119
    v_pk_fma_f32 v[188:189], v[116:117], v[168:169], v[188:189] op_sel_hi:[1,0,1]
    v_pk_fma_f32 v[190:191], v[118:119], v[170:171], v[190:191] op_sel_hi:[1,0,1]
    v_fma_f32 v188, -v117, v169, v188
    v_fma_f32 v190, -v119, v171, v190
    v_fma_f32 v189, v116, v169, v189
    v_fma_f32 v191, v118, v171, v191
    v_mov_b32 v200, v116
    v_mov_b32 v201, v188
    v_mov_b32 v204, v117
    v_mov_b32 v205, v189
    v_mov_b32 v202, v118
    v_mov_b32 v203, v190
    v_mov_b32 v206, v119
    v_mov_b32 v207, v191
    v_pk_fma_f32 v[128:129], v[228:229], v[200:201], v[128:129] op_sel:[0,0,0] op_sel_hi:[0,1,1]
    v_pk_fma_f32 v[130:131], v[230:231], v[200:201], v[130:131] op_sel:[0,0,0] op_sel_hi:[0,1,1]
    v_pk_fma_f32 v[132:133], v[232:233], v[200:201], v[132:133] op_sel:[0,0,0] op_sel_hi:[0,1,1]
    v_pk_fma_f32 v[134:135], v[234:235], v[200:201], v[134:135] op_sel:[0,0,0] op_sel_hi:[0,1,1]
    v_pk_fma_f32 v[136:137], v[80:81], v[200:201], v[136:137] op_sel:[0,0,0] op_sel_hi:[0,1,1]
    v_pk_fma_f32 v[138:139], v[82:83], v[200:201], v[138:139] op_sel:[0,0,0] op_sel_hi:[0,1,1]
    v_pk_fma_f32 v[140:141], v[84:85], v[200:201], v[140:141] op_sel:[0,0,0] op_sel_hi:[0,1,1]
    v_pk_fma_f32 v[142:143], v[86:87], v[200:201], v[142:143] op_sel:[0,0,0] op_sel_hi:[0,1,1]
    v_pk_fma_f32 v[128:129], v[228:229], v[204:205], v[128:129] op_sel:[1,0,0] op_sel_hi:[1,1,1] neg_lo:[1,0,0] neg_hi:[1,0,0]
    v_pk_fma_f32 v[130:131], v[230:231], v[204:205], v[130:131] op_sel:[1,0,0] op_sel_hi:[1,1,1] neg_lo:[1,0,0] neg_hi:[1,0,0]
    v_pk_fma_f32 v[132:133], v[232:233], v[204:205], v[132:133] op_sel:[1,0,0] op_sel_hi:[1,1,1] neg_lo:[1,0,0] neg_hi:[1,0,0]
    v_pk_fma_f32 v[134:135], v[234:235], v[204:205], v[134:135] op_sel:[1,0,0] op_sel_hi:[1,1,1] neg_lo:[1,0,0] neg_hi:[1,0,0]
    v_pk_fma_f32 v[136:137], v[80:81], v[204:205], v[136:137] op_sel:[1,0,0] op_sel_hi:[1,1,1] neg_lo:[1,0,0] neg_hi:[1,0,0]
    v_pk_fma_f32 v[138:139], v[82:83], v[204:205], v[138:139] op_sel:[1,0,0] op_sel_hi:[1,1,1] neg_lo:[1,0,0] neg_hi:[1,0,0]
    v_pk_fma_f32 v[140:141], v[84:85], v[204:205], v[140:141] op_sel:[1,0,0] op_sel_hi:[1,1,1] neg_lo:[1,0,0] neg_hi:[1,0,0]
    v_pk_fma_f32 v[142:143], v[86:87], v[204:205], v[142:143] op_sel:[1,0,0] op_sel_hi:[1,1,1] neg_lo:[1,0,0] neg_hi:[1,0,0]
    v_cvt_pk_bf16_f32 v16, v128, v130
    v_cvt_pk_bf16_f32 v17, v132, v134
    v_cvt_pk_bf16_f32 v18, v136, v138
    v_cvt_pk_bf16_f32 v19, v140, v142
    ds_write_b128 v14, v[16:19] offset:0
    v_cvt_pk_bf16_f32 v32, v129, v131
    v_cvt_pk_bf16_f32 v33, v133, v135
    v_cvt_pk_bf16_f32 v34, v137, v139
    v_cvt_pk_bf16_f32 v35, v141, v143
    ds_write_b128 v15, v[32:35] offset:0
    v_pk_fma_f32 v[144:145], v[236:237], v[202:203], v[144:145] op_sel:[0,0,0] op_sel_hi:[0,1,1]
    v_pk_fma_f32 v[146:147], v[238:239], v[202:203], v[146:147] op_sel:[0,0,0] op_sel_hi:[0,1,1]
    v_pk_fma_f32 v[148:149], v[240:241], v[202:203], v[148:149] op_sel:[0,0,0] op_sel_hi:[0,1,1]
    v_pk_fma_f32 v[150:151], v[242:243], v[202:203], v[150:151] op_sel:[0,0,0] op_sel_hi:[0,1,1]
    v_pk_fma_f32 v[152:153], v[88:89], v[202:203], v[152:153] op_sel:[0,0,0] op_sel_hi:[0,1,1]
    v_pk_fma_f32 v[154:155], v[90:91], v[202:203], v[154:155] op_sel:[0,0,0] op_sel_hi:[0,1,1]
    v_pk_fma_f32 v[156:157], v[92:93], v[202:203], v[156:157] op_sel:[0,0,0] op_sel_hi:[0,1,1]
    v_pk_fma_f32 v[158:159], v[94:95], v[202:203], v[158:159] op_sel:[0,0,0] op_sel_hi:[0,1,1]
    v_pk_fma_f32 v[144:145], v[236:237], v[206:207], v[144:145] op_sel:[1,0,0] op_sel_hi:[1,1,1] neg_lo:[1,0,0] neg_hi:[1,0,0]
    v_pk_fma_f32 v[146:147], v[238:239], v[206:207], v[146:147] op_sel:[1,0,0] op_sel_hi:[1,1,1] neg_lo:[1,0,0] neg_hi:[1,0,0]
    v_pk_fma_f32 v[148:149], v[240:241], v[206:207], v[148:149] op_sel:[1,0,0] op_sel_hi:[1,1,1] neg_lo:[1,0,0] neg_hi:[1,0,0]
    v_pk_fma_f32 v[150:151], v[242:243], v[206:207], v[150:151] op_sel:[1,0,0] op_sel_hi:[1,1,1] neg_lo:[1,0,0] neg_hi:[1,0,0]
    v_pk_fma_f32 v[152:153], v[88:89], v[206:207], v[152:153] op_sel:[1,0,0] op_sel_hi:[1,1,1] neg_lo:[1,0,0] neg_hi:[1,0,0]
    v_pk_fma_f32 v[154:155], v[90:91], v[206:207], v[154:155] op_sel:[1,0,0] op_sel_hi:[1,1,1] neg_lo:[1,0,0] neg_hi:[1,0,0]
    v_pk_fma_f32 v[156:157], v[92:93], v[206:207], v[156:157] op_sel:[1,0,0] op_sel_hi:[1,1,1] neg_lo:[1,0,0] neg_hi:[1,0,0]
    v_pk_fma_f32 v[158:159], v[94:95], v[206:207], v[158:159] op_sel:[1,0,0] op_sel_hi:[1,1,1] neg_lo:[1,0,0] neg_hi:[1,0,0]
    v_cvt_pk_bf16_f32 v20, v144, v146
    v_cvt_pk_bf16_f32 v21, v148, v150
    v_cvt_pk_bf16_f32 v22, v152, v154
    v_cvt_pk_bf16_f32 v23, v156, v158
    ds_write_b128 v14, v[20:23] offset:256
    v_cvt_pk_bf16_f32 v36, v145, v147
    v_cvt_pk_bf16_f32 v37, v149, v151
    v_cvt_pk_bf16_f32 v38, v153, v155
    v_cvt_pk_bf16_f32 v39, v157, v159
    ds_write_b128 v15, v[36:39] offset:256
    ds_read_b64_tr_b16 v[96:97], v8 offset:0
    ds_read_b64_tr_b16 v[98:99], v9 offset:0
    ds_read_b64_tr_b16 v[100:101], v8 offset:1024
    ds_read_b64_tr_b16 v[102:103], v9 offset:1024
    ds_read_b64_tr_b16 v[104:105], v8 offset:2048
    ds_read_b64_tr_b16 v[106:107], v9 offset:2048
    ds_read_b64_tr_b16 v[108:109], v8 offset:3072
    ds_read_b64_tr_b16 v[110:111], v9 offset:3072
    v_pk_fma_f32 v[24:25], v[228:229], v[204:205], v[24:25] op_sel:[0,0,0] op_sel_hi:[0,1,1] neg_lo:[1,0,0] neg_hi:[1,0,0]
    v_pk_fma_f32 v[26:27], v[230:231], v[204:205], v[26:27] op_sel:[0,0,0] op_sel_hi:[0,1,1] neg_lo:[1,0,0] neg_hi:[1,0,0]
    v_pk_fma_f32 v[40:41], v[232:233], v[204:205], v[40:41] op_sel:[0,0,0] op_sel_hi:[0,1,1] neg_lo:[1,0,0] neg_hi:[1,0,0]
    v_pk_fma_f32 v[42:43], v[234:235], v[204:205], v[42:43] op_sel:[0,0,0] op_sel_hi:[0,1,1] neg_lo:[1,0,0] neg_hi:[1,0,0]
    v_pk_fma_f32 v[56:57], v[80:81], v[204:205], v[56:57] op_sel:[0,0,0] op_sel_hi:[0,1,1] neg_lo:[1,0,0] neg_hi:[1,0,0]
    v_pk_fma_f32 v[58:59], v[82:83], v[204:205], v[58:59] op_sel:[0,0,0] op_sel_hi:[0,1,1] neg_lo:[1,0,0] neg_hi:[1,0,0]
    v_pk_fma_f32 v[72:73], v[84:85], v[204:205], v[72:73] op_sel:[0,0,0] op_sel_hi:[0,1,1] neg_lo:[1,0,0] neg_hi:[1,0,0]
    v_pk_fma_f32 v[74:75], v[86:87], v[204:205], v[74:75] op_sel:[0,0,0] op_sel_hi:[0,1,1] neg_lo:[1,0,0] neg_hi:[1,0,0]
    v_pk_fma_f32 v[24:25], v[228:229], v[200:201], v[24:25] op_sel:[1,0,0] op_sel_hi:[1,1,1] neg_lo:[1,0,0] neg_hi:[1,0,0]
    v_pk_fma_f32 v[26:27], v[230:231], v[200:201], v[26:27] op_sel:[1,0,0] op_sel_hi:[1,1,1] neg_lo:[1,0,0] neg_hi:[1,0,0]
    v_pk_fma_f32 v[40:41], v[232:233], v[200:201], v[40:41] op_sel:[1,0,0] op_sel_hi:[1,1,1] neg_lo:[1,0,0] neg_hi:[1,0,0]
    v_pk_fma_f32 v[42:43], v[234:235], v[200:201], v[42:43] op_sel:[1,0,0] op_sel_hi:[1,1,1] neg_lo:[1,0,0] neg_hi:[1,0,0]
    v_pk_fma_f32 v[56:57], v[80:81], v[200:201], v[56:57] op_sel:[1,0,0] op_sel_hi:[1,1,1] neg_lo:[1,0,0] neg_hi:[1,0,0]
    v_pk_fma_f32 v[58:59], v[82:83], v[200:201], v[58:59] op_sel:[1,0,0] op_sel_hi:[1,1,1] neg_lo:[1,0,0] neg_hi:[1,0,0]
    v_pk_fma_f32 v[72:73], v[84:85], v[200:201], v[72:73] op_sel:[1,0,0] op_sel_hi:[1,1,1] neg_lo:[1,0,0] neg_hi:[1,0,0]
    v_pk_fma_f32 v[74:75], v[86:87], v[200:201], v[74:75] op_sel:[1,0,0] op_sel_hi:[1,1,1] neg_lo:[1,0,0] neg_hi:[1,0,0]
    s_waitcnt lgkmcnt(0)
    s_add_u32 s55, s58, 0
    buffer_store_dwordx4 v[96:99], v5, s[8:11], s55 offen sc1
    s_add_u32 s55, s58, 40960
    buffer_store_dwordx4 v[100:103], v5, s[8:11], s55 offen sc1
    v_cvt_pk_bf16_f32 v48, v24, v26
    v_cvt_pk_bf16_f32 v49, v40, v42
    v_cvt_pk_bf16_f32 v50, v56, v58
    v_cvt_pk_bf16_f32 v51, v72, v74
    ds_write_b128 v14, v[48:51] offset:0
    v_cvt_pk_bf16_f32 v64, v25, v27
    v_cvt_pk_bf16_f32 v65, v41, v43
    v_cvt_pk_bf16_f32 v66, v57, v59
    v_cvt_pk_bf16_f32 v67, v73, v75
    ds_write_b128 v15, v[64:67] offset:0
    v_pk_fma_f32 v[28:29], v[236:237], v[206:207], v[28:29] op_sel:[0,0,0] op_sel_hi:[0,1,1] neg_lo:[1,0,0] neg_hi:[1,0,0]
    v_pk_fma_f32 v[30:31], v[238:239], v[206:207], v[30:31] op_sel:[0,0,0] op_sel_hi:[0,1,1] neg_lo:[1,0,0] neg_hi:[1,0,0]
    v_pk_fma_f32 v[44:45], v[240:241], v[206:207], v[44:45] op_sel:[0,0,0] op_sel_hi:[0,1,1] neg_lo:[1,0,0] neg_hi:[1,0,0]
    v_pk_fma_f32 v[46:47], v[242:243], v[206:207], v[46:47] op_sel:[0,0,0] op_sel_hi:[0,1,1] neg_lo:[1,0,0] neg_hi:[1,0,0]
    v_pk_fma_f32 v[60:61], v[88:89], v[206:207], v[60:61] op_sel:[0,0,0] op_sel_hi:[0,1,1] neg_lo:[1,0,0] neg_hi:[1,0,0]
    v_pk_fma_f32 v[62:63], v[90:91], v[206:207], v[62:63] op_sel:[0,0,0] op_sel_hi:[0,1,1] neg_lo:[1,0,0] neg_hi:[1,0,0]
    v_pk_fma_f32 v[76:77], v[92:93], v[206:207], v[76:77] op_sel:[0,0,0] op_sel_hi:[0,1,1] neg_lo:[1,0,0] neg_hi:[1,0,0]
    v_pk_fma_f32 v[78:79], v[94:95], v[206:207], v[78:79] op_sel:[0,0,0] op_sel_hi:[0,1,1] neg_lo:[1,0,0] neg_hi:[1,0,0]
    v_pk_fma_f32 v[28:29], v[236:237], v[202:203], v[28:29] op_sel:[1,0,0] op_sel_hi:[1,1,1] neg_lo:[1,0,0] neg_hi:[1,0,0]
    v_pk_fma_f32 v[30:31], v[238:239], v[202:203], v[30:31] op_sel:[1,0,0] op_sel_hi:[1,1,1] neg_lo:[1,0,0] neg_hi:[1,0,0]
    v_pk_fma_f32 v[44:45], v[240:241], v[202:203], v[44:45] op_sel:[1,0,0] op_sel_hi:[1,1,1] neg_lo:[1,0,0] neg_hi:[1,0,0]
    v_pk_fma_f32 v[46:47], v[242:243], v[202:203], v[46:47] op_sel:[1,0,0] op_sel_hi:[1,1,1] neg_lo:[1,0,0] neg_hi:[1,0,0]
    v_pk_fma_f32 v[60:61], v[88:89], v[202:203], v[60:61] op_sel:[1,0,0] op_sel_hi:[1,1,1] neg_lo:[1,0,0] neg_hi:[1,0,0]
    v_pk_fma_f32 v[62:63], v[90:91], v[202:203], v[62:63] op_sel:[1,0,0] op_sel_hi:[1,1,1] neg_lo:[1,0,0] neg_hi:[1,0,0]
    v_pk_fma_f32 v[76:77], v[92:93], v[202:203], v[76:77] op_sel:[1,0,0] op_sel_hi:[1,1,1] neg_lo:[1,0,0] neg_hi:[1,0,0]
    v_pk_fma_f32 v[78:79], v[94:95], v[202:203], v[78:79] op_sel:[1,0,0] op_sel_hi:[1,1,1] neg_lo:[1,0,0] neg_hi:[1,0,0]
    s_add_u32 s55, s58, 81920
    buffer_store_dwordx4 v[104:107], v5, s[8:11], s55 offen sc1
    s_add_u32 s55, s58, 122880
    buffer_store_dwordx4 v[108:111], v5, s[8:11], s55 offen sc1
    v_cvt_pk_bf16_f32 v52, v28, v30
    v_cvt_pk_bf16_f32 v53, v44, v46
    v_cvt_pk_bf16_f32 v54, v60, v62
    v_cvt_pk_bf16_f32 v55, v76, v78
    ds_write_b128 v14, v[52:55] offset:256
    v_cvt_pk_bf16_f32 v68, v29, v31
    v_cvt_pk_bf16_f32 v69, v45, v47
    v_cvt_pk_bf16_f32 v70, v61, v63
    v_cvt_pk_bf16_f32 v71, v77, v79
    ds_write_b128 v15, v[68:71] offset:256
    ds_read_b64_tr_b16 v[112:113], v8 offset:0
    ds_read_b64_tr_b16 v[114:115], v9 offset:0
    ds_read_b64_tr_b16 v[116:117], v8 offset:1024
    ds_read_b64_tr_b16 v[118:119], v9 offset:1024
    ds_read_b64_tr_b16 v[120:121], v8 offset:2048
    ds_read_b64_tr_b16 v[122:123], v9 offset:2048
    ds_read_b64_tr_b16 v[124:125], v8 offset:3072
    ds_read_b64_tr_b16 v[126:127], v9 offset:3072
    s_waitcnt lgkmcnt(6)
    s_add_u32 s55, s58, 20480
    buffer_store_dwordx4 v[112:115], v5, s[8:11], s55 offen sc1
    s_waitcnt lgkmcnt(4)
    s_add_u32 s55, s58, 61440
    buffer_store_dwordx4 v[116:119], v5, s[8:11], s55 offen sc1
    s_waitcnt lgkmcnt(2)
    s_add_u32 s55, s58, 102400
    buffer_store_dwordx4 v[120:123], v5, s[8:11], s55 offen sc1
    s_waitcnt lgkmcnt(0)
    s_add_u32 s55, s58, 143360
    buffer_store_dwordx4 v[124:127], v5, s[8:11], s55 offen sc1
    s_setprio 0
    s_waitcnt vmcnt(0)
    s_barrier
    s_cmp_lg_u32 s32, 0
    s_cbranch_scc1 Lskip_38
    s_lshl_b32 s60, s35, 5
    s_add_u32 s60, s60, s36
    s_lshl_b32 s60, s60, 7
    s_add_u32 s60, s60, 166656
    v_mov_b32 v2, 1
    s_mov_b64 exec, 1
    buffer_store_dword v2, off, s[8:11], s60 sc1
    s_mov_b64 exec, -1
Lskip_38:
    s_add_u32 s44, s30, 92160
    s_sub_u32 s45, s44, s31
    s_min_u32 s44, s44, s45
    s_add_u32 m0, s40, 0
    s_nop 0
    buffer_load_dwordx4 v247, s[8:11], s44 offen sc1 lds
    s_add_u32 s44, s30, 100352
    s_sub_u32 s45, s44, s31
    s_min_u32 s44, s44, s45
    s_add_u32 m0, s40, 8192
    s_nop 0
    buffer_load_dwordx4 v247, s[8:11], s44 offen sc1 lds
    s_add_u32 s44, s30, 108544
    s_sub_u32 s45, s44, s31
    s_min_u32 s44, s44, s45
    s_add_u32 m0, s40, 16384
    s_nop 0
    buffer_load_dwordx4 v247, s[8:11], s44 offen sc1 lds
    s_add_u32 s44, s30, 116736
    s_sub_u32 s45, s44, s31
    s_min_u32 s44, s44, s45
    s_add_u32 m0, s40, 24576
    s_nop 0
    buffer_load_dwordx4 v247, s[8:11], s44 offen sc1 lds
    s_add_u32 s44, s30, 124928
    s_sub_u32 s45, s44, s31
    s_min_u32 s44, s44, s45
    s_add_u32 m0, s40, 32768
    s_nop 0
    buffer_load_dwordx4 v247, s[8:11], s44 offen sc1 lds
    s_branch L_p2y
L_p2:
    s_nop 7
    s_nop 1
    s_cmp_ge_u32 s38, 4
    s_cbranch_scc1 L_p2y
    ds_read_b64_tr_b16 v[56:57], v245 offset:10240
    ds_read_b64_tr_b16 v[58:59], v245 offset:10752
    ds_read_b64_tr_b16 v[60:61], v245 offset:11264
    ds_read_b64_tr_b16 v[62:63], v245 offset:11776
    ds_read_b64_tr_b16 v[64:65], v245 offset:12288
    ds_read_b64_tr_b16 v[66:67], v245 offset:12800
    ds_read_b64_tr_b16 v[68:69], v245 offset:13312
    ds_read_b64_tr_b16 v[70:71], v245 offset:13824
    ds_read_b64_tr_b16 v[72:73], v245 offset:14336
    ds_read_b64_tr_b16 v[74:75], v245 offset:14848
    ds_read_b64_tr_b16 v[76:77], v245 offset:20480
    ds_read_b64_tr_b16 v[78:79], v245 offset:20992
    ds_read_b64_tr_b16 v[80:81], v245 offset:21504
    ds_read_b64_tr_b16 v[82:83], v245 offset:22016
    ds_read_b64_tr_b16 v[84:85], v245 offset:22528
    ds_read_b64_tr_b16 v[86:87], v245 offset:23040
    ds_read_b64_tr_b16 v[88:89], v245 offset:23552
    ds_read_b64_tr_b16 v[90:91], v245 offset:24064
    ds_read_b64_tr_b16 v[92:93], v245 offset:24576
    ds_read_b64_tr_b16 v[94:95], v245 offset:25088
    s_mov_b32 s12, s90
    s_mov_b32 s13, s91
    s_mov_b32 s14, 5242880
    s_mov_b32 s15, 0x20000
    v_lshlrev_b32 v10, 3, v4
    v_add_u32 v10, 157696, v10
    ds_read_b64 v[198:199], v10 offset:0
    ds_read_b64 v[200:201], v10 offset:32
    ds_read_b64 v[202:203], v10 offset:64
    ds_read_b64 v[204:205], v10 offset:96
    ds_read_b64 v[206:207], v10 offset:128
    s_and_b32 s60, s16, 7
    s_lshl_b32 s60, s60, 6
    s_add_u32 s60, s60, 155648
    v_add_u32 v10, s60, v9
    ds_read2st64_b32 v[208:209], v10 offset0:0 offset1:4
    s_add_u32 s44, s30, 153600
    s_sub_u32 s45, s44, s31
    s_min_u32 s44, s44, s45
    buffer_load_dwordx4 v[164:167], v247, s[8:11], s44 offen sc1
    s_add_u32 s44, s30, 161792
    s_sub_u32 s45, s44, s31
    s_min_u32 s44, s44, s45
    buffer_load_dwordx4 v[168:171], v247, s[8:11], s44 offen sc1
    s_add_u32 s44, s30, 169984
    s_sub_u32 s45, s44, s31
    s_min_u32 s44, s44, s45
    buffer_load_dwordx4 v[172:175], v247, s[8:11], s44 offen sc1
    s_add_u32 s44, s30, 178176
    s_sub_u32 s45, s44, s31
    s_min_u32 s44, s44, s45
    buffer_load_dwordx4 v[176:179], v247, s[8:11], s44 offen sc1
    s_add_u32 s44, s30, 186368
    s_sub_u32 s45, s44, s31
    s_min_u32 s44, s44, s45
    buffer_load_dwordx4 v[180:183], v247, s[8:11], s44 offen sc1
    s_add_u32 s44, s30, 194560
    s_sub_u32 s45, s44, s31
    s_min_u32 s44, s44, s45
    buffer_load_dwordx4 v[212:215], v247, s[8:11], s44 offen sc1
    s_add_u32 s44, s30, 202752
    s_sub_u32 s45, s44, s31
    s_min_u32 s44, s44, s45
    buffer_load_dwordx4 v[216:219], v247, s[8:11], s44 offen sc1
    s_add_u32 s44, s30, 210944
    s_sub_u32 s45, s44, s31
    s_min_u32 s44, s44, s45
    buffer_load_dwordx4 v[220:223], v247, s[8:11], s44 offen sc1
    s_add_u32 s44, s30, 219136
    s_sub_u32 s45, s44, s31
    s_min_u32 s44, s44, s45
    buffer_load_dwordx4 v[224:227], v247, s[8:11], s44 offen sc1
    s_add_u32 s44, s30, 227328
    s_sub_u32 s45, s44, s31
    s_min_u32 s44, s44, s45
    buffer_load_dwordx4 v[228:231], v247, s[8:11], s44 offen sc1
    s_cmp_lg_u32 s32, 1
    s_cbranch_scc1 Lcd_40
    s_mov_b32 s60, 0
    v_lshlrev_b32 v7, 7, v1
    s_mov_b64 exec, 0x3fffff
Lc_39:
    buffer_load_dword v2, v7, s[8:11], s23 offen sc1
    s_waitcnt vmcnt(0)
    v_cmp_ne_u32 vcc, 1, v2
    s_nop 1
    s_cmp_eq_u64 vcc, 0
    s_cbranch_scc1 Lcd_40
    s_mov_b64 exec, vcc
    s_sleep 2
    s_add_u32 s60, s60, 1
    s_cmp_lt_u32 s60, 100000
    s_cbranch_scc1 Lc_39
Lcd_40:
    s_mov_b64 exec, -1
    s_barrier
    s_add_u32 s46, s54, 0
    s_sub_u32 s47, s46, 55296
    s_min_u32 s46, s46, s47
    buffer_load_dwordx4 v[116:119], v248, s[8:11], s46 offen sc1
    buffer_load_dwordx4 v[120:123], v249, s[8:11], s46 offen sc1
    s_add_u32 s46, s54, 2048
    s_sub_u32 s47, s46, 55296
    s_min_u32 s46, s46, s47
    buffer_load_dwordx4 v[124:127], v248, s[8:11], s46 offen sc1
    buffer_load_dwordx4 v[128:131], v249, s[8:11], s46 offen sc1
    s_add_u32 s46, s54, 4096
    s_sub_u32 s47, s46, 55296
    s_min_u32 s46, s46, s47
    buffer_load_dwordx4 v[132:135], v248, s[8:11], s46 offen sc1
    buffer_load_dwordx4 v[136:139], v249, s[8:11], s46 offen sc1
    s_waitcnt vmcnt(4) lgkmcnt(0)
    v_mfma_f32_16x16x32_bf16 v[16:19], v[56:59], v[116:119], 0
    ds_read_b64_tr_b16 v[96:97], v245 offset:30720
    s_add_u32 s46, s54, 6144
    s_sub_u32 s47, s46, 55296
    s_min_u32 s46, s46, s47
    buffer_load_dwordx4 v[140:143], v248, s[8:11], s46 offen sc1
    buffer_load_dwordx4 v[144:147], v249, s[8:11], s46 offen sc1
    v_mfma_f32_16x16x32_bf16 v[20:23], v[56:59], v[120:123], 0
    ds_read_b64_tr_b16 v[98:99], v245 offset:31232
    v_mfma_f32_16x16x32_bf16 v[24:27], v[60:63], v[116:119], 0
    ds_read_b64_tr_b16 v[100:101], v245 offset:31744
    v_mfma_f32_16x16x32_bf16 v[28:31], v[60:63], v[120:123], 0
    ds_read_b64_tr_b16 v[102:103], v245 offset:32256
    v_mfma_f32_16x16x32_bf16 v[32:35], v[64:67], v[116:119], 0
    ds_read_b64_tr_b16 v[104:105], v245 offset:32768
    v_mfma_f32_16x16x32_bf16 v[36:39], v[64:67], v[120:123], 0
    ds_read_b64_tr_b16 v[106:107], v245 offset:33280
    v_mfma_f32_16x16x32_bf16 v[40:43], v[68:71], v[116:119], 0
    ds_read_b64_tr_b16 v[108:109], v245 offset:33792
    v_mfma_f32_16x16x32_bf16 v[44:47], v[68:71], v[120:123], 0
    ds_read_b64_tr_b16 v[110:111], v245 offset:34304
    v_mfma_f32_16x16x32_bf16 v[48:51], v[72:75], v[116:119], 0
    ds_read_b64_tr_b16 v[112:113], v245 offset:34816
    v_mfma_f32_16x16x32_bf16 v[52:55], v[72:75], v[120:123], 0
    ds_read_b64_tr_b16 v[114:115], v245 offset:35328
    s_add_u32 s46, s54, 8192
    s_sub_u32 s47, s46, 55296
    s_min_u32 s46, s46, s47
    buffer_load_dwordx4 v[148:151], v248, s[8:11], s46 offen sc1
    buffer_load_dwordx4 v[152:155], v249, s[8:11], s46 offen sc1
    s_waitcnt vmcnt(6) lgkmcnt(10)
    v_mfma_f32_16x16x32_bf16 v[16:19], v[76:79], v[124:127], v[16:19]
    ds_read_b64_tr_b16 v[56:57], v245 offset:40960
    s_add_u32 s46, s54, 10240
    s_sub_u32 s47, s46, 55296
    s_min_u32 s46, s46, s47
    buffer_load_dwordx4 v[156:159], v248, s[8:11], s46 offen sc1
    buffer_load_dwordx4 v[160:163], v249, s[8:11], s46 offen sc1
    v_mfma_f32_16x16x32_bf16 v[20:23], v[76:79], v[128:131], v[20:23]
    ds_read_b64_tr_b16 v[58:59], v245 offset:41472
    v_mfma_f32_16x16x32_bf16 v[24:27], v[80:83], v[124:127], v[24:27]
    ds_read_b64_tr_b16 v[60:61], v245 offset:41984
    v_mfma_f32_16x16x32_bf16 v[28:31], v[80:83], v[128:131], v[28:31]
    ds_read_b64_tr_b16 v[62:63], v245 offset:42496
    v_mfma_f32_16x16x32_bf16 v[32:35], v[84:87], v[124:127], v[32:35]
    ds_read_b64_tr_b16 v[64:65], v245 offset:43008
    v_mfma_f32_16x16x32_bf16 v[36:39], v[84:87], v[128:131], v[36:39]
    ds_read_b64_tr_b16 v[66:67], v245 offset:43520
    v_mfma_f32_16x16x32_bf16 v[40:43], v[88:91], v[124:127], v[40:43]
    ds_read_b64_tr_b16 v[68:69], v245 offset:44032
    v_mfma_f32_16x16x32_bf16 v[44:47], v[88:91], v[128:131], v[44:47]
    ds_read_b64_tr_b16 v[70:71], v245 offset:44544
    v_mfma_f32_16x16x32_bf16 v[48:51], v[92:95], v[124:127], v[48:51]
    ds_read_b64_tr_b16 v[72:73], v245 offset:45056
    v_mfma_f32_16x16x32_bf16 v[52:55], v[92:95], v[128:131], v[52:55]
    ds_read_b64_tr_b16 v[74:75], v245 offset:45568
    s_add_u32 s46, s54, 12288
    s_sub_u32 s47, s46, 55296
    s_min_u32 s46, s46, s47
    buffer_load_dwordx4 v[116:119], v248, s[8:11], s46 offen sc1
    buffer_load_dwordx4 v[120:123], v249, s[8:11], s46 offen sc1
    s_waitcnt vmcnt(8) lgkmcnt(10)
    v_mfma_f32_16x16x32_bf16 v[16:19], v[96:99], v[132:135], v[16:19]
    ds_read_b64_tr_b16 v[76:77], v246 offset:0
    s_add_u32 s46, s54, 14336
    s_sub_u32 s47, s46, 55296
    s_min_u32 s46, s46, s47
    buffer_load_dwordx4 v[124:127], v248, s[8:11], s46 offen sc1
    buffer_load_dwordx4 v[128:131], v249, s[8:11], s46 offen sc1
    v_mfma_f32_16x16x32_bf16 v[20:23], v[96:99], v[136:139], v[20:23]
    ds_read_b64_tr_b16 v[78:79], v246 offset:512
    v_mfma_f32_16x16x32_bf16 v[24:27], v[100:103], v[132:135], v[24:27]
    ds_read_b64_tr_b16 v[80:81], v246 offset:1024
    v_mfma_f32_16x16x32_bf16 v[28:31], v[100:103], v[136:139], v[28:31]
    ds_read_b64_tr_b16 v[82:83], v246 offset:1536
    v_mfma_f32_16x16x32_bf16 v[32:35], v[104:107], v[132:135], v[32:35]
    ds_read_b64_tr_b16 v[84:85], v246 offset:2048
    v_mfma_f32_16x16x32_bf16 v[36:39], v[104:107], v[136:139], v[36:39]
    ds_read_b64_tr_b16 v[86:87], v246 offset:2560
    v_mfma_f32_16x16x32_bf16 v[40:43], v[108:111], v[132:135], v[40:43]
    ds_read_b64_tr_b16 v[88:89], v246 offset:3072
    v_mfma_f32_16x16x32_bf16 v[44:47], v[108:111], v[136:139], v[44:47]
    ds_read_b64_tr_b16 v[90:91], v246 offset:3584
    v_mfma_f32_16x16x32_bf16 v[48:51], v[112:115], v[132:135], v[48:51]
    ds_read_b64_tr_b16 v[92:93], v246 offset:4096
    v_mfma_f32_16x16x32_bf16 v[52:55], v[112:115], v[136:139], v[52:55]
    ds_read_b64_tr_b16 v[94:95], v246 offset:4608
    s_add_u32 s46, s54, 16384
    s_sub_u32 s47, s46, 55296
    s_min_u32 s46, s46, s47
    buffer_load_dwordx4 v[132:135], v248, s[8:11], s46 offen sc1
    buffer_load_dwordx4 v[136:139], v249, s[8:11], s46 offen sc1
    s_waitcnt vmcnt(10) lgkmcnt(10)
    s_barrier
    v_mfma_f32_16x16x32_bf16 v[16:19], v[56:59], v[140:143], v[16:19]
    ds_read_b64_tr_b16 v[96:97], v246 offset:10240
    v_mfma_f32_16x16x32_bf16 v[20:23], v[56:59], v[144:147], v[20:23]
    ds_read_b64_tr_b16 v[98:99], v246 offset:10752
    v_mfma_f32_16x16x32_bf16 v[24:27], v[60:63], v[140:143], v[24:27]
    ds_read_b64_tr_b16 v[100:101], v246 offset:11264
    v_mfma_f32_16x16x32_bf16 v[28:31], v[60:63], v[144:147], v[28:31]
    ds_read_b64_tr_b16 v[102:103], v246 offset:11776
    v_mfma_f32_16x16x32_bf16 v[32:35], v[64:67], v[140:143], v[32:35]
    ds_read_b64_tr_b16 v[104:105], v246 offset:12288
    v_mfma_f32_16x16x32_bf16 v[36:39], v[64:67], v[144:147], v[36:39]
    ds_read_b64_tr_b16 v[106:107], v246 offset:12800
    s_add_u32 s44, s40, 61440
    v_add_u32 v14, s44, v5
    v_mfma_f32_16x16x32_bf16 v[40:43], v[68:71], v[140:143], v[40:43]
    ds_read_b64_tr_b16 v[108:109], v246 offset:13312
    ds_write_b128 v14, v[164:167] offset:0
    v_mfma_f32_16x16x32_bf16 v[44:47], v[68:71], v[144:147], v[44:47]
    ds_read_b64_tr_b16 v[110:111], v246 offset:13824
    v_mfma_f32_16x16x32_bf16 v[48:51], v[72:75], v[140:143], v[48:51]
    ds_read_b64_tr_b16 v[112:113], v246 offset:14336
    ds_write_b128 v14, v[168:171] offset:8192
    v_mfma_f32_16x16x32_bf16 v[52:55], v[72:75], v[144:147], v[52:55]
    ds_read_b64_tr_b16 v[114:115], v246 offset:14848
    s_add_u32 s46, s54, 18432
    s_sub_u32 s47, s46, 55296
    s_min_u32 s46, s46, s47
    buffer_load_dwordx4 v[140:143], v248, s[8:11], s46 offen sc1
    buffer_load_dwordx4 v[144:147], v249, s[8:11], s46 offen sc1
    s_waitcnt vmcnt(10) lgkmcnt(12)
    v_mfma_f32_16x16x32_bf16 v[16:19], v[76:79], v[148:151], v[16:19]
    ds_read_b64_tr_b16 v[56:57], v246 offset:20480
    v_mfma_f32_16x16x32_bf16 v[20:23], v[76:79], v[152:155], v[20:23]
    ds_read_b64_tr_b16 v[58:59], v246 offset:20992
    v_mfma_f32_16x16x32_bf16 v[24:27], v[80:83], v[148:151], v[24:27]
    ds_read_b64_tr_b16 v[60:61], v246 offset:21504
    v_mfma_f32_16x16x32_bf16 v[28:31], v[80:83], v[152:155], v[28:31]
    ds_read_b64_tr_b16 v[62:63], v246 offset:22016
    v_mfma_f32_16x16x32_bf16 v[32:35], v[84:87], v[148:151], v[32:35]
    ds_read_b64_tr_b16 v[64:65], v246 offset:22528
    v_mfma_f32_16x16x32_bf16 v[36:39], v[84:87], v[152:155], v[36:39]
    ds_read_b64_tr_b16 v[66:67], v246 offset:23040
    v_mfma_f32_16x16x32_bf16 v[40:43], v[88:91], v[148:151], v[40:43]
    ds_read_b64_tr_b16 v[68:69], v246 offset:23552
    ds_write_b128 v14, v[172:175] offset:16384
    v_mfma_f32_16x16x32_bf16 v[44:47], v[88:91], v[152:155], v[44:47]
    ds_read_b64_tr_b16 v[70:71], v246 offset:24064
    v_mfma_f32_16x16x32_bf16 v[48:51], v[92:95], v[148:151], v[48:51]
    ds_read_b64_tr_b16 v[72:73], v246 offset:24576
    v_mfma_f32_16x16x32_bf16 v[52:55], v[92:95], v[152:155], v[52:55]
    ds_read_b64_tr_b16 v[74:75], v246 offset:25088
    s_add_u32 s46, s54, 20480
    s_sub_u32 s47, s46, 55296
    s_min_u32 s46, s46, s47
    buffer_load_dwordx4 v[148:151], v248, s[8:11], s46 offen sc1
    buffer_load_dwordx4 v[152:155], v249, s[8:11], s46 offen sc1
    s_waitcnt vmcnt(10) lgkmcnt(11)
    v_mfma_f32_16x16x32_bf16 v[16:19], v[96:99], v[156:159], v[16:19]
    ds_read_b64_tr_b16 v[76:77], v246 offset:30720
    v_mfma_f32_16x16x32_bf16 v[20:23], v[96:99], v[160:163], v[20:23]
    ds_read_b64_tr_b16 v[78:79], v246 offset:31232
    v_mfma_f32_16x16x32_bf16 v[24:27], v[100:103], v[156:159], v[24:27]
    ds_read_b64_tr_b16 v[80:81], v246 offset:31744
    v_mfma_f32_16x16x32_bf16 v[28:31], v[100:103], v[160:163], v[28:31]
    ds_read_b64_tr_b16 v[82:83], v246 offset:32256
    v_mfma_f32_16x16x32_bf16 v[32:35], v[104:107], v[156:159], v[32:35]
    ds_read_b64_tr_b16 v[84:85], v246 offset:32768
    v_mfma_f32_16x16x32_bf16 v[36:39], v[104:107], v[160:163], v[36:39]
    ds_read_b64_tr_b16 v[86:87], v246 offset:33280
    v_mfma_f32_16x16x32_bf16 v[40:43], v[108:111], v[156:159], v[40:43]
    ds_read_b64_tr_b16 v[88:89], v246 offset:33792
    ds_write_b128 v14, v[176:179] offset:24576
    v_mfma_f32_16x16x32_bf16 v[44:47], v[108:111], v[160:163], v[44:47]
    ds_read_b64_tr_b16 v[90:91], v246 offset:34304
    v_mfma_f32_16x16x32_bf16 v[48:51], v[112:115], v[156:159], v[48:51]
    ds_read_b64_tr_b16 v[92:93], v246 offset:34816
    v_mfma_f32_16x16x32_bf16 v[52:55], v[112:115], v[160:163], v[52:55]
    ds_read_b64_tr_b16 v[94:95], v246 offset:35328
    s_add_u32 s46, s54, 22528
    s_sub_u32 s47, s46, 55296
    s_min_u32 s46, s46, s47
    buffer_load_dwordx4 v[156:159], v248, s[8:11], s46 offen sc1
    buffer_load_dwordx4 v[160:163], v249, s[8:11], s46 offen sc1
    s_waitcnt vmcnt(10) lgkmcnt(11)
    v_mfma_f32_16x16x32_bf16 v[16:19], v[56:59], v[116:119], v[16:19]
    ds_read_b64_tr_b16 v[96:97], v246 offset:40960
    v_mfma_f32_16x16x32_bf16 v[20:23], v[56:59], v[120:123], v[20:23]
    ds_read_b64_tr_b16 v[98:99], v246 offset:41472
    v_mfma_f32_16x16x32_bf16 v[24:27], v[60:63], v[116:119], v[24:27]
    ds_read_b64_tr_b16 v[100:101], v246 offset:41984
    v_mfma_f32_16x16x32_bf16 v[28:31], v[60:63], v[120:123], v[28:31]
    ds_read_b64_tr_b16 v[102:103], v246 offset:42496
    v_mfma_f32_16x16x32_bf16 v[32:35], v[64:67], v[116:119], v[32:35]
    ds_read_b64_tr_b16 v[104:105], v246 offset:43008
    v_mfma_f32_16x16x32_bf16 v[36:39], v[64:67], v[120:123], v[36:39]
    ds_read_b64_tr_b16 v[106:107], v246 offset:43520
    v_mfma_f32_16x16x32_bf16 v[40:43], v[68:71], v[116:119], v[40:43]
    ds_read_b64_tr_b16 v[108:109], v246 offset:44032
    ds_write_b128 v14, v[180:183] offset:32768
    v_mfma_f32_16x16x32_bf16 v[44:47], v[68:71], v[120:123], v[44:47]
    ds_read_b64_tr_b16 v[110:111], v246 offset:44544
    v_mfma_f32_16x16x32_bf16 v[48:51], v[72:75], v[116:119], v[48:51]
    ds_read_b64_tr_b16 v[112:113], v246 offset:45056
    v_mfma_f32_16x16x32_bf16 v[52:55], v[72:75], v[120:123], v[52:55]
    ds_read_b64_tr_b16 v[114:115], v246 offset:45568
    s_add_u32 s46, s54, 24576
    s_sub_u32 s47, s46, 55296
    s_min_u32 s46, s46, s47
    buffer_load_dwordx4 v[116:119], v248, s[8:11], s46 offen sc1
    buffer_load_dwordx4 v[120:123], v249, s[8:11], s46 offen sc1
    s_waitcnt vmcnt(10) lgkmcnt(11)
    s_barrier
    v_mfma_f32_16x16x32_bf16 v[16:19], v[76:79], v[124:127], v[16:19]
    ds_read_b64_tr_b16 v[56:57], v244 offset:0
    v_mfma_f32_16x16x32_bf16 v[20:23], v[76:79], v[128:131], v[20:23]
    ds_read_b64_tr_b16 v[58:59], v244 offset:512
    v_mfma_f32_16x16x32_bf16 v[24:27], v[80:83], v[124:127], v[24:27]
    ds_read_b64_tr_b16 v[60:61], v244 offset:1024
    v_mfma_f32_16x16x32_bf16 v[28:31], v[80:83], v[128:131], v[28:31]
    ds_read_b64_tr_b16 v[62:63], v244 offset:1536
    v_mfma_f32_16x16x32_bf16 v[32:35], v[84:87], v[124:127], v[32:35]
    ds_read_b64_tr_b16 v[64:65], v244 offset:2048
    v_mfma_f32_16x16x32_bf16 v[36:39], v[84:87], v[128:131], v[36:39]
    ds_read_b64_tr_b16 v[66:67], v244 offset:2560
    s_add_u32 s44, s40, 102400
    v_add_u32 v14, s44, v5
    v_mfma_f32_16x16x32_bf16 v[40:43], v[88:91], v[124:127], v[40:43]
    ds_read_b64_tr_b16 v[68:69], v244 offset:3072
    ds_write_b128 v14, v[212:215] offset:0
    v_mfma_f32_16x16x32_bf16 v[44:47], v[88:91], v[128:131], v[44:47]
    ds_read_b64_tr_b16 v[70:71], v244 offset:3584
    v_mfma_f32_16x16x32_bf16 v[48:51], v[92:95], v[124:127], v[48:51]
    ds_read_b64_tr_b16 v[72:73], v244 offset:4096
    ds_write_b128 v14, v[216:219] offset:8192
    v_mfma_f32_16x16x32_bf16 v[52:55], v[92:95], v[128:131], v[52:55]
    ds_read_b64_tr_b16 v[74:75], v244 offset:4608
    s_add_u32 s46, s54, 26624
    s_sub_u32 s47, s46, 55296
    s_min_u32 s46, s46, s47
    buffer_load_dwordx4 v[124:127], v248, s[8:11], s46 offen sc1
    buffer_load_dwordx4 v[128:131], v249, s[8:11], s46 offen sc1
    s_waitcnt vmcnt(10) lgkmcnt(12)
    v_mfma_f32_16x16x32_bf16 v[16:19], v[96:99], v[132:135], v[16:19]
    ds_read_b64_tr_b16 v[76:77], v244 offset:10240
    v_mfma_f32_16x16x32_bf16 v[20:23], v[96:99], v[136:139], v[20:23]
    ds_read_b64_tr_b16 v[78:79], v244 offset:10752
    v_mfma_f32_16x16x32_bf16 v[24:27], v[100:103], v[132:135], v[24:27]
    ds_read_b64_tr_b16 v[80:81], v244 offset:11264
    v_mfma_f32_16x16x32_bf16 v[28:31], v[100:103], v[136:139], v[28:31]
    ds_read_b64_tr_b16 v[82:83], v244 offset:11776
    v_mfma_f32_16x16x32_bf16 v[32:35], v[104:107], v[132:135], v[32:35]
    ds_read_b64_tr_b16 v[84:85], v244 offset:12288
    v_mfma_f32_16x16x32_bf16 v[36:39], v[104:107], v[136:139], v[36:39]
    ds_read_b64_tr_b16 v[86:87], v244 offset:12800
    v_mfma_f32_16x16x32_bf16 v[40:43], v[108:111], v[132:135], v[40:43]
    ds_read_b64_tr_b16 v[88:89], v244 offset:13312
    ds_write_b128 v14, v[220:223] offset:16384
    v_mfma_f32_16x16x32_bf16 v[44:47], v[108:111], v[136:139], v[44:47]
    ds_read_b64_tr_b16 v[90:91], v244 offset:13824
    v_mfma_f32_16x16x32_bf16 v[48:51], v[112:115], v[132:135], v[48:51]
    ds_read_b64_tr_b16 v[92:93], v244 offset:14336
    v_mfma_f32_16x16x32_bf16 v[52:55], v[112:115], v[136:139], v[52:55]
    ds_read_b64_tr_b16 v[94:95], v244 offset:14848
    s_add_u32 s46, s54, 28672
    s_sub_u32 s47, s46, 55296
    s_min_u32 s46, s46, s47
    buffer_load_dwordx4 v[132:135], v248, s[8:11], s46 offen sc1
    buffer_load_dwordx4 v[136:139], v249, s[8:11], s46 offen sc1
    s_waitcnt vmcnt(10) lgkmcnt(11)
    v_mfma_f32_16x16x32_bf16 v[16:19], v[56:59], v[140:143], v[16:19]
    ds_read_b64_tr_b16 v[96:97], v244 offset:20480
    v_mfma_f32_16x16x32_bf16 v[20:23], v[56:59], v[144:147], v[20:23]
    ds_read_b64_tr_b16 v[98:99], v244 offset:20992
    v_mfma_f32_16x16x32_bf16 v[24:27], v[60:63], v[140:143], v[24:27]
    ds_read_b64_tr_b16 v[100:101], v244 offset:21504
    v_mfma_f32_16x16x32_bf16 v[28:31], v[60:63], v[144:147], v[28:31]
    ds_read_b64_tr_b16 v[102:103], v244 offset:22016
    v_mfma_f32_16x16x32_bf16 v[32:35], v[64:67], v[140:143], v[32:35]
    ds_read_b64_tr_b16 v[104:105], v244 offset:22528
    v_mfma_f32_16x16x32_bf16 v[36:39], v[64:67], v[144:147], v[36:39]
    ds_read_b64_tr_b16 v[106:107], v244 offset:23040
    v_mfma_f32_16x16x32_bf16 v[40:43], v[68:71], v[140:143], v[40:43]
    ds_read_b64_tr_b16 v[108:109], v244 offset:23552
    ds_write_b128 v14, v[224:227] offset:24576
    v_mfma_f32_16x16x32_bf16 v[44:47], v[68:71], v[144:147], v[44:47]
    ds_read_b64_tr_b16 v[110:111], v244 offset:24064
    v_mfma_f32_16x16x32_bf16 v[48:51], v[72:75], v[140:143], v[48:51]
    ds_read_b64_tr_b16 v[112:113], v244 offset:24576
    v_mfma_f32_16x16x32_bf16 v[52:55], v[72:75], v[144:147], v[52:55]
    ds_read_b64_tr_b16 v[114:115], v244 offset:25088
    s_add_u32 s46, s54, 30720
    s_sub_u32 s47, s46, 55296
    s_min_u32 s46, s46, s47
    buffer_load_dwordx4 v[140:143], v248, s[8:11], s46 offen sc1
    buffer_load_dwordx4 v[144:147], v249, s[8:11], s46 offen sc1
    s_waitcnt vmcnt(10) lgkmcnt(11)
    v_mfma_f32_16x16x32_bf16 v[16:19], v[76:79], v[148:151], v[16:19]
    ds_read_b64_tr_b16 v[56:57], v244 offset:30720
    v_mfma_f32_16x16x32_bf16 v[20:23], v[76:79], v[152:155], v[20:23]
    ds_read_b64_tr_b16 v[58:59], v244 offset:31232
    v_mfma_f32_16x16x32_bf16 v[24:27], v[80:83], v[148:151], v[24:27]
    ds_read_b64_tr_b16 v[60:61], v244 offset:31744
    v_mfma_f32_16x16x32_bf16 v[28:31], v[80:83], v[152:155], v[28:31]
    ds_read_b64_tr_b16 v[62:63], v244 offset:32256
    v_mfma_f32_16x16x32_bf16 v[32:35], v[84:87], v[148:151], v[32:35]
    ds_read_b64_tr_b16 v[64:65], v244 offset:32768
    v_mfma_f32_16x16x32_bf16 v[36:39], v[84:87], v[152:155], v[36:39]
    ds_read_b64_tr_b16 v[66:67], v244 offset:33280
    v_mfma_f32_16x16x32_bf16 v[40:43], v[88:91], v[148:151], v[40:43]
    ds_read_b64_tr_b16 v[68:69], v244 offset:33792
    ds_write_b128 v14, v[228:231] offset:32768
    v_mfma_f32_16x16x32_bf16 v[44:47], v[88:91], v[152:155], v[44:47]
    ds_read_b64_tr_b16 v[70:71], v244 offset:34304
    v_mfma_f32_16x16x32_bf16 v[48:51], v[92:95], v[148:151], v[48:51]
    ds_read_b64_tr_b16 v[72:73], v244 offset:34816
    v_mfma_f32_16x16x32_bf16 v[52:55], v[92:95], v[152:155], v[52:55]
    ds_read_b64_tr_b16 v[74:75], v244 offset:35328
    s_add_u32 s46, s54, 32768
    s_sub_u32 s47, s46, 55296
    s_min_u32 s46, s46, s47
    buffer_load_dwordx4 v[148:151], v248, s[8:11], s46 offen sc1
    buffer_load_dwordx4 v[152:155], v249, s[8:11], s46 offen sc1
    s_waitcnt vmcnt(10) lgkmcnt(11)
    v_mfma_f32_16x16x32_bf16 v[16:19], v[96:99], v[156:159], v[16:19]
    ds_read_b64_tr_b16 v[76:77], v244 offset:40960
    v_mfma_f32_16x16x32_bf16 v[20:23], v[96:99], v[160:163], v[20:23]
    ds_read_b64_tr_b16 v[78:79], v244 offset:41472
    v_mfma_f32_16x16x32_bf16 v[24:27], v[100:103], v[156:159], v[24:27]
    ds_read_b64_tr_b16 v[80:81], v244 offset:41984
    v_mfma_f32_16x16x32_bf16 v[28:31], v[100:103], v[160:163], v[28:31]
    ds_read_b64_tr_b16 v[82:83], v244 offset:42496
    v_mfma_f32_16x16x32_bf16 v[32:35], v[104:107], v[156:159], v[32:35]
    ds_read_b64_tr_b16 v[84:85], v244 offset:43008
    v_mfma_f32_16x16x32_bf16 v[36:39], v[104:107], v[160:163], v[36:39]
    ds_read_b64_tr_b16 v[86:87], v244 offset:43520
    v_mfma_f32_16x16x32_bf16 v[40:43], v[108:111], v[156:159], v[40:43]
    ds_read_b64_tr_b16 v[88:89], v244 offset:44032
    v_mfma_f32_16x16x32_bf16 v[44:47], v[108:111], v[160:163], v[44:47]
    ds_read_b64_tr_b16 v[90:91], v244 offset:44544
    v_mfma_f32_16x16x32_bf16 v[48:51], v[112:115], v[156:159], v[48:51]
    ds_read_b64_tr_b16 v[92:93], v244 offset:45056
    v_mfma_f32_16x16x32_bf16 v[52:55], v[112:115], v[160:163], v[52:55]
    ds_read_b64_tr_b16 v[94:95], v244 offset:45568
    s_add_u32 s46, s54, 34816
    s_sub_u32 s47, s46, 55296
    s_min_u32 s46, s46, s47
    buffer_load_dwordx4 v[156:159], v248, s[8:11], s46 offen sc1
    buffer_load_dwordx4 v[160:163], v249, s[8:11], s46 offen sc1
    s_waitcnt vmcnt(10) lgkmcnt(10)
    s_barrier
    v_mfma_f32_16x16x32_bf16 v[16:19], v[56:59], v[116:119], v[16:19]
    ds_read_b64_tr_b16 v[96:97], v245 offset:0
    v_mfma_f32_16x16x32_bf16 v[20:23], v[56:59], v[120:123], v[20:23]
    ds_read_b64_tr_b16 v[98:99], v245 offset:512
    v_mfma_f32_16x16x32_bf16 v[24:27], v[60:63], v[116:119], v[24:27]
    ds_read_b64_tr_b16 v[100:101], v245 offset:1024
    v_mfma_f32_16x16x32_bf16 v[28:31], v[60:63], v[120:123], v[28:31]
    ds_read_b64_tr_b16 v[102:103], v245 offset:1536
    v_mfma_f32_16x16x32_bf16 v[32:35], v[64:67], v[116:119], v[32:35]
    ds_read_b64_tr_b16 v[104:105], v245 offset:2048
    v_mfma_f32_16x16x32_bf16 v[36:39], v[64:67], v[120:123], v[36:39]
    ds_read_b64_tr_b16 v[106:107], v245 offset:2560
    s_add_u32 s44, s30, 235520
    s_sub_u32 s45, s44, s31
    s_min_u32 s44, s44, s45
    s_add_u32 m0, s40, 0
    v_mfma_f32_16x16x32_bf16 v[40:43], v[68:71], v[116:119], v[40:43]
    ds_read_b64_tr_b16 v[108:109], v245 offset:3072
    buffer_load_dwordx4 v247, s[8:11], s44 offen sc1 lds
    v_mfma_f32_16x16x32_bf16 v[44:47], v[68:71], v[120:123], v[44:47]
    ds_read_b64_tr_b16 v[110:111], v245 offset:3584
    s_add_u32 s44, s30, 243712
    s_sub_u32 s45, s44, s31
    s_min_u32 s44, s44, s45
    s_add_u32 m0, s40, 8192
    v_mfma_f32_16x16x32_bf16 v[48:51], v[72:75], v[116:119], v[48:51]
    ds_read_b64_tr_b16 v[112:113], v245 offset:4096
    buffer_load_dwordx4 v247, s[8:11], s44 offen sc1 lds
    v_mfma_f32_16x16x32_bf16 v[52:55], v[72:75], v[120:123], v[52:55]
    ds_read_b64_tr_b16 v[114:115], v245 offset:4608
    s_add_u32 s46, s54, 36864
    s_sub_u32 s47, s46, 55296
    s_min_u32 s46, s46, s47
    buffer_load_dwordx4 v[116:119], v248, s[8:11], s46 offen sc1
    buffer_load_dwordx4 v[120:123], v249, s[8:11], s46 offen sc1
    s_waitcnt vmcnt(12) lgkmcnt(10)
    v_mfma_f32_16x16x32_bf16 v[16:19], v[76:79], v[124:127], v[16:19]
    ds_read_b64_tr_b16 v[56:57], v245 offset:10240
    v_mfma_f32_16x16x32_bf16 v[20:23], v[76:79], v[128:131], v[20:23]
    ds_read_b64_tr_b16 v[58:59], v245 offset:10752
    v_mfma_f32_16x16x32_bf16 v[24:27], v[80:83], v[124:127], v[24:27]
    ds_read_b64_tr_b16 v[60:61], v245 offset:11264
    v_mfma_f32_16x16x32_bf16 v[28:31], v[80:83], v[128:131], v[28:31]
    ds_read_b64_tr_b16 v[62:63], v245 offset:11776
    v_mfma_f32_16x16x32_bf16 v[32:35], v[84:87], v[124:127], v[32:35]
    ds_read_b64_tr_b16 v[64:65], v245 offset:12288
    v_mfma_f32_16x16x32_bf16 v[36:39], v[84:87], v[128:131], v[36:39]
    ds_read_b64_tr_b16 v[66:67], v245 offset:12800
    s_add_u32 s44, s30, 251904
    s_sub_u32 s45, s44, s31
    s_min_u32 s44, s44, s45
    s_add_u32 m0, s40, 16384
    v_mfma_f32_16x16x32_bf16 v[40:43], v[88:91], v[124:127], v[40:43]
    ds_read_b64_tr_b16 v[68:69], v245 offset:13312
    buffer_load_dwordx4 v247, s[8:11], s44 offen sc1 lds
    v_mfma_f32_16x16x32_bf16 v[44:47], v[88:91], v[128:131], v[44:47]
    ds_read_b64_tr_b16 v[70:71], v245 offset:13824
    v_mfma_f32_16x16x32_bf16 v[48:51], v[92:95], v[124:127], v[48:51]
    ds_read_b64_tr_b16 v[72:73], v245 offset:14336
    v_mfma_f32_16x16x32_bf16 v[52:55], v[92:95], v[128:131], v[52:55]
    ds_read_b64_tr_b16 v[74:75], v245 offset:14848
    s_add_u32 s46, s54, 38912
    s_sub_u32 s47, s46, 55296
    s_min_u32 s46, s46, s47
    buffer_load_dwordx4 v[124:127], v248, s[8:11], s46 offen sc1
    buffer_load_dwordx4 v[128:131], v249, s[8:11], s46 offen sc1
    s_waitcnt vmcnt(13) lgkmcnt(10)
    v_mfma_f32_16x16x32_bf16 v[16:19], v[96:99], v[132:135], v[16:19]
    ds_read_b64_tr_b16 v[76:77], v245 offset:20480
    v_mfma_f32_16x16x32_bf16 v[20:23], v[96:99], v[136:139], v[20:23]
    ds_read_b64_tr_b16 v[78:79], v245 offset:20992
    v_mfma_f32_16x16x32_bf16 v[24:27], v[100:103], v[132:135], v[24:27]
    ds_read_b64_tr_b16 v[80:81], v245 offset:21504
    v_mfma_f32_16x16x32_bf16 v[28:31], v[100:103], v[136:139], v[28:31]
    ds_read_b64_tr_b16 v[82:83], v245 offset:22016
    v_mfma_f32_16x16x32_bf16 v[32:35], v[104:107], v[132:135], v[32:35]
    ds_read_b64_tr_b16 v[84:85], v245 offset:22528
    v_mfma_f32_16x16x32_bf16 v[36:39], v[104:107], v[136:139], v[36:39]
    ds_read_b64_tr_b16 v[86:87], v245 offset:23040
    s_add_u32 s44, s30, 260096
    s_sub_u32 s45, s44, s31
    s_min_u32 s44, s44, s45
    s_add_u32 m0, s40, 24576
    v_mfma_f32_16x16x32_bf16 v[40:43], v[108:111], v[132:135], v[40:43]
    ds_read_b64_tr_b16 v[88:89], v245 offset:23552
    buffer_load_dwordx4 v247, s[8:11], s44 offen sc1 lds
    v_mfma_f32_16x16x32_bf16 v[44:47], v[108:111], v[136:139], v[44:47]
    ds_read_b64_tr_b16 v[90:91], v245 offset:24064
    v_mfma_f32_16x16x32_bf16 v[48:51], v[112:115], v[132:135], v[48:51]
    ds_read_b64_tr_b16 v[92:93], v245 offset:24576
    v_mfma_f32_16x16x32_bf16 v[52:55], v[112:115], v[136:139], v[52:55]
    ds_read_b64_tr_b16 v[94:95], v245 offset:25088
    s_add_u32 s46, s54, 40960
    s_sub_u32 s47, s46, 55296
    s_min_u32 s46, s46, s47
    buffer_load_dwordx4 v[132:135], v248, s[8:11], s46 offen sc1
    buffer_load_dwordx4 v[136:139], v249, s[8:11], s46 offen sc1
    s_waitcnt vmcnt(14) lgkmcnt(10)
    v_mfma_f32_16x16x32_bf16 v[16:19], v[56:59], v[140:143], v[16:19]
    ds_read_b64_tr_b16 v[96:97], v245 offset:30720
    v_mfma_f32_16x16x32_bf16 v[20:23], v[56:59], v[144:147], v[20:23]
    ds_read_b64_tr_b16 v[98:99], v245 offset:31232
    v_mfma_f32_16x16x32_bf16 v[24:27], v[60:63], v[140:143], v[24:27]
    ds_read_b64_tr_b16 v[100:101], v245 offset:31744
    v_mfma_f32_16x16x32_bf16 v[28:31], v[60:63], v[144:147], v[28:31]
    ds_read_b64_tr_b16 v[102:103], v245 offset:32256
    v_mfma_f32_16x16x32_bf16 v[32:35], v[64:67], v[140:143], v[32:35]
    ds_read_b64_tr_b16 v[104:105], v245 offset:32768
    v_mfma_f32_16x16x32_bf16 v[36:39], v[64:67], v[144:147], v[36:39]
    ds_read_b64_tr_b16 v[106:107], v245 offset:33280
    s_add_u32 s44, s30, 268288
    s_sub_u32 s45, s44, s31
    s_min_u32 s44, s44, s45
    s_add_u32 m0, s40, 32768
    v_mfma_f32_16x16x32_bf16 v[40:43], v[68:71], v[140:143], v[40:43]
    ds_read_b64_tr_b16 v[108:109], v245 offset:33792
    buffer_load_dwordx4 v247, s[8:11], s44 offen sc1 lds
    v_mfma_f32_16x16x32_bf16 v[44:47], v[68:71], v[144:147], v[44:47]
    ds_read_b64_tr_b16 v[110:111], v245 offset:34304
    v_mfma_f32_16x16x32_bf16 v[48:51], v[72:75], v[140:143], v[48:51]
    ds_read_b64_tr_b16 v[112:113], v245 offset:34816
    v_mfma_f32_16x16x32_bf16 v[52:55], v[72:75], v[144:147], v[52:55]
    ds_read_b64_tr_b16 v[114:115], v245 offset:35328
    s_add_u32 s46, s54, 43008
    s_sub_u32 s47, s46, 55296
    s_min_u32 s46, s46, s47
    buffer_load_dwordx4 v[140:143], v248, s[8:11], s46 offen sc1
    buffer_load_dwordx4 v[144:147], v249, s[8:11], s46 offen sc1
    s_waitcnt vmcnt(15) lgkmcnt(10)
    v_mfma_f32_16x16x32_bf16 v[16:19], v[76:79], v[148:151], v[16:19]
    ds_read_b64_tr_b16 v[56:57], v245 offset:40960
    v_mfma_f32_16x16x32_bf16 v[20:23], v[76:79], v[152:155], v[20:23]
    ds_read_b64_tr_b16 v[58:59], v245 offset:41472
    v_mfma_f32_16x16x32_bf16 v[24:27], v[80:83], v[148:151], v[24:27]
    ds_read_b64_tr_b16 v[60:61], v245 offset:41984
    v_mfma_f32_16x16x32_bf16 v[28:31], v[80:83], v[152:155], v[28:31]
    ds_read_b64_tr_b16 v[62:63], v245 offset:42496
    v_mfma_f32_16x16x32_bf16 v[32:35], v[84:87], v[148:151], v[32:35]
    ds_read_b64_tr_b16 v[64:65], v245 offset:43008
    v_mfma_f32_16x16x32_bf16 v[36:39], v[84:87], v[152:155], v[36:39]
    ds_read_b64_tr_b16 v[66:67], v245 offset:43520
    v_mfma_f32_16x16x32_bf16 v[40:43], v[88:91], v[148:151], v[40:43]
    ds_read_b64_tr_b16 v[68:69], v245 offset:44032
    v_mfma_f32_16x16x32_bf16 v[44:47], v[88:91], v[152:155], v[44:47]
    ds_read_b64_tr_b16 v[70:71], v245 offset:44544
    v_mfma_f32_16x16x32_bf16 v[48:51], v[92:95], v[148:151], v[48:51]
    ds_read_b64_tr_b16 v[72:73], v245 offset:45056
    v_mfma_f32_16x16x32_bf16 v[52:55], v[92:95], v[152:155], v[52:55]
    ds_read_b64_tr_b16 v[74:75], v245 offset:45568
    s_add_u32 s46, s54, 45056
    s_sub_u32 s47, s46, 55296
    s_min_u32 s46, s46, s47
    buffer_load_dwordx4 v[148:151], v248, s[8:11], s46 offen sc1
    buffer_load_dwordx4 v[152:155], v249, s[8:11], s46 offen sc1
    s_waitcnt vmcnt(15) lgkmcnt(10)
    v_mfma_f32_16x16x32_bf16 v[16:19], v[96:99], v[156:159], v[16:19]
    ds_read_b64_tr_b16 v[76:77], v246 offset:0
    v_permlane16_swap_b32 v232, v234
    v_permlane16_swap_b32 v233, v235
    v_mfma_f32_16x16x32_bf16 v[20:23], v[96:99], v[160:163], v[20:23]
    ds_read_b64_tr_b16 v[78:79], v246 offset:512
    v_permlane32_swap_b32 v232, v234
    v_permlane32_swap_b32 v233, v235
    v_mfma_f32_16x16x32_bf16 v[24:27], v[100:103], v[156:159], v[24:27]
    ds_read_b64_tr_b16 v[80:81], v246 offset:1024
    v_permlane16_swap_b32 v236, v238
    v_permlane16_swap_b32 v237, v239
    v_mfma_f32_16x16x32_bf16 v[28:31], v[100:103], v[160:163], v[28:31]
    ds_read_b64_tr_b16 v[82:83], v246 offset:1536
    v_permlane32_swap_b32 v236, v238
    v_permlane32_swap_b32 v237, v239
    v_mfma_f32_16x16x32_bf16 v[32:35], v[104:107], v[156:159], v[32:35]
    ds_read_b64_tr_b16 v[84:85], v246 offset:2048
    v_permlane16_swap_b32 v240, v242
    v_permlane16_swap_b32 v241, v243
    v_mfma_f32_16x16x32_bf16 v[36:39], v[104:107], v[160:163], v[36:39]
    ds_read_b64_tr_b16 v[86:87], v246 offset:2560
    v_permlane32_swap_b32 v240, v242
    v_permlane32_swap_b32 v241, v243
    v_mfma_f32_16x16x32_bf16 v[40:43], v[108:111], v[156:159], v[40:43]
    ds_read_b64_tr_b16 v[88:89], v246 offset:3072
    v_lshlrev_b32 v212, 16, v232
    v_and_b32 v213, 0xffff0000, v232
    v_mfma_f32_16x16x32_bf16 v[44:47], v[108:111], v[160:163], v[44:47]
    ds_read_b64_tr_b16 v[90:91], v246 offset:3584
    v_lshlrev_b32 v214, 16, v233
    v_and_b32 v215, 0xffff0000, v233
    v_mfma_f32_16x16x32_bf16 v[48:51], v[112:115], v[156:159], v[48:51]
    ds_read_b64_tr_b16 v[92:93], v246 offset:4096
    v_lshlrev_b32 v164, 16, v198
    v_and_b32 v165, 0xffff0000, v198
    v_mfma_f32_16x16x32_bf16 v[52:55], v[112:115], v[160:163], v[52:55]
    ds_read_b64_tr_b16 v[94:95], v246 offset:4608
    v_lshlrev_b32 v166, 16, v199
    v_and_b32 v167, 0xffff0000, v199
    s_add_u32 s46, s54, 47104
    s_sub_u32 s47, s46, 55296
    s_min_u32 s46, s46, s47
    buffer_load_dwordx4 v[156:159], v248, s[8:11], s46 offen sc1
    buffer_load_dwordx4 v[160:163], v249, s[8:11], s46 offen sc1
    s_waitcnt vmcnt(13) lgkmcnt(10)
    v_mfma_f32_16x16x32_bf16 v[16:19], v[56:59], v[116:119], v[16:19]
    ds_read_b64_tr_b16 v[96:97], v246 offset:10240
    v_sub_f32 v188, v212, v208
    v_sub_f32 v189, v213, v208
    v_mfma_f32_16x16x32_bf16 v[20:23], v[56:59], v[120:123], v[20:23]
    ds_read_b64_tr_b16 v[98:99], v246 offset:10752
    v_sub_f32 v190, v214, v208
    v_sub_f32 v191, v215, v208
    v_mfma_f32_16x16x32_bf16 v[24:27], v[60:63], v[116:119], v[24:27]
    ds_read_b64_tr_b16 v[100:101], v246 offset:11264
    v_mul_f32 v188, v188, v209
    v_mul_f32 v189, v189, v209
    v_mfma_f32_16x16x32_bf16 v[28:31], v[60:63], v[120:123], v[28:31]
    ds_read_b64_tr_b16 v[102:103], v246 offset:11776
    v_mul_f32 v190, v190, v209
    v_mul_f32 v191, v191, v209
    v_mfma_f32_16x16x32_bf16 v[32:35], v[64:67], v[116:119], v[32:35]
    ds_read_b64_tr_b16 v[104:105], v246 offset:12288
    v_mul_f32 v164, v164, v188
    v_mul_f32 v165, v165, v189
    v_mfma_f32_16x16x32_bf16 v[36:39], v[64:67], v[120:123], v[36:39]
    ds_read_b64_tr_b16 v[106:107], v246 offset:12800
    v_mul_f32 v166, v166, v190
    v_mul_f32 v167, v167, v191
    v_mfma_f32_16x16x32_bf16 v[40:43], v[68:71], v[116:119], v[40:43]
    ds_read_b64_tr_b16 v[108:109], v246 offset:13312
    v_lshlrev_b32 v216, 16, v234
    v_and_b32 v217, 0xffff0000, v234
    v_mfma_f32_16x16x32_bf16 v[44:47], v[68:71], v[120:123], v[44:47]
    ds_read_b64_tr_b16 v[110:111], v246 offset:13824
    v_lshlrev_b32 v218, 16, v235
    v_and_b32 v219, 0xffff0000, v235
    v_mfma_f32_16x16x32_bf16 v[48:51], v[72:75], v[116:119], v[48:51]
    ds_read_b64_tr_b16 v[112:113], v246 offset:14336
    v_lshlrev_b32 v168, 16, v200
    v_and_b32 v169, 0xffff0000, v200
    v_mfma_f32_16x16x32_bf16 v[52:55], v[72:75], v[120:123], v[52:55]
    ds_read_b64_tr_b16 v[114:115], v246 offset:14848
    v_lshlrev_b32 v170, 16, v201
    v_and_b32 v171, 0xffff0000, v201
    s_add_u32 s46, s54, 49152
    s_sub_u32 s47, s46, 55296
    s_min_u32 s46, s46, s47
    buffer_load_dwordx4 v[116:119], v248, s[8:11], s46 offen sc1
    buffer_load_dwordx4 v[120:123], v249, s[8:11], s46 offen sc1
    s_waitcnt vmcnt(12) lgkmcnt(10)
    v_mfma_f32_16x16x32_bf16 v[16:19], v[76:79], v[124:127], v[16:19]
    ds_read_b64_tr_b16 v[56:57], v246 offset:20480
    v_sub_f32 v188, v216, v208
    v_sub_f32 v189, v217, v208
    v_mfma_f32_16x16x32_bf16 v[20:23], v[76:79], v[128:131], v[20:23]
    ds_read_b64_tr_b16 v[58:59], v246 offset:20992
    v_sub_f32 v190, v218, v208
    v_sub_f32 v191, v219, v208
    v_mfma_f32_16x16x32_bf16 v[24:27], v[80:83], v[124:127], v[24:27]
    ds_read_b64_tr_b16 v[60:61], v246 offset:21504
    v_mul_f32 v188, v188, v209
    v_mul_f32 v189, v189, v209
    v_mfma_f32_16x16x32_bf16 v[28:31], v[80:83], v[128:131], v[28:31]
    ds_read_b64_tr_b16 v[62:63], v246 offset:22016
    v_mul_f32 v190, v190, v209
    v_mul_f32 v191, v191, v209
    v_mfma_f32_16x16x32_bf16 v[32:35], v[84:87], v[124:127], v[32:35]
    ds_read_b64_tr_b16 v[64:65], v246 offset:22528
    v_mul_f32 v168, v168, v188
    v_mul_f32 v169, v169, v189
    v_mfma_f32_16x16x32_bf16 v[36:39], v[84:87], v[128:131], v[36:39]
    ds_read_b64_tr_b16 v[66:67], v246 offset:23040
    v_mul_f32 v170, v170, v190
    v_mul_f32 v171, v171, v191
    v_mfma_f32_16x16x32_bf16 v[40:43], v[88:91], v[124:127], v[40:43]
    ds_read_b64_tr_b16 v[68:69], v246 offset:23552
    v_lshlrev_b32 v220, 16, v236
    v_and_b32 v221, 0xffff0000, v236
    v_mfma_f32_16x16x32_bf16 v[44:47], v[88:91], v[128:131], v[44:47]
    ds_read_b64_tr_b16 v[70:71], v246 offset:24064
    v_lshlrev_b32 v222, 16, v237
    v_and_b32 v223, 0xffff0000, v237
    v_mfma_f32_16x16x32_bf16 v[48:51], v[92:95], v[124:127], v[48:51]
    ds_read_b64_tr_b16 v[72:73], v246 offset:24576
    v_lshlrev_b32 v172, 16, v202
    v_and_b32 v173, 0xffff0000, v202
    v_mfma_f32_16x16x32_bf16 v[52:55], v[92:95], v[128:131], v[52:55]
    ds_read_b64_tr_b16 v[74:75], v246 offset:25088
    v_lshlrev_b32 v174, 16, v203
    v_and_b32 v175, 0xffff0000, v203
    s_add_u32 s46, s54, 51200
    s_sub_u32 s47, s46, 55296
    s_min_u32 s46, s46, s47
    buffer_load_dwordx4 v[124:127], v248, s[8:11], s46 offen sc1
    buffer_load_dwordx4 v[128:131], v249, s[8:11], s46 offen sc1
    s_waitcnt vmcnt(11) lgkmcnt(10)
    s_waitcnt vmcnt(10)
    s_barrier
    v_mfma_f32_16x16x32_bf16 v[16:19], v[96:99], v[132:135], v[16:19]
    ds_read_b64_tr_b16 v[76:77], v246 offset:30720
    v_sub_f32 v188, v220, v208
    v_sub_f32 v189, v221, v208
    v_mfma_f32_16x16x32_bf16 v[20:23], v[96:99], v[136:139], v[20:23]
    ds_read_b64_tr_b16 v[78:79], v246 offset:31232
    v_sub_f32 v190, v222, v208
    v_sub_f32 v191, v223, v208
    v_mfma_f32_16x16x32_bf16 v[24:27], v[100:103], v[132:135], v[24:27]
    ds_read_b64_tr_b16 v[80:81], v246 offset:31744
    v_mul_f32 v188, v188, v209
    v_mul_f32 v189, v189, v209
    v_mfma_f32_16x16x32_bf16 v[28:31], v[100:103], v[136:139], v[28:31]
    ds_read_b64_tr_b16 v[82:83], v246 offset:32256
    v_mul_f32 v190, v190, v209
    v_mul_f32 v191, v191, v209
    v_mfma_f32_16x16x32_bf16 v[32:35], v[104:107], v[132:135], v[32:35]
    ds_read_b64_tr_b16 v[84:85], v246 offset:32768
    v_mul_f32 v172, v172, v188
    v_mul_f32 v173, v173, v189
    v_mfma_f32_16x16x32_bf16 v[36:39], v[104:107], v[136:139], v[36:39]
    ds_read_b64_tr_b16 v[86:87], v246 offset:33280
    v_mul_f32 v174, v174, v190
    v_mul_f32 v175, v175, v191
    v_mfma_f32_16x16x32_bf16 v[40:43], v[108:111], v[132:135], v[40:43]
    ds_read_b64_tr_b16 v[88:89], v246 offset:33792
    v_lshlrev_b32 v224, 16, v238
    v_and_b32 v225, 0xffff0000, v238
    v_mfma_f32_16x16x32_bf16 v[44:47], v[108:111], v[136:139], v[44:47]
    ds_read_b64_tr_b16 v[90:91], v246 offset:34304
    v_lshlrev_b32 v226, 16, v239
    v_and_b32 v227, 0xffff0000, v239
    v_mfma_f32_16x16x32_bf16 v[48:51], v[112:115], v[132:135], v[48:51]
    ds_read_b64_tr_b16 v[92:93], v246 offset:34816
    v_lshlrev_b32 v176, 16, v204
    v_and_b32 v177, 0xffff0000, v204
    v_mfma_f32_16x16x32_bf16 v[52:55], v[112:115], v[136:139], v[52:55]
    ds_read_b64_tr_b16 v[94:95], v246 offset:35328
    v_lshlrev_b32 v178, 16, v205
    v_and_b32 v179, 0xffff0000, v205
    s_add_u32 s46, s54, 53248
    s_sub_u32 s47, s46, 55296
    s_min_u32 s46, s46, s47
    buffer_load_dwordx4 v[132:135], v248, s[8:11], s46 offen sc1
    buffer_load_dwordx4 v[136:139], v249, s[8:11], s46 offen sc1
    s_waitcnt vmcnt(10) lgkmcnt(10)
    v_mfma_f32_16x16x32_bf16 v[16:19], v[56:59], v[140:143], v[16:19]
    ds_read_b64_tr_b16 v[96:97], v244 offset:0
    v_sub_f32 v188, v224, v208
    v_sub_f32 v189, v225, v208
    v_mfma_f32_16x16x32_bf16 v[20:23], v[56:59], v[144:147], v[20:23]
    ds_read_b64_tr_b16 v[98:99], v244 offset:512
    v_sub_f32 v190, v226, v208
    v_sub_f32 v191, v227, v208
    v_mfma_f32_16x16x32_bf16 v[24:27], v[60:63], v[140:143], v[24:27]
    ds_read_b64_tr_b16 v[100:101], v244 offset:1024
    v_mul_f32 v188, v188, v209
    v_mul_f32 v189, v189, v209
    v_mfma_f32_16x16x32_bf16 v[28:31], v[60:63], v[144:147], v[28:31]
    ds_read_b64_tr_b16 v[102:103], v244 offset:1536
    v_mul_f32 v190, v190, v209
    v_mul_f32 v191, v191, v209
    v_mfma_f32_16x16x32_bf16 v[32:35], v[64:67], v[140:143], v[32:35]
    ds_read_b64_tr_b16 v[104:105], v244 offset:2048
    v_mul_f32 v176, v176, v188
    v_mul_f32 v177, v177, v189
    v_mfma_f32_16x16x32_bf16 v[36:39], v[64:67], v[144:147], v[36:39]
    ds_read_b64_tr_b16 v[106:107], v244 offset:2560
    v_mul_f32 v178, v178, v190
    v_mul_f32 v179, v179, v191
    v_mfma_f32_16x16x32_bf16 v[40:43], v[68:71], v[140:143], v[40:43]
    ds_read_b64_tr_b16 v[108:109], v244 offset:3072
    v_lshlrev_b32 v228, 16, v240
    v_and_b32 v229, 0xffff0000, v240
    v_mfma_f32_16x16x32_bf16 v[44:47], v[68:71], v[144:147], v[44:47]
    ds_read_b64_tr_b16 v[110:111], v244 offset:3584
    v_lshlrev_b32 v230, 16, v241
    v_and_b32 v231, 0xffff0000, v241
    v_mfma_f32_16x16x32_bf16 v[48:51], v[72:75], v[140:143], v[48:51]
    ds_read_b64_tr_b16 v[112:113], v244 offset:4096
    v_lshlrev_b32 v180, 16, v206
    v_and_b32 v181, 0xffff0000, v206
    v_mfma_f32_16x16x32_bf16 v[52:55], v[72:75], v[144:147], v[52:55]
    ds_read_b64_tr_b16 v[114:115], v244 offset:4608
    v_lshlrev_b32 v182, 16, v207
    v_and_b32 v183, 0xffff0000, v207
    s_waitcnt vmcnt(8) lgkmcnt(10)
    v_mfma_f32_16x16x32_bf16 v[16:19], v[76:79], v[148:151], v[16:19]
    ds_read_b64_tr_b16 v[56:57], v244 offset:10240
    v_sub_f32 v188, v228, v208
    v_sub_f32 v189, v229, v208
    v_mfma_f32_16x16x32_bf16 v[20:23], v[76:79], v[152:155], v[20:23]
    ds_read_b64_tr_b16 v[58:59], v244 offset:10752
    v_sub_f32 v190, v230, v208
    v_sub_f32 v191, v231, v208
    v_mfma_f32_16x16x32_bf16 v[24:27], v[80:83], v[148:151], v[24:27]
    ds_read_b64_tr_b16 v[60:61], v244 offset:11264
    v_mul_f32 v188, v188, v209
    v_mul_f32 v189, v189, v209
    v_mfma_f32_16x16x32_bf16 v[28:31], v[80:83], v[152:155], v[28:31]
    ds_read_b64_tr_b16 v[62:63], v244 offset:11776
    v_mul_f32 v190, v190, v209
    v_mul_f32 v191, v191, v209
    v_mfma_f32_16x16x32_bf16 v[32:35], v[84:87], v[148:151], v[32:35]
    ds_read_b64_tr_b16 v[64:65], v244 offset:12288
    v_mul_f32 v180, v180, v188
    v_mul_f32 v181, v181, v189
    v_mfma_f32_16x16x32_bf16 v[36:39], v[84:87], v[152:155], v[36:39]
    ds_read_b64_tr_b16 v[66:67], v244 offset:12800
    v_mul_f32 v182, v182, v190
    v_mul_f32 v183, v183, v191
    v_mfma_f32_16x16x32_bf16 v[40:43], v[88:91], v[148:151], v[40:43]
    ds_read_b64_tr_b16 v[68:69], v244 offset:13312
    v_mfma_f32_16x16x32_bf16 v[44:47], v[88:91], v[152:155], v[44:47]
    ds_read_b64_tr_b16 v[70:71], v244 offset:13824
    v_mfma_f32_16x16x32_bf16 v[48:51], v[92:95], v[148:151], v[48:51]
    ds_read_b64_tr_b16 v[72:73], v244 offset:14336
    v_mfma_f32_16x16x32_bf16 v[52:55], v[92:95], v[152:155], v[52:55]
    ds_read_b64_tr_b16 v[74:75], v244 offset:14848
    s_waitcnt vmcnt(6) lgkmcnt(10)
    v_mfma_f32_16x16x32_bf16 v[16:19], v[96:99], v[156:159], v[16:19]
    ds_read_b64_tr_b16 v[76:77], v244 offset:20480
    v_mfma_f32_16x16x32_bf16 v[20:23], v[96:99], v[160:163], v[20:23]
    ds_read_b64_tr_b16 v[78:79], v244 offset:20992
    v_mfma_f32_16x16x32_bf16 v[24:27], v[100:103], v[156:159], v[24:27]
    ds_read_b64_tr_b16 v[80:81], v244 offset:21504
    v_mfma_f32_16x16x32_bf16 v[28:31], v[100:103], v[160:163], v[28:31]
    ds_read_b64_tr_b16 v[82:83], v244 offset:22016
    v_mfma_f32_16x16x32_bf16 v[32:35], v[104:107], v[156:159], v[32:35]
    ds_read_b64_tr_b16 v[84:85], v244 offset:22528
    v_mfma_f32_16x16x32_bf16 v[36:39], v[104:107], v[160:163], v[36:39]
    ds_read_b64_tr_b16 v[86:87], v244 offset:23040
    v_mfma_f32_16x16x32_bf16 v[40:43], v[108:111], v[156:159], v[40:43]
    ds_read_b64_tr_b16 v[88:89], v244 offset:23552
    v_mfma_f32_16x16x32_bf16 v[44:47], v[108:111], v[160:163], v[44:47]
    ds_read_b64_tr_b16 v[90:91], v244 offset:24064
    v_mfma_f32_16x16x32_bf16 v[48:51], v[112:115], v[156:159], v[48:51]
    ds_read_b64_tr_b16 v[92:93], v244 offset:24576
    v_mfma_f32_16x16x32_bf16 v[52:55], v[112:115], v[160:163], v[52:55]
    ds_read_b64_tr_b16 v[94:95], v244 offset:25088
    s_waitcnt vmcnt(4) lgkmcnt(10)
    v_mfma_f32_16x16x32_bf16 v[16:19], v[56:59], v[116:119], v[16:19]
    ds_read_b64_tr_b16 v[96:97], v244 offset:30720
    v_mfma_f32_16x16x32_bf16 v[20:23], v[56:59], v[120:123], v[20:23]
    ds_read_b64_tr_b16 v[98:99], v244 offset:31232
    v_mfma_f32_16x16x32_bf16 v[24:27], v[60:63], v[116:119], v[24:27]
    ds_read_b64_tr_b16 v[100:101], v244 offset:31744
    v_mfma_f32_16x16x32_bf16 v[28:31], v[60:63], v[120:123], v[28:31]
    ds_read_b64_tr_b16 v[102:103], v244 offset:32256
    v_mfma_f32_16x16x32_bf16 v[32:35], v[64:67], v[116:119], v[32:35]
    ds_read_b64_tr_b16 v[104:105], v244 offset:32768
    v_mfma_f32_16x16x32_bf16 v[36:39], v[64:67], v[120:123], v[36:39]
    ds_read_b64_tr_b16 v[106:107], v244 offset:33280
    v_mfma_f32_16x16x32_bf16 v[40:43], v[68:71], v[116:119], v[40:43]
    ds_read_b64_tr_b16 v[108:109], v244 offset:33792
    v_mfma_f32_16x16x32_bf16 v[44:47], v[68:71], v[120:123], v[44:47]
    ds_read_b64_tr_b16 v[110:111], v244 offset:34304
    v_mfma_f32_16x16x32_bf16 v[48:51], v[72:75], v[116:119], v[48:51]
    ds_read_b64_tr_b16 v[112:113], v244 offset:34816
    v_mfma_f32_16x16x32_bf16 v[52:55], v[72:75], v[120:123], v[52:55]
    ds_read_b64_tr_b16 v[114:115], v244 offset:35328
    s_waitcnt vmcnt(2) lgkmcnt(10)
    v_mfma_f32_16x16x32_bf16 v[16:19], v[76:79], v[124:127], v[16:19]
    v_mfma_f32_16x16x32_bf16 v[20:23], v[76:79], v[128:131], v[20:23]
    v_mfma_f32_16x16x32_bf16 v[24:27], v[80:83], v[124:127], v[24:27]
    v_mfma_f32_16x16x32_bf16 v[28:31], v[80:83], v[128:131], v[28:31]
    v_mfma_f32_16x16x32_bf16 v[32:35], v[84:87], v[124:127], v[32:35]
    v_mfma_f32_16x16x32_bf16 v[36:39], v[84:87], v[128:131], v[36:39]
    v_mfma_f32_16x16x32_bf16 v[40:43], v[88:91], v[124:127], v[40:43]
    v_mfma_f32_16x16x32_bf16 v[44:47], v[88:91], v[128:131], v[44:47]
    s_add_u32 s22, s20, 4096
    s_bfe_u32 s56, s49, 0x80000
    s_bfe_u32 s57, s49, 0x80008
    s_bfe_u32 s58, s49, 0x80010
    s_bfe_u32 s59, s49, 0x80018
    v_mfma_f32_16x16x32_bf16 v[48:51], v[92:95], v[124:127], v[48:51]
    buffer_load_dword v2, off, s[8:11], s22 offset:1020 sc1
    v_mfma_f32_16x16x32_bf16 v[52:55], v[92:95], v[128:131], v[52:55]
    s_waitcnt vmcnt(1) lgkmcnt(0)
    v_mfma_f32_16x16x32_bf16 v[20:23], v[96:99], v[136:139], v[20:23]
    v_mfma_f32_16x16x32_bf16 v[28:31], v[100:103], v[136:139], v[28:31]
    v_mfma_f32_16x16x32_bf16 v[36:39], v[104:107], v[136:139], v[36:39]
    v_mfma_f32_16x16x32_bf16 v[44:47], v[108:111], v[136:139], v[44:47]
    v_mfma_f32_16x16x32_bf16 v[52:55], v[112:115], v[136:139], v[52:55]
    v_mfma_f32_16x16x32_bf16 v[16:19], v[96:99], v[132:135], v[16:19]
    v_mfma_f32_16x16x32_bf16 v[24:27], v[100:103], v[132:135], v[24:27]
    v_mfma_f32_16x16x32_bf16 v[32:35], v[104:107], v[132:135], v[32:35]
    v_mfma_f32_16x16x32_bf16 v[40:43], v[108:111], v[132:135], v[40:43]
    v_mfma_f32_16x16x32_bf16 v[48:51], v[112:115], v[132:135], v[48:51]
    ds_write_b128 v250, v[20:23] offset:0
    ds_write_b128 v250, v[28:31] offset:1024
    ds_write_b128 v250, v[36:39] offset:2048
    ds_write_b128 v250, v[44:47] offset:3072
    ds_write_b128 v250, v[52:55] offset:4096
    s_waitcnt lgkmcnt(0)
    s_barrier
    ds_read_b128 v[56:59], v251 offset:0
    ds_read_b128 v[60:63], v251 offset:1024
    ds_read_b128 v[64:67], v251 offset:2048
    ds_read_b128 v[68:71], v251 offset:3072
    ds_read_b128 v[72:75], v251 offset:4096
    s_waitcnt vmcnt(0)
    v_readfirstlane_b32 s61, v2
    s_nop 0
    s_and_b32 s61, s61, 0xff
    s_cmp_lg_u32 s61, s59
    s_cbranch_scc1 Lskip_41
    s_add_u32 s45, s20, 0
    buffer_load_dwordx4 v[184:187], v5, s[8:11], s45 offen offset:0 sc1
    s_add_u32 s45, s20, 0
    buffer_load_dwordx4 v[188:191], v5, s[8:11], s45 offen offset:1024 sc1
    s_add_u32 s45, s20, 0
    buffer_load_dwordx4 v[192:195], v5, s[8:11], s45 offen offset:2048 sc1
    s_add_u32 s45, s20, 0
    buffer_load_dwordx4 v[196:199], v5, s[8:11], s45 offen offset:3072 sc1
    s_add_u32 s45, s20, 4096
    buffer_load_dwordx4 v[200:203], v5, s[8:11], s45 offen offset:0 sc1
Lskip_41:
    s_waitcnt lgkmcnt(4)
    v_pk_add_f32 v[16:17], v[16:17], v[56:57]
    v_pk_add_f32 v[18:19], v[18:19], v[58:59]
    v_mul_f32 v76, 0xbfb8aa3b, v16
    v_mul_f32 v77, 0xbfb8aa3b, v17
    v_mul_f32 v78, 0xbfb8aa3b, v18
    v_mul_f32 v79, 0xbfb8aa3b, v19
    v_exp_f32 v76, v76
    v_exp_f32 v77, v77
    v_exp_f32 v78, v78
    v_exp_f32 v79, v79
    s_waitcnt lgkmcnt(3)
    v_pk_add_f32 v[24:25], v[24:25], v[60:61]
    v_pk_add_f32 v[26:27], v[26:27], v[62:63]
    v_mul_f32 v80, 0xbfb8aa3b, v24
    v_mul_f32 v81, 0xbfb8aa3b, v25
    v_mul_f32 v82, 0xbfb8aa3b, v26
    v_mul_f32 v83, 0xbfb8aa3b, v27
    v_exp_f32 v80, v80
    v_exp_f32 v81, v81
    v_exp_f32 v82, v82
    v_exp_f32 v83, v83
    s_waitcnt lgkmcnt(2)
    v_pk_add_f32 v[32:33], v[32:33], v[64:65]
    v_pk_add_f32 v[34:35], v[34:35], v[66:67]
    v_mul_f32 v84, 0xbfb8aa3b, v32
    v_mul_f32 v85, 0xbfb8aa3b, v33
    v_mul_f32 v86, 0xbfb8aa3b, v34
    v_mul_f32 v87, 0xbfb8aa3b, v35
    v_exp_f32 v84, v84
    v_exp_f32 v85, v85
    v_exp_f32 v86, v86
    v_exp_f32 v87, v87
    s_waitcnt lgkmcnt(1)
    v_pk_add_f32 v[40:41], v[40:41], v[68:69]
    v_pk_add_f32 v[42:43], v[42:43], v[70:71]
    v_mul_f32 v88, 0xbfb8aa3b, v40
    v_mul_f32 v89, 0xbfb8aa3b, v41
    v_mul_f32 v90, 0xbfb8aa3b, v42
    v_mul_f32 v91, 0xbfb8aa3b, v43
    v_exp_f32 v88, v88
    v_exp_f32 v89, v89
    v_exp_f32 v90, v90
    v_exp_f32 v91, v91
    s_waitcnt lgkmcnt(0)
    v_pk_add_f32 v[48:49], v[48:49], v[72:73]
    v_pk_add_f32 v[50:51], v[50:51], v[74:75]
    v_mul_f32 v92, 0xbfb8aa3b, v48
    v_mul_f32 v93, 0xbfb8aa3b, v49
    v_mul_f32 v94, 0xbfb8aa3b, v50
    v_mul_f32 v95, 0xbfb8aa3b, v51
    v_exp_f32 v92, v92
    v_exp_f32 v93, v93
    v_exp_f32 v94, v94
    v_exp_f32 v95, v95
    v_add_f32 v76, 1.0, v76
    v_add_f32 v77, 1.0, v77
    v_add_f32 v78, 1.0, v78
    v_add_f32 v79, 1.0, v79
    v_rcp_f32 v76, v76
    v_rcp_f32 v77, v77
    v_rcp_f32 v78, v78
    v_rcp_f32 v79, v79
    v_add_f32 v80, 1.0, v80
    v_add_f32 v81, 1.0, v81
    v_add_f32 v82, 1.0, v82
    v_add_f32 v83, 1.0, v83
    v_rcp_f32 v80, v80
    v_rcp_f32 v81, v81
    v_rcp_f32 v82, v82
    v_rcp_f32 v83, v83
    v_add_f32 v84, 1.0, v84
    v_add_f32 v85, 1.0, v85
    v_add_f32 v86, 1.0, v86
    v_add_f32 v87, 1.0, v87
    v_rcp_f32 v84, v84
    v_rcp_f32 v85, v85
    v_rcp_f32 v86, v86
    v_rcp_f32 v87, v87
    v_add_f32 v88, 1.0, v88
    v_add_f32 v89, 1.0, v89
    v_add_f32 v90, 1.0, v90
    v_add_f32 v91, 1.0, v91
    v_rcp_f32 v88, v88
    v_rcp_f32 v89, v89
    v_rcp_f32 v90, v90
    v_rcp_f32 v91, v91
    v_add_f32 v92, 1.0, v92
    v_add_f32 v93, 1.0, v93
    v_add_f32 v94, 1.0, v94
    v_add_f32 v95, 1.0, v95
    v_rcp_f32 v92, v92
    v_rcp_f32 v93, v93
    v_rcp_f32 v94, v94
    v_rcp_f32 v95, v95
    v_pk_mul_f32 v[16:17], v[16:17], v[76:77]
    v_pk_mul_f32 v[18:19], v[18:19], v[78:79]
    v_pk_mul_f32 v[24:25], v[24:25], v[80:81]
    v_pk_mul_f32 v[26:27], v[26:27], v[82:83]
    v_pk_mul_f32 v[32:33], v[32:33], v[84:85]
    v_pk_mul_f32 v[34:35], v[34:35], v[86:87]
    v_pk_mul_f32 v[40:41], v[40:41], v[88:89]
    v_pk_mul_f32 v[42:43], v[42:43], v[90:91]
    v_pk_mul_f32 v[48:49], v[48:49], v[92:93]
    v_pk_mul_f32 v[50:51], v[50:51], v[94:95]
    v_pk_fma_f32 v[212:213], v[16:17], v[164:165], v[212:213]
    v_pk_fma_f32 v[214:215], v[18:19], v[166:167], v[214:215]
    v_pk_fma_f32 v[216:217], v[24:25], v[168:169], v[216:217]
    v_pk_fma_f32 v[218:219], v[26:27], v[170:171], v[218:219]
    v_pk_fma_f32 v[220:221], v[32:33], v[172:173], v[220:221]
    v_pk_fma_f32 v[222:223], v[34:35], v[174:175], v[222:223]
    v_pk_fma_f32 v[224:225], v[40:41], v[176:177], v[224:225]
    v_pk_fma_f32 v[226:227], v[42:43], v[178:179], v[226:227]
    v_pk_fma_f32 v[228:229], v[48:49], v[180:181], v[228:229]
    v_pk_fma_f32 v[230:231], v[50:51], v[182:183], v[230:231]
    s_mov_b32 s60, 0
    s_cmp_eq_u32 s61, s59
    s_cbranch_scc1 Lchk_44
Lfl_42:
    buffer_load_dword v2, off, s[8:11], s22 offset:1020 sc1
    s_add_u32 s60, s60, 1
    s_waitcnt vmcnt(0)
    v_readfirstlane_b32 s61, v2
    s_cmp_ge_u32 s60, 100000
    s_cbranch_scc1 Lgot_43
    s_and_b32 s61, s61, 0xff
    s_cmp_lg_u32 s61, s59
    s_cbranch_scc1 Lfl_42
    s_add_u32 s45, s20, 0
    buffer_load_dwordx4 v[184:187], v5, s[8:11], s45 offen offset:0 sc1
    s_add_u32 s45, s20, 0
    buffer_load_dwordx4 v[188:191], v5, s[8:11], s45 offen offset:1024 sc1
    s_add_u32 s45, s20, 0
    buffer_load_dwordx4 v[192:195], v5, s[8:11], s45 offen offset:2048 sc1
    s_add_u32 s45, s20, 0
    buffer_load_dwordx4 v[196:199], v5, s[8:11], s45 offen offset:3072 sc1
    s_add_u32 s45, s20, 4096
    buffer_load_dwordx4 v[200:203], v5, s[8:11], s45 offen offset:0 sc1
Lchk_44:
    s_waitcnt vmcnt(0)
    v_xor_b32 v184, s56, v184
    v_xor_b32 v185, s57, v185
    v_xor_b32 v186, s58, v186
    v_xor_b32 v187, s59, v187
    v_xor_b32 v188, s56, v188
    v_xor_b32 v189, s57, v189
    v_xor_b32 v190, s58, v190
    v_xor_b32 v191, s59, v191
    v_xor_b32 v192, s56, v192
    v_xor_b32 v193, s57, v193
    v_xor_b32 v194, s58, v194
    v_xor_b32 v195, s59, v195
    v_xor_b32 v196, s56, v196
    v_xor_b32 v197, s57, v197
    v_xor_b32 v198, s58, v198
    v_xor_b32 v199, s59, v199
    v_xor_b32 v200, s56, v200
    v_xor_b32 v201, s57, v201
    v_xor_b32 v202, s58, v202
    v_xor_b32 v203, s59, v203
    v_or_b32 v2, v184, v185
    v_or_b32 v7, v186, v187
    v_or3_b32 v2, v2, v188, v189
    v_or3_b32 v7, v7, v190, v191
    v_or3_b32 v2, v2, v192, v193
    v_or3_b32 v7, v7, v194, v195
    v_or3_b32 v2, v2, v196, v197
    v_or3_b32 v7, v7, v198, v199
    v_or3_b32 v2, v2, v200, v201
    v_or3_b32 v7, v7, v202, v203
    v_or_b32 v2, v2, v7
    v_and_b32 v2, 0xff, v2
    v_cmp_ne_u32 vcc, 0, v2
    s_nop 1
    s_cmp_lg_u64 vcc, 0
    s_cbranch_scc1 Lfl_42
Lgot_43:
    v_pk_fma_f32 v[16:17], v[16:17], v[184:185], v[212:213]
    v_pk_fma_f32 v[18:19], v[18:19], v[186:187], v[214:215]
    buffer_store_dwordx4 v[16:19], v253, s[12:15], s24 offen offset:0 sc1
    v_pk_fma_f32 v[24:25], v[24:25], v[188:189], v[216:217]
    v_pk_fma_f32 v[26:27], v[26:27], v[190:191], v[218:219]
    buffer_store_dwordx4 v[24:27], v253, s[12:15], s24 offen offset:64 sc1
    v_pk_fma_f32 v[32:33], v[32:33], v[192:193], v[220:221]
    v_pk_fma_f32 v[34:35], v[34:35], v[194:195], v[222:223]
    buffer_store_dwordx4 v[32:35], v253, s[12:15], s24 offen offset:128 sc1
    v_pk_fma_f32 v[40:41], v[40:41], v[196:197], v[224:225]
    v_pk_fma_f32 v[42:43], v[42:43], v[198:199], v[226:227]
    buffer_store_dwordx4 v[40:43], v253, s[12:15], s24 offen offset:192 sc1
    v_pk_fma_f32 v[48:49], v[48:49], v[200:201], v[228:229]
    v_pk_fma_f32 v[50:51], v[50:51], v[202:203], v[230:231]
    buffer_store_dwordx4 v[48:51], v253, s[12:15], s24 offen offset:256 sc1
    s_branch L_end
L_p2y:
    s_nop 7
    s_nop 1
    ds_read_b128 v[56:59], v245 offset:10240
    ds_read_b128 v[60:63], v245 offset:12288
    ds_read_b128 v[64:67], v245 offset:14336
    ds_read_b128 v[68:71], v245 offset:16384
    ds_read_b128 v[72:75], v245 offset:18432
    ds_read_b128 v[76:79], v245 offset:20480
    ds_read_b128 v[80:83], v245 offset:22528
    ds_read_b128 v[84:87], v245 offset:24576
    ds_read_b128 v[88:91], v245 offset:26624
    ds_read_b128 v[92:95], v245 offset:28672
    s_and_b32 s60, s38, 3
    s_lshl_b32 s60, s60, 2
    s_and_b32 s61, s39, 3
    s_add_u32 s60, s60, s61
    s_lshl_b32 s60, s60, 3
    s_lshr_b32 s61, s39, 2
    s_add_u32 s60, s60, s61
    s_lshl_b32 s60, s60, 7
    s_add_u32 s60, s60, 229376
    buffer_load_dword v217, off, s[8:11], s60 sc1
    s_add_u32 s44, s30, 153600
    s_sub_u32 s45, s44, s31
    s_min_u32 s44, s44, s45
    buffer_load_dwordx4 v[164:167], v247, s[8:11], s44 offen sc1
    s_add_u32 s44, s30, 161792
    s_sub_u32 s45, s44, s31
    s_min_u32 s44, s44, s45
    buffer_load_dwordx4 v[168:171], v247, s[8:11], s44 offen sc1
    s_add_u32 s44, s30, 169984
    s_sub_u32 s45, s44, s31
    s_min_u32 s44, s44, s45
    buffer_load_dwordx4 v[172:175], v247, s[8:11], s44 offen sc1
    s_add_u32 s44, s30, 178176
    s_sub_u32 s45, s44, s31
    s_min_u32 s44, s44, s45
    buffer_load_dwordx4 v[176:179], v247, s[8:11], s44 offen sc1
    s_add_u32 s44, s30, 186368
    s_sub_u32 s45, s44, s31
    s_min_u32 s44, s44, s45
    buffer_load_dwordx4 v[180:183], v247, s[8:11], s44 offen sc1
    s_add_u32 s44, s30, 194560
    s_sub_u32 s45, s44, s31
    s_min_u32 s44, s44, s45
    buffer_load_dwordx4 v[184:187], v247, s[8:11], s44 offen sc1
    s_add_u32 s44, s30, 202752
    s_sub_u32 s45, s44, s31
    s_min_u32 s44, s44, s45
    buffer_load_dwordx4 v[188:191], v247, s[8:11], s44 offen sc1
    s_cmp_lg_u32 s32, 1
    s_cbranch_scc1 Lcd_46
    s_mov_b32 s60, 0
    v_lshlrev_b32 v7, 7, v1
    s_mov_b64 exec, 0x3ff
Lc_45:
    buffer_load_dword v2, v7, s[8:11], s23 offen sc1
    s_waitcnt vmcnt(0)
    v_cmp_ne_u32 vcc, 1, v2
    s_nop 1
    s_cmp_eq_u64 vcc, 0
    s_cbranch_scc1 Lcd_46
    s_mov_b64 exec, vcc
    s_sleep 2
    s_add_u32 s60, s60, 1
    s_cmp_lt_u32 s60, 100000
    s_cbranch_scc1 Lc_45
Lcd_46:
    s_mov_b64 exec, -1
    s_barrier
    s_add_u32 s46, s54, 0
    s_sub_u32 s47, s46, 40960
    s_min_u32 s46, s46, s47
    buffer_load_dwordx4 v[116:119], v248, s[8:11], s46 offen sc1
    buffer_load_dwordx4 v[120:123], v249, s[8:11], s46 offen sc1
    s_add_u32 s46, s54, 2048
    s_sub_u32 s47, s46, 40960
    s_min_u32 s46, s46, s47
    buffer_load_dwordx4 v[124:127], v248, s[8:11], s46 offen sc1
    buffer_load_dwordx4 v[128:131], v249, s[8:11], s46 offen sc1
    s_add_u32 s46, s54, 4096
    s_sub_u32 s47, s46, 40960
    s_min_u32 s46, s46, s47
    buffer_load_dwordx4 v[132:135], v248, s[8:11], s46 offen sc1
    buffer_load_dwordx4 v[136:139], v249, s[8:11], s46 offen sc1
    s_waitcnt vmcnt(4) lgkmcnt(0)
    v_mfma_f32_16x16x32_bf16 v[16:19], v[56:59], v[116:119], 0
    ds_read_b128 v[96:99], v245 offset:30720
    s_add_u32 s46, s54, 6144
    s_sub_u32 s47, s46, 40960
    s_min_u32 s46, s46, s47
    buffer_load_dwordx4 v[140:143], v248, s[8:11], s46 offen sc1
    buffer_load_dwordx4 v[144:147], v249, s[8:11], s46 offen sc1
    v_mfma_f32_16x16x32_bf16 v[20:23], v[56:59], v[120:123], 0
    ds_read_b128 v[100:103], v245 offset:32768
    v_mfma_f32_16x16x32_bf16 v[24:27], v[60:63], v[116:119], 0
    ds_read_b128 v[104:107], v245 offset:34816
    v_mfma_f32_16x16x32_bf16 v[28:31], v[60:63], v[120:123], 0
    ds_read_b128 v[108:111], v245 offset:36864
    v_mfma_f32_16x16x32_bf16 v[32:35], v[64:67], v[116:119], 0
    ds_read_b128 v[112:115], v245 offset:38912
    v_mfma_f32_16x16x32_bf16 v[36:39], v[64:67], v[120:123], 0
    v_mfma_f32_16x16x32_bf16 v[40:43], v[68:71], v[116:119], 0
    v_mfma_f32_16x16x32_bf16 v[44:47], v[68:71], v[120:123], 0
    v_mfma_f32_16x16x32_bf16 v[48:51], v[72:75], v[116:119], 0
    v_mfma_f32_16x16x32_bf16 v[52:55], v[72:75], v[120:123], 0
    s_add_u32 s46, s54, 8192
    s_sub_u32 s47, s46, 40960
    s_min_u32 s46, s46, s47
    buffer_load_dwordx4 v[148:151], v248, s[8:11], s46 offen sc1
    buffer_load_dwordx4 v[152:155], v249, s[8:11], s46 offen sc1
    s_waitcnt vmcnt(6) lgkmcnt(5)
    v_mfma_f32_16x16x32_bf16 v[16:19], v[76:79], v[124:127], v[16:19]
    ds_read_b128 v[56:59], v245 offset:40960
    s_add_u32 s46, s54, 10240
    s_sub_u32 s47, s46, 40960
    s_min_u32 s46, s46, s47
    buffer_load_dwordx4 v[156:159], v248, s[8:11], s46 offen sc1
    buffer_load_dwordx4 v[160:163], v249, s[8:11], s46 offen sc1
    v_mfma_f32_16x16x32_bf16 v[20:23], v[76:79], v[128:131], v[20:23]
    ds_read_b128 v[60:63], v245 offset:43008
    v_mfma_f32_16x16x32_bf16 v[24:27], v[80:83], v[124:127], v[24:27]
    ds_read_b128 v[64:67], v245 offset:45056
    v_mfma_f32_16x16x32_bf16 v[28:31], v[80:83], v[128:131], v[28:31]
    ds_read_b128 v[68:71], v245 offset:47104
    v_mfma_f32_16x16x32_bf16 v[32:35], v[84:87], v[124:127], v[32:35]
    ds_read_b128 v[72:75], v245 offset:49152
    v_mfma_f32_16x16x32_bf16 v[36:39], v[84:87], v[128:131], v[36:39]
    v_mfma_f32_16x16x32_bf16 v[40:43], v[88:91], v[124:127], v[40:43]
    v_mfma_f32_16x16x32_bf16 v[44:47], v[88:91], v[128:131], v[44:47]
    v_mfma_f32_16x16x32_bf16 v[48:51], v[92:95], v[124:127], v[48:51]
    v_mfma_f32_16x16x32_bf16 v[52:55], v[92:95], v[128:131], v[52:55]
    s_add_u32 s46, s54, 12288
    s_sub_u32 s47, s46, 40960
    s_min_u32 s46, s46, s47
    buffer_load_dwordx4 v[116:119], v248, s[8:11], s46 offen sc1
    buffer_load_dwordx4 v[120:123], v249, s[8:11], s46 offen sc1
    s_waitcnt vmcnt(8) lgkmcnt(5)
    v_mfma_f32_16x16x32_bf16 v[16:19], v[96:99], v[132:135], v[16:19]
    ds_read_b128 v[76:79], v246 offset:0
    s_add_u32 s46, s54, 14336
    s_sub_u32 s47, s46, 40960
    s_min_u32 s46, s46, s47
    buffer_load_dwordx4 v[124:127], v248, s[8:11], s46 offen sc1
    buffer_load_dwordx4 v[128:131], v249, s[8:11], s46 offen sc1
    v_mfma_f32_16x16x32_bf16 v[20:23], v[96:99], v[136:139], v[20:23]
    ds_read_b128 v[80:83], v246 offset:2048
    v_mfma_f32_16x16x32_bf16 v[24:27], v[100:103], v[132:135], v[24:27]
    ds_read_b128 v[84:87], v246 offset:4096
    v_mfma_f32_16x16x32_bf16 v[28:31], v[100:103], v[136:139], v[28:31]
    ds_read_b128 v[88:91], v246 offset:6144
    v_mfma_f32_16x16x32_bf16 v[32:35], v[104:107], v[132:135], v[32:35]
    ds_read_b128 v[92:95], v246 offset:8192
    v_mfma_f32_16x16x32_bf16 v[36:39], v[104:107], v[136:139], v[36:39]
    v_mfma_f32_16x16x32_bf16 v[40:43], v[108:111], v[132:135], v[40:43]
    v_mfma_f32_16x16x32_bf16 v[44:47], v[108:111], v[136:139], v[44:47]
    v_mfma_f32_16x16x32_bf16 v[48:51], v[112:115], v[132:135], v[48:51]
    v_mfma_f32_16x16x32_bf16 v[52:55], v[112:115], v[136:139], v[52:55]
    s_add_u32 s46, s54, 16384
    s_sub_u32 s47, s46, 40960
    s_min_u32 s46, s46, s47
    buffer_load_dwordx4 v[132:135], v248, s[8:11], s46 offen sc1
    buffer_load_dwordx4 v[136:139], v249, s[8:11], s46 offen sc1
    s_waitcnt vmcnt(10) lgkmcnt(5)
    v_mfma_f32_16x16x32_bf16 v[16:19], v[56:59], v[140:143], v[16:19]
    ds_read_b128 v[96:99], v246 offset:10240
    v_mfma_f32_16x16x32_bf16 v[20:23], v[56:59], v[144:147], v[20:23]
    ds_read_b128 v[100:103], v246 offset:12288
    v_mfma_f32_16x16x32_bf16 v[24:27], v[60:63], v[140:143], v[24:27]
    ds_read_b128 v[104:107], v246 offset:14336
    v_mfma_f32_16x16x32_bf16 v[28:31], v[60:63], v[144:147], v[28:31]
    ds_read_b128 v[108:111], v246 offset:16384
    v_mfma_f32_16x16x32_bf16 v[32:35], v[64:67], v[140:143], v[32:35]
    ds_read_b128 v[112:115], v246 offset:18432
    v_mfma_f32_16x16x32_bf16 v[36:39], v[64:67], v[144:147], v[36:39]
    v_mfma_f32_16x16x32_bf16 v[40:43], v[68:71], v[140:143], v[40:43]
    v_mfma_f32_16x16x32_bf16 v[44:47], v[68:71], v[144:147], v[44:47]
    v_mfma_f32_16x16x32_bf16 v[48:51], v[72:75], v[140:143], v[48:51]
    v_mfma_f32_16x16x32_bf16 v[52:55], v[72:75], v[144:147], v[52:55]
    s_add_u32 s46, s54, 18432
    s_sub_u32 s47, s46, 40960
    s_min_u32 s46, s46, s47
    buffer_load_dwordx4 v[140:143], v248, s[8:11], s46 offen sc1
    buffer_load_dwordx4 v[144:147], v249, s[8:11], s46 offen sc1
    s_waitcnt vmcnt(10) lgkmcnt(5)
    s_barrier
    v_mfma_f32_16x16x32_bf16 v[16:19], v[76:79], v[148:151], v[16:19]
    ds_read_b128 v[56:59], v246 offset:20480
    v_mfma_f32_16x16x32_bf16 v[20:23], v[76:79], v[152:155], v[20:23]
    ds_read_b128 v[60:63], v246 offset:22528
    v_mfma_f32_16x16x32_bf16 v[24:27], v[80:83], v[148:151], v[24:27]
    ds_read_b128 v[64:67], v246 offset:24576
    v_mfma_f32_16x16x32_bf16 v[28:31], v[80:83], v[152:155], v[28:31]
    ds_read_b128 v[68:71], v246 offset:26624
    v_mfma_f32_16x16x32_bf16 v[32:35], v[84:87], v[148:151], v[32:35]
    ds_read_b128 v[72:75], v246 offset:28672
    v_mfma_f32_16x16x32_bf16 v[36:39], v[84:87], v[152:155], v[36:39]
    s_add_u32 s44, s40, 61440
    v_add_u32 v14, s44, v5
    v_mfma_f32_16x16x32_bf16 v[40:43], v[88:91], v[148:151], v[40:43]
    ds_write_b128 v14, v[164:167] offset:0
    v_mfma_f32_16x16x32_bf16 v[44:47], v[88:91], v[152:155], v[44:47]
    v_mfma_f32_16x16x32_bf16 v[48:51], v[92:95], v[148:151], v[48:51]
    ds_write_b128 v14, v[168:171] offset:8192
    v_mfma_f32_16x16x32_bf16 v[52:55], v[92:95], v[152:155], v[52:55]
    s_add_u32 s46, s54, 20480
    s_sub_u32 s47, s46, 40960
    s_min_u32 s46, s46, s47
    buffer_load_dwordx4 v[148:151], v248, s[8:11], s46 offen sc1
    buffer_load_dwordx4 v[152:155], v249, s[8:11], s46 offen sc1
    s_waitcnt vmcnt(10) lgkmcnt(7)
    v_mfma_f32_16x16x32_bf16 v[16:19], v[96:99], v[156:159], v[16:19]
    ds_read_b128 v[76:79], v246 offset:30720
    v_mfma_f32_16x16x32_bf16 v[20:23], v[96:99], v[160:163], v[20:23]
    ds_read_b128 v[80:83], v246 offset:32768
    v_mfma_f32_16x16x32_bf16 v[24:27], v[100:103], v[156:159], v[24:27]
    ds_read_b128 v[84:87], v246 offset:34816
    v_mfma_f32_16x16x32_bf16 v[28:31], v[100:103], v[160:163], v[28:31]
    ds_read_b128 v[88:91], v246 offset:36864
    v_mfma_f32_16x16x32_bf16 v[32:35], v[104:107], v[156:159], v[32:35]
    ds_read_b128 v[92:95], v246 offset:38912
    v_mfma_f32_16x16x32_bf16 v[36:39], v[104:107], v[160:163], v[36:39]
    v_mfma_f32_16x16x32_bf16 v[40:43], v[108:111], v[156:159], v[40:43]
    ds_write_b128 v14, v[172:175] offset:16384
    v_mfma_f32_16x16x32_bf16 v[44:47], v[108:111], v[160:163], v[44:47]
    v_mfma_f32_16x16x32_bf16 v[48:51], v[112:115], v[156:159], v[48:51]
    ds_write_b128 v14, v[176:179] offset:24576
    v_mfma_f32_16x16x32_bf16 v[52:55], v[112:115], v[160:163], v[52:55]
    s_add_u32 s46, s54, 22528
    s_sub_u32 s47, s46, 40960
    s_min_u32 s46, s46, s47
    buffer_load_dwordx4 v[156:159], v248, s[8:11], s46 offen sc1
    buffer_load_dwordx4 v[160:163], v249, s[8:11], s46 offen sc1
    s_waitcnt vmcnt(10) lgkmcnt(7)
    v_mfma_f32_16x16x32_bf16 v[16:19], v[56:59], v[116:119], v[16:19]
    ds_read_b128 v[96:99], v246 offset:40960
    v_mfma_f32_16x16x32_bf16 v[20:23], v[56:59], v[120:123], v[20:23]
    ds_read_b128 v[100:103], v246 offset:43008
    v_mfma_f32_16x16x32_bf16 v[24:27], v[60:63], v[116:119], v[24:27]
    ds_read_b128 v[104:107], v246 offset:45056
    v_mfma_f32_16x16x32_bf16 v[28:31], v[60:63], v[120:123], v[28:31]
    ds_read_b128 v[108:111], v246 offset:47104
    v_mfma_f32_16x16x32_bf16 v[32:35], v[64:67], v[116:119], v[32:35]
    ds_read_b128 v[112:115], v246 offset:49152
    v_mfma_f32_16x16x32_bf16 v[36:39], v[64:67], v[120:123], v[36:39]
    v_mfma_f32_16x16x32_bf16 v[40:43], v[68:71], v[116:119], v[40:43]
    ds_write_b128 v14, v[180:183] offset:32768
    v_mfma_f32_16x16x32_bf16 v[44:47], v[68:71], v[120:123], v[44:47]
    v_mfma_f32_16x16x32_bf16 v[48:51], v[72:75], v[116:119], v[48:51]
    ds_write_b128 v14, v[184:187] offset:40960
    v_mfma_f32_16x16x32_bf16 v[52:55], v[72:75], v[120:123], v[52:55]
    s_add_u32 s46, s54, 24576
    s_sub_u32 s47, s46, 40960
    s_min_u32 s46, s46, s47
    buffer_load_dwordx4 v[116:119], v248, s[8:11], s46 offen sc1
    buffer_load_dwordx4 v[120:123], v249, s[8:11], s46 offen sc1
    s_waitcnt vmcnt(10) lgkmcnt(7)
    v_mfma_f32_16x16x32_bf16 v[16:19], v[76:79], v[124:127], v[16:19]
    ds_read_b128 v[56:59], v244 offset:0
    v_mfma_f32_16x16x32_bf16 v[20:23], v[76:79], v[128:131], v[20:23]
    ds_read_b128 v[60:63], v244 offset:2048
    v_mfma_f32_16x16x32_bf16 v[24:27], v[80:83], v[124:127], v[24:27]
    ds_read_b128 v[64:67], v244 offset:4096
    v_mfma_f32_16x16x32_bf16 v[28:31], v[80:83], v[128:131], v[28:31]
    ds_read_b128 v[68:71], v244 offset:6144
    v_mfma_f32_16x16x32_bf16 v[32:35], v[84:87], v[124:127], v[32:35]
    ds_read_b128 v[72:75], v244 offset:8192
    v_mfma_f32_16x16x32_bf16 v[36:39], v[84:87], v[128:131], v[36:39]
    v_mfma_f32_16x16x32_bf16 v[40:43], v[88:91], v[124:127], v[40:43]
    s_cmp_ge_u32 s32, 2
    s_cbranch_scc1 Lskip_47
    ds_write_b128 v14, v[188:191] offset:49152
Lskip_47:
    v_mfma_f32_16x16x32_bf16 v[44:47], v[88:91], v[128:131], v[44:47]
    v_mfma_f32_16x16x32_bf16 v[48:51], v[92:95], v[124:127], v[48:51]
    v_mfma_f32_16x16x32_bf16 v[52:55], v[92:95], v[128:131], v[52:55]
    s_add_u32 s46, s54, 26624
    s_sub_u32 s47, s46, 40960
    s_min_u32 s46, s46, s47
    buffer_load_dwordx4 v[124:127], v248, s[8:11], s46 offen sc1
    buffer_load_dwordx4 v[128:131], v249, s[8:11], s46 offen sc1
    s_waitcnt vmcnt(10) lgkmcnt(5)
    v_mfma_f32_16x16x32_bf16 v[16:19], v[96:99], v[132:135], v[16:19]
    ds_read_b128 v[76:79], v244 offset:10240
    v_mfma_f32_16x16x32_bf16 v[20:23], v[96:99], v[136:139], v[20:23]
    ds_read_b128 v[80:83], v244 offset:12288
    v_mfma_f32_16x16x32_bf16 v[24:27], v[100:103], v[132:135], v[24:27]
    ds_read_b128 v[84:87], v244 offset:14336
    v_mfma_f32_16x16x32_bf16 v[28:31], v[100:103], v[136:139], v[28:31]
    ds_read_b128 v[88:91], v244 offset:16384
    v_mfma_f32_16x16x32_bf16 v[32:35], v[104:107], v[132:135], v[32:35]
    ds_read_b128 v[92:95], v244 offset:18432
    v_mfma_f32_16x16x32_bf16 v[36:39], v[104:107], v[136:139], v[36:39]
    v_mfma_f32_16x16x32_bf16 v[40:43], v[108:111], v[132:135], v[40:43]
    v_mfma_f32_16x16x32_bf16 v[44:47], v[108:111], v[136:139], v[44:47]
    v_mfma_f32_16x16x32_bf16 v[48:51], v[112:115], v[132:135], v[48:51]
    v_mfma_f32_16x16x32_bf16 v[52:55], v[112:115], v[136:139], v[52:55]
    s_add_u32 s46, s54, 28672
    s_sub_u32 s47, s46, 40960
    s_min_u32 s46, s46, s47
    buffer_load_dwordx4 v[132:135], v248, s[8:11], s46 offen sc1
    buffer_load_dwordx4 v[136:139], v249, s[8:11], s46 offen sc1
    s_waitcnt vmcnt(10) lgkmcnt(5)
    v_mfma_f32_16x16x32_bf16 v[16:19], v[56:59], v[140:143], v[16:19]
    ds_read_b128 v[96:99], v244 offset:20480
    v_mfma_f32_16x16x32_bf16 v[20:23], v[56:59], v[144:147], v[20:23]
    ds_read_b128 v[100:103], v244 offset:22528
    v_mfma_f32_16x16x32_bf16 v[24:27], v[60:63], v[140:143], v[24:27]
    ds_read_b128 v[104:107], v244 offset:24576
    v_mfma_f32_16x16x32_bf16 v[28:31], v[60:63], v[144:147], v[28:31]
    ds_read_b128 v[108:111], v244 offset:26624
    v_mfma_f32_16x16x32_bf16 v[32:35], v[64:67], v[140:143], v[32:35]
    ds_read_b128 v[112:115], v244 offset:28672
    v_mfma_f32_16x16x32_bf16 v[36:39], v[64:67], v[144:147], v[36:39]
    v_mfma_f32_16x16x32_bf16 v[40:43], v[68:71], v[140:143], v[40:43]
    v_mfma_f32_16x16x32_bf16 v[44:47], v[68:71], v[144:147], v[44:47]
    v_mfma_f32_16x16x32_bf16 v[48:51], v[72:75], v[140:143], v[48:51]
    v_mfma_f32_16x16x32_bf16 v[52:55], v[72:75], v[144:147], v[52:55]
    s_add_u32 s46, s54, 30720
    s_sub_u32 s47, s46, 40960
    s_min_u32 s46, s46, s47
    buffer_load_dwordx4 v[140:143], v248, s[8:11], s46 offen sc1
    buffer_load_dwordx4 v[144:147], v249, s[8:11], s46 offen sc1
    s_waitcnt vmcnt(10) lgkmcnt(5)
    v_mfma_f32_16x16x32_bf16 v[16:19], v[76:79], v[148:151], v[16:19]
    ds_read_b128 v[56:59], v244 offset:30720
    v_mfma_f32_16x16x32_bf16 v[20:23], v[76:79], v[152:155], v[20:23]
    ds_read_b128 v[60:63], v244 offset:32768
    v_mfma_f32_16x16x32_bf16 v[24:27], v[80:83], v[148:151], v[24:27]
    ds_read_b128 v[64:67], v244 offset:34816
    v_mfma_f32_16x16x32_bf16 v[28:31], v[80:83], v[152:155], v[28:31]
    ds_read_b128 v[68:71], v244 offset:36864
    v_mfma_f32_16x16x32_bf16 v[32:35], v[84:87], v[148:151], v[32:35]
    ds_read_b128 v[72:75], v244 offset:38912
    v_mfma_f32_16x16x32_bf16 v[36:39], v[84:87], v[152:155], v[36:39]
    v_mfma_f32_16x16x32_bf16 v[40:43], v[88:91], v[148:151], v[40:43]
    v_mfma_f32_16x16x32_bf16 v[44:47], v[88:91], v[152:155], v[44:47]
    v_mfma_f32_16x16x32_bf16 v[48:51], v[92:95], v[148:151], v[48:51]
    v_mfma_f32_16x16x32_bf16 v[52:55], v[92:95], v[152:155], v[52:55]
    s_add_u32 s46, s54, 32768
    s_sub_u32 s47, s46, 40960
    s_min_u32 s46, s46, s47
    buffer_load_dwordx4 v[148:151], v248, s[8:11], s46 offen sc1
    buffer_load_dwordx4 v[152:155], v249, s[8:11], s46 offen sc1
    s_waitcnt vmcnt(10) lgkmcnt(5)
    v_mfma_f32_16x16x32_bf16 v[16:19], v[96:99], v[156:159], v[16:19]
    ds_read_b128 v[76:79], v244 offset:40960
    v_mfma_f32_16x16x32_bf16 v[20:23], v[96:99], v[160:163], v[20:23]
    ds_read_b128 v[80:83], v244 offset:43008
    v_mfma_f32_16x16x32_bf16 v[24:27], v[100:103], v[156:159], v[24:27]
    ds_read_b128 v[84:87], v244 offset:45056
    v_mfma_f32_16x16x32_bf16 v[28:31], v[100:103], v[160:163], v[28:31]
    ds_read_b128 v[88:91], v244 offset:47104
    v_mfma_f32_16x16x32_bf16 v[32:35], v[104:107], v[156:159], v[32:35]
    ds_read_b128 v[92:95], v244 offset:49152
    v_mfma_f32_16x16x32_bf16 v[36:39], v[104:107], v[160:163], v[36:39]
    v_mfma_f32_16x16x32_bf16 v[40:43], v[108:111], v[156:159], v[40:43]
    v_mfma_f32_16x16x32_bf16 v[44:47], v[108:111], v[160:163], v[44:47]
    v_mfma_f32_16x16x32_bf16 v[48:51], v[112:115], v[156:159], v[48:51]
    v_mfma_f32_16x16x32_bf16 v[52:55], v[112:115], v[160:163], v[52:55]
    s_add_u32 s46, s54, 34816
    s_sub_u32 s47, s46, 40960
    s_min_u32 s46, s46, s47
    buffer_load_dwordx4 v[156:159], v248, s[8:11], s46 offen sc1
    buffer_load_dwordx4 v[160:163], v249, s[8:11], s46 offen sc1
    s_waitcnt vmcnt(10) lgkmcnt(5)
    s_barrier
    v_mfma_f32_16x16x32_bf16 v[16:19], v[56:59], v[116:119], v[16:19]
    ds_read_b128 v[96:99], v245 offset:0
    v_mfma_f32_16x16x32_bf16 v[20:23], v[56:59], v[120:123], v[20:23]
    ds_read_b128 v[100:103], v245 offset:2048
    v_mfma_f32_16x16x32_bf16 v[24:27], v[60:63], v[116:119], v[24:27]
    ds_read_b128 v[104:107], v245 offset:4096
    v_mfma_f32_16x16x32_bf16 v[28:31], v[60:63], v[120:123], v[28:31]
    ds_read_b128 v[108:111], v245 offset:6144
    v_mfma_f32_16x16x32_bf16 v[32:35], v[64:67], v[116:119], v[32:35]
    ds_read_b128 v[112:115], v245 offset:8192
    v_mfma_f32_16x16x32_bf16 v[36:39], v[64:67], v[120:123], v[36:39]
    v_mfma_f32_16x16x32_bf16 v[40:43], v[68:71], v[116:119], v[40:43]
    v_mfma_f32_16x16x32_bf16 v[44:47], v[68:71], v[120:123], v[44:47]
    v_mfma_f32_16x16x32_bf16 v[48:51], v[72:75], v[116:119], v[48:51]
    v_mfma_f32_16x16x32_bf16 v[52:55], v[72:75], v[120:123], v[52:55]
    s_add_u32 s46, s54, 36864
    s_sub_u32 s47, s46, 40960
    s_min_u32 s46, s46, s47
    buffer_load_dwordx4 v[116:119], v248, s[8:11], s46 offen sc1
    buffer_load_dwordx4 v[120:123], v249, s[8:11], s46 offen sc1
    s_waitcnt vmcnt(10) lgkmcnt(5)
    v_mfma_f32_16x16x32_bf16 v[16:19], v[76:79], v[124:127], v[16:19]
    ds_read_b128 v[56:59], v245 offset:10240
    v_mfma_f32_16x16x32_bf16 v[20:23], v[76:79], v[128:131], v[20:23]
    ds_read_b128 v[60:63], v245 offset:12288
    v_mfma_f32_16x16x32_bf16 v[24:27], v[80:83], v[124:127], v[24:27]
    ds_read_b128 v[64:67], v245 offset:14336
    v_mfma_f32_16x16x32_bf16 v[28:31], v[80:83], v[128:131], v[28:31]
    ds_read_b128 v[68:71], v245 offset:16384
    v_mfma_f32_16x16x32_bf16 v[32:35], v[84:87], v[124:127], v[32:35]
    ds_read_b128 v[72:75], v245 offset:18432
    v_mfma_f32_16x16x32_bf16 v[36:39], v[84:87], v[128:131], v[36:39]
    v_mfma_f32_16x16x32_bf16 v[40:43], v[88:91], v[124:127], v[40:43]
    v_mfma_f32_16x16x32_bf16 v[44:47], v[88:91], v[128:131], v[44:47]
    v_mfma_f32_16x16x32_bf16 v[48:51], v[92:95], v[124:127], v[48:51]
    v_mfma_f32_16x16x32_bf16 v[52:55], v[92:95], v[128:131], v[52:55]
    s_add_u32 s46, s54, 38912
    s_sub_u32 s47, s46, 40960
    s_min_u32 s46, s46, s47
    buffer_load_dwordx4 v[124:127], v248, s[8:11], s46 offen sc1
    buffer_load_dwordx4 v[128:131], v249, s[8:11], s46 offen sc1
    s_waitcnt vmcnt(10) lgkmcnt(5)
    v_mfma_f32_16x16x32_bf16 v[16:19], v[96:99], v[132:135], v[16:19]
    ds_read_b128 v[76:79], v245 offset:20480
    v_mfma_f32_16x16x32_bf16 v[20:23], v[96:99], v[136:139], v[20:23]
    ds_read_b128 v[80:83], v245 offset:22528
    v_mfma_f32_16x16x32_bf16 v[24:27], v[100:103], v[132:135], v[24:27]
    ds_read_b128 v[84:87], v245 offset:24576
    v_mfma_f32_16x16x32_bf16 v[28:31], v[100:103], v[136:139], v[28:31]
    ds_read_b128 v[88:91], v245 offset:26624
    v_mfma_f32_16x16x32_bf16 v[32:35], v[104:107], v[132:135], v[32:35]
    ds_read_b128 v[92:95], v245 offset:28672
    v_mfma_f32_16x16x32_bf16 v[36:39], v[104:107], v[136:139], v[36:39]
    v_mfma_f32_16x16x32_bf16 v[40:43], v[108:111], v[132:135], v[40:43]
    v_mfma_f32_16x16x32_bf16 v[44:47], v[108:111], v[136:139], v[44:47]
    v_mfma_f32_16x16x32_bf16 v[48:51], v[112:115], v[132:135], v[48:51]
    v_mfma_f32_16x16x32_bf16 v[52:55], v[112:115], v[136:139], v[52:55]
    s_waitcnt vmcnt(8) lgkmcnt(5)
    v_mfma_f32_16x16x32_bf16 v[16:19], v[56:59], v[140:143], v[16:19]
    ds_read_b128 v[96:99], v245 offset:30720
    v_mfma_f32_16x16x32_bf16 v[20:23], v[56:59], v[144:147], v[20:23]
    ds_read_b128 v[100:103], v245 offset:32768
    v_mfma_f32_16x16x32_bf16 v[24:27], v[60:63], v[140:143], v[24:27]
    ds_read_b128 v[104:107], v245 offset:34816
    v_mfma_f32_16x16x32_bf16 v[28:31], v[60:63], v[144:147], v[28:31]
    ds_read_b128 v[108:111], v245 offset:36864
    v_mfma_f32_16x16x32_bf16 v[32:35], v[64:67], v[140:143], v[32:35]
    ds_read_b128 v[112:115], v245 offset:38912
    v_mfma_f32_16x16x32_bf16 v[36:39], v[64:67], v[144:147], v[36:39]
    v_mfma_f32_16x16x32_bf16 v[40:43], v[68:71], v[140:143], v[40:43]
    v_mfma_f32_16x16x32_bf16 v[44:47], v[68:71], v[144:147], v[44:47]
    v_mfma_f32_16x16x32_bf16 v[48:51], v[72:75], v[140:143], v[48:51]
    v_mfma_f32_16x16x32_bf16 v[52:55], v[72:75], v[144:147], v[52:55]
    s_waitcnt vmcnt(6) lgkmcnt(5)
    v_mfma_f32_16x16x32_bf16 v[16:19], v[76:79], v[148:151], v[16:19]
    ds_read_b128 v[56:59], v245 offset:40960
    v_mfma_f32_16x16x32_bf16 v[20:23], v[76:79], v[152:155], v[20:23]
    ds_read_b128 v[60:63], v245 offset:43008
    v_mfma_f32_16x16x32_bf16 v[24:27], v[80:83], v[148:151], v[24:27]
    ds_read_b128 v[64:67], v245 offset:45056
    v_mfma_f32_16x16x32_bf16 v[28:31], v[80:83], v[152:155], v[28:31]
    ds_read_b128 v[68:71], v245 offset:47104
    v_mfma_f32_16x16x32_bf16 v[32:35], v[84:87], v[148:151], v[32:35]
    ds_read_b128 v[72:75], v245 offset:49152
    v_mfma_f32_16x16x32_bf16 v[36:39], v[84:87], v[152:155], v[36:39]
    v_mfma_f32_16x16x32_bf16 v[40:43], v[88:91], v[148:151], v[40:43]
    v_mfma_f32_16x16x32_bf16 v[44:47], v[88:91], v[152:155], v[44:47]
    v_mfma_f32_16x16x32_bf16 v[48:51], v[92:95], v[148:151], v[48:51]
    v_mfma_f32_16x16x32_bf16 v[52:55], v[92:95], v[152:155], v[52:55]
    s_waitcnt vmcnt(4) lgkmcnt(5)
    v_mfma_f32_16x16x32_bf16 v[16:19], v[96:99], v[156:159], v[16:19]
    ds_read_b128 v[76:79], v246 offset:0
    v_mfma_f32_16x16x32_bf16 v[20:23], v[96:99], v[160:163], v[20:23]
    ds_read_b128 v[80:83], v246 offset:2048
    v_mfma_f32_16x16x32_bf16 v[24:27], v[100:103], v[156:159], v[24:27]
    ds_read_b128 v[84:87], v246 offset:4096
    v_mfma_f32_16x16x32_bf16 v[28:31], v[100:103], v[160:163], v[28:31]
    ds_read_b128 v[88:91], v246 offset:6144
    v_mfma_f32_16x16x32_bf16 v[32:35], v[104:107], v[156:159], v[32:35]
    ds_read_b128 v[92:95], v246 offset:8192
    v_mfma_f32_16x16x32_bf16 v[36:39], v[104:107], v[160:163], v[36:39]
    v_mfma_f32_16x16x32_bf16 v[40:43], v[108:111], v[156:159], v[40:43]
    v_mfma_f32_16x16x32_bf16 v[44:47], v[108:111], v[160:163], v[44:47]
    v_mfma_f32_16x16x32_bf16 v[48:51], v[112:115], v[156:159], v[48:51]
    v_mfma_f32_16x16x32_bf16 v[52:55], v[112:115], v[160:163], v[52:55]
    s_waitcnt vmcnt(2) lgkmcnt(5)
    v_mfma_f32_16x16x32_bf16 v[16:19], v[56:59], v[116:119], v[16:19]
    v_mfma_f32_16x16x32_bf16 v[20:23], v[56:59], v[120:123], v[20:23]
    v_mfma_f32_16x16x32_bf16 v[24:27], v[60:63], v[116:119], v[24:27]
    v_mfma_f32_16x16x32_bf16 v[28:31], v[60:63], v[120:123], v[28:31]
    v_mfma_f32_16x16x32_bf16 v[32:35], v[64:67], v[116:119], v[32:35]
    v_mfma_f32_16x16x32_bf16 v[36:39], v[64:67], v[120:123], v[36:39]
    v_mfma_f32_16x16x32_bf16 v[40:43], v[68:71], v[116:119], v[40:43]
    v_mfma_f32_16x16x32_bf16 v[44:47], v[68:71], v[120:123], v[44:47]
    v_mfma_f32_16x16x32_bf16 v[48:51], v[72:75], v[116:119], v[48:51]
    v_mfma_f32_16x16x32_bf16 v[52:55], v[72:75], v[120:123], v[52:55]
    s_waitcnt vmcnt(0) lgkmcnt(0)
    v_mfma_f32_16x16x32_bf16 v[20:23], v[76:79], v[128:131], v[20:23]
    v_mfma_f32_16x16x32_bf16 v[28:31], v[80:83], v[128:131], v[28:31]
    v_mfma_f32_16x16x32_bf16 v[36:39], v[84:87], v[128:131], v[36:39]
    v_mfma_f32_16x16x32_bf16 v[44:47], v[88:91], v[128:131], v[44:47]
    v_mfma_f32_16x16x32_bf16 v[52:55], v[92:95], v[128:131], v[52:55]
    v_mfma_f32_16x16x32_bf16 v[16:19], v[76:79], v[124:127], v[16:19]
    v_mfma_f32_16x16x32_bf16 v[24:27], v[80:83], v[124:127], v[24:27]
    v_mfma_f32_16x16x32_bf16 v[32:35], v[84:87], v[124:127], v[32:35]
    v_mfma_f32_16x16x32_bf16 v[40:43], v[88:91], v[124:127], v[40:43]
    v_mfma_f32_16x16x32_bf16 v[48:51], v[92:95], v[124:127], v[48:51]
    s_mov_b32 s60, 0xff
    s_add_u32 s22, s20, 4096
    ds_write_b128 v250, v[20:23] offset:0
    ds_write_b128 v250, v[28:31] offset:1024
    ds_write_b128 v250, v[36:39] offset:2048
    ds_write_b128 v250, v[44:47] offset:3072
    ds_write_b128 v250, v[52:55] offset:4096
    v_lshrrev_b32 v218, 8, v217
    v_lshrrev_b32 v219, 16, v217
    v_lshrrev_b32 v220, 24, v217
    s_waitcnt lgkmcnt(0)
    s_barrier
    ds_read_b128 v[56:59], v251 offset:0
    ds_read_b128 v[60:63], v251 offset:1024
    ds_read_b128 v[64:67], v251 offset:2048
    ds_read_b128 v[68:71], v251 offset:3072
    ds_read_b128 v[72:75], v251 offset:4096
    s_waitcnt lgkmcnt(4)
    v_pk_add_f32 v[16:17], v[16:17], v[56:57]
    v_pk_add_f32 v[18:19], v[18:19], v[58:59]
    v_bfi_b32 v16, s60, v217, v16
    v_bfi_b32 v17, s60, v218, v17
    v_bfi_b32 v18, s60, v219, v18
    v_bfi_b32 v19, s60, v220, v19
    buffer_store_dwordx4 v[16:19], v5, s[8:11], s20 offen offset:0 sc1
    s_waitcnt lgkmcnt(3)
    v_pk_add_f32 v[24:25], v[24:25], v[60:61]
    v_pk_add_f32 v[26:27], v[26:27], v[62:63]
    v_bfi_b32 v24, s60, v217, v24
    v_bfi_b32 v25, s60, v218, v25
    v_bfi_b32 v26, s60, v219, v26
    v_bfi_b32 v27, s60, v220, v27
    buffer_store_dwordx4 v[24:27], v5, s[8:11], s20 offen offset:1024 sc1
    s_waitcnt lgkmcnt(2)
    v_pk_add_f32 v[32:33], v[32:33], v[64:65]
    v_pk_add_f32 v[34:35], v[34:35], v[66:67]
    v_bfi_b32 v32, s60, v217, v32
    v_bfi_b32 v33, s60, v218, v33
    v_bfi_b32 v34, s60, v219, v34
    v_bfi_b32 v35, s60, v220, v35
    buffer_store_dwordx4 v[32:35], v5, s[8:11], s20 offen offset:2048 sc1
    s_waitcnt lgkmcnt(1)
    v_pk_add_f32 v[40:41], v[40:41], v[68:69]
    v_pk_add_f32 v[42:43], v[42:43], v[70:71]
    v_bfi_b32 v40, s60, v217, v40
    v_bfi_b32 v41, s60, v218, v41
    v_bfi_b32 v42, s60, v219, v42
    v_bfi_b32 v43, s60, v220, v43
    buffer_store_dwordx4 v[40:43], v5, s[8:11], s20 offen offset:3072 sc1
    s_waitcnt lgkmcnt(0)
    v_pk_add_f32 v[48:49], v[48:49], v[72:73]
    v_pk_add_f32 v[50:51], v[50:51], v[74:75]
    v_bfi_b32 v48, s60, v217, v48
    v_bfi_b32 v49, s60, v218, v49
    v_bfi_b32 v50, s60, v219, v50
    v_bfi_b32 v51, s60, v220, v51
    buffer_store_dwordx4 v[48:51], v5, s[8:11], s22 offen offset:0 sc1
L_end:
    s_endpgm
.set CODE_BYTES, L_end - L_pc
.section .rodata,"a"
.p2align 6
.amdhsa_kernel recurrent_scan__ssm_conv_s5__glu_gated_swiglu__prompt_kernel
  .amdhsa_next_free_vgpr 256
  .amdhsa_next_free_sgpr 102
  .amdhsa_accum_offset 256
  .amdhsa_group_segment_fixed_size 0
  .amdhsa_kernarg_size 128
  .amdhsa_user_sgpr_count 2
  .amdhsa_user_sgpr_kernarg_segment_ptr 1
  .amdhsa_system_sgpr_workgroup_id_x 1
.end_amdhsa_kernel
```
